```python
import torch

def _softmax(x, axis=-1):
    return torch.softmax(x, dim=axis)
def _gelu(x):
    return torch.nn.functional.gelu(x, approximate="tanh")
def _silu(x):
    return torch.nn.functional.silu(x)
def _sigmoid(x):
    return torch.sigmoid(x)
def _layernorm(x, axis=-1, eps=1e-5):
    m = x.mean(dim=axis, keepdim=True)
    v = x.var(dim=axis, keepdim=True, unbiased=False)
    return (x - m) / torch.sqrt(v + eps)
def _scatter_add(tgt, idx, src, axis=0):
    return tgt.clone().index_add_(axis, idx, src)
def _segment_sum(src, seg, n):
    out = torch.zeros((n,) + src.shape[1:], dtype=src.dtype)
    return out.index_add_(0, seg, src)
def _pad(x, pw):
    flat = tuple(v for pair in reversed(pw) for v in pair)
    return torch.nn.functional.pad(x, flat)

kernel_name = 'sequential_preLN__grouped_kv_mqa__glu_gated_geglu__prompt'

def setup_inputs():

    _w = (lambda a: (lambda t: t.to(torch.bfloat16) if t.is_floating_point() else t)(torch.as_tensor(a)))
    def _A_setup():
        B, S, D, H = 1, 2048, 640, 32
        Dh = D // H
        return {
            "x": _w((lambda *s: torch.randn(*s, dtype=torch.bfloat16) * 0.05)(B, S, D)),
            "wq": _w((lambda *s: torch.randn(*s, dtype=torch.bfloat16) * 0.05)(D, H * Dh)),
            "wk": _w((lambda *s: torch.randn(*s, dtype=torch.bfloat16) * 0.05)(D, Dh)),
            "wv": _w((lambda *s: torch.randn(*s, dtype=torch.bfloat16) * 0.05)(D, Dh)),
            "wo": _w((lambda *s: torch.randn(*s, dtype=torch.bfloat16) * 0.05)(H * Dh, D)),
        }
    _A_in = _A_setup()

    def _B_setup():
        B, S, Dm, Df = 1, 2048, 640, 1536
        return {
            "x": _w((lambda *s: torch.randn(*s, dtype=torch.bfloat16) * 0.05)(B, S, Dm)),
            "w_gate": _w((lambda *s: torch.randn(*s, dtype=torch.bfloat16) * 0.8)(Dm, Df) * (Dm ** -0.5)),
            "w_up": _w((lambda *s: torch.randn(*s, dtype=torch.bfloat16) * 0.8)(Dm, Df) * (Dm ** -0.5)),
            "w_down": _w((lambda *s: torch.randn(*s, dtype=torch.bfloat16) * 0.8)(Df, Dm) * (Df ** -0.5)),
        }
    _B_in = _B_setup()

    return {
        "A_x": _A_in["x"],
        "A_wq": _A_in["wq"],
        "A_wk": _A_in["wk"],
        "A_wv": _A_in["wv"],
        "A_wo": _A_in["wo"],
        "B_x": _B_in["x"],
        "B_w_gate": _B_in["w_gate"],
        "B_w_up": _B_in["w_up"],
        "B_w_down": _B_in["w_down"],
    }

def reference(A_x, A_wq, A_wk, A_wv, A_wo, B_x, B_w_gate, B_w_up, B_w_down):
    def _A_ref(x, wq, wk, wv, wo):
        B, S, D = x.shape
        H = 32
        Dh = D // H
        q = (lambda x, *d: x.permute(*d))((x @ wq).reshape(B, S, H, Dh), 0, 2, 1, 3)
        k = x @ wk
        v = x @ wv
        scores = torch.einsum("bhqd,bkd->bhqk", q, k) * (Dh ** -0.5)
        p = _softmax(scores, axis=-1)
        o = torch.einsum("bhqk,bkd->bhqd", p, v)
        return (lambda x, *d: x.permute(*d))(o, 0, 2, 1, 3).reshape(B, S, H * Dh) @ wo

    def _B_ref(x, w_gate, w_up, w_down):
        g = torch.einsum("bsd,df->bsf", x, w_gate)
        u = torch.einsum("bsd,df->bsf", x, w_up)
        h = _gelu(g) * u
        return torch.einsum("bsf,fd->bsd", h, w_down)

    x = A_x
    h = x + _A_ref(_layernorm(x, axis=-1), A_wq, A_wk, A_wv, A_wo)
    h2 = h + _B_ref(_layernorm(h, axis=-1), B_w_gate, B_w_up, B_w_down)
    return h2
```

```asm
; @launch grid=(256,1,1) block=(512,1,1) lds=163840
.amdgcn_target "amdgcn-amd-amdhsa--gfx950"
.text
.globl sequential_preLN__grouped_kv_mqa__glu_gated_geglu__prompt_kernel
.p2align 8
.type sequential_preLN__grouped_kv_mqa__glu_gated_geglu__prompt_kernel,@function
sequential_preLN__grouped_kv_mqa__glu_gated_geglu__prompt_kernel:
    s_cmp_ge_u32 s2, 256
    s_cbranch_scc1 L_exit
    s_load_dwordx16 s[52:67], s[0:1], 0
    s_load_dwordx8 s[68:75], s[0:1], 64
    s_getpc_b64 s[80:81]
L_pc:
    v_lshrrev_b32 v1, 6, v0
    v_and_b32 v245, 63, v0
    s_lshr_b32 s5, s2, 3
    s_lshl_b32 s78, s5, 11
    v_lshlrev_b32 v253, 7, v245
    v_lshl_add_u32 v2, v1, 8, v253
    v_add_u32 v2, s78, v2
    v_min_u32 v2, L_end-L_pc-4, v2
    s_mov_b64 exec, 3
    global_load_dword v203, v2, s[80:81]
    s_mov_b64 exec, -1
    v_readfirstlane_b32 s3, v1
    s_and_b32 s4, s2, 7
    s_lshr_b32 s6, s5, 3
    s_and_b32 s7, s5, 7
    s_lshl_b32 s78, s4, 2
    s_add_u32 s6, s6, s78
    s_lshr_b32 s43, s3, 1
    s_and_b32 s44, s3, 1
    s_lshl_b32 s50, s6, 2
    s_add_u32 s50, s50, s43
    s_mul_i32 s78, s50, 20480
    s_mul_i32 s79, s44, 640
    s_add_u32 s78, s78, s79
    v_lshrrev_b32 v209, 3, v245
    v_lshrrev_b32 v210, 4, v245
    v_and_b32 v211, 7, v245
    v_xor_b32 v211, v211, v210
    v_mul_u32_u24 v4, 1280, v209
    v_lshl_add_u32 v4, v211, 4, v4
    v_add_u32 v200, s78, v4
    v_xor_b32 v201, 64, v200
    s_mul_i32 s51, s3, 10240
    s_cmp_lt_u32 s3, 5
    s_cselect_b32 s78, 0, 25600
    s_add_u32 s51, s51, s78
    s_add_u32 s51, s51, 51200
    s_and_b32 s47, s7, 3
    s_waitcnt lgkmcnt(0)
    s_mov_b32 s8, s52
    s_mov_b32 s9, s53
    s_mov_b32 s10, 2621440
    s_mov_b32 s11, 0x00020000
    s_cmp_lg_u32 s47, s43
    s_cbranch_scc1 L_a1
    s_setprio 2
    s_movk_i32 s79, 10240
    s_add_u32 m0, s51, 0
    s_nop 0
    buffer_load_dwordx4 v200, s[8:11], 0 offen offset:0 lds
    s_add_u32 m0, s51, 1024
    s_nop 0
    buffer_load_dwordx4 v201, s[8:11], s79 offen offset:0 lds
    s_add_u32 m0, s51, 1920
    s_nop 0
    buffer_load_dwordx4 v200, s[8:11], 0 offen offset:128 lds
    s_add_u32 m0, s51, 2944
    s_nop 0
    buffer_load_dwordx4 v201, s[8:11], s79 offen offset:128 lds
    s_add_u32 m0, s51, 3840
    s_nop 0
    buffer_load_dwordx4 v200, s[8:11], 0 offen offset:256 lds
    s_add_u32 m0, s51, 4864
    s_nop 0
    buffer_load_dwordx4 v201, s[8:11], s79 offen offset:256 lds
    s_add_u32 m0, s51, 5760
    s_nop 0
    buffer_load_dwordx4 v200, s[8:11], 0 offen offset:384 lds
    s_add_u32 m0, s51, 6784
    s_nop 0
    buffer_load_dwordx4 v201, s[8:11], s79 offen offset:384 lds
    s_add_u32 m0, s51, 7680
    s_nop 0
    buffer_load_dwordx4 v200, s[8:11], 0 offen offset:512 lds
    s_add_u32 m0, s51, 8704
    s_nop 0
    buffer_load_dwordx4 v201, s[8:11], s79 offen offset:512 lds
    s_mov_b32 s36, s74
    s_mov_b32 s37, s75
    s_mov_b32 s38, 16777216
    s_mov_b32 s39, 0x00020000
    s_mov_b32 s12, s54
    s_mov_b32 s13, s55
    s_mov_b32 s14, 819200
    s_mov_b32 s15, 0x00020000
    s_cmp_lt_u32 s7, 4
    s_cselect_b32 s16, s56, s58
    s_cselect_b32 s17, s57, s59
    s_mov_b32 s18, 25600
    s_mov_b32 s19, 0x00020000
    s_lshr_b32 s78, s5, 3
    s_lshl_b32 s78, s78, 2
    s_add_u32 s78, s78, s47
    s_lshl_b32 s78, s78, 1
    s_add_u32 s78, s78, s44
    s_mul_i32 s78, s78, 896
    s_mov_b64 exec, 0x7f
    buffer_load_dword v203, v253, s[16:19], s78 offen
    s_mov_b64 exec, -1
    buffer_load_dword v202, off, s[36:39], 0 sc1
    s_lshl_b32 s78, s4, 5
    s_add_u32 s78, s78, s5
    s_lshl_b32 s78, s78, 7
    s_add_u32 s75, s78, 4096
    s_mul_i32 s49, s44, 409600
    s_add_u32 s49, s49, 368640
    s_mul_i32 s48, s44, 5120
    s_add_u32 s48, s48, 92160
    v_mov_b32 v219, 0
    s_branch L_a2
L_a1:
    s_mov_b32 s36, s74
    s_mov_b32 s37, s75
    s_mov_b32 s38, 16777216
    s_mov_b32 s39, 0x00020000
    s_mov_b32 s12, s54
    s_mov_b32 s13, s55
    s_mov_b32 s14, 819200
    s_mov_b32 s15, 0x00020000
    s_cmp_lt_u32 s7, 4
    s_cselect_b32 s16, s56, s58
    s_cselect_b32 s17, s57, s59
    s_mov_b32 s18, 25600
    s_mov_b32 s19, 0x00020000
    s_sub_u32 s48, s3, 2
    s_cmp_gt_u32 s43, s47
    s_cselect_b32 s48, s48, s3
    s_mul_i32 s49, s5, 6
    s_add_u32 s49, s49, s48
    s_add_u32 s78, s49, 224
    s_cmp_lt_u32 s49, 96
    s_cselect_b32 s78, s49, s78
    s_mul_i32 s78, s78, 1280
    s_mov_b64 exec, 0x3ff
    buffer_load_dword v203, v253, s[12:15], s78 offen
    s_mov_b64 exec, -1
    s_mul_i32 s79, s49, 3072
    v_add_u32 v204, s79, v253
    v_add_u32 v205, 122880, v204
    v_cmp_gt_u32 vcc, 286720, v204
    s_mov_b32 s75, 122880
    s_and_b32 s49, s48, 1
    v_cndmask_b32 v219, v205, v204, vcc
    s_mul_i32 s49, s49, 10
    s_lshr_b32 s79, s48, 1
    s_add_u32 s49, s49, s79
    s_mul_i32 s49, s49, 40960
    s_mul_i32 s48, s48, 5120
L_a2:
    s_getreg_b32 s41, hwreg(HW_REG_XCC_ID, 0, 4)
    s_lshr_b32 s45, s3, 2
    s_and_b32 s46, s3, 3
    v_lshlrev_b32 v246, 4, v245
    v_mov_b32 v216, 0
    v_lshlrev_b32 v215, 2, v245
    v_add_u32 v215, 161792, v215
    ds_write_b32 v215, v216
    s_mul_i32 s50, s50, 1280
    s_lshr_b32 s79, s7, 2
    s_mul_i32 s79, s79, 640
    s_add_u32 s50, s50, s79
    s_add_u32 s50, s50, 65536
    v_mov_b32 v255, 0
    v_mov_b32 v226, 0
    v_mov_b32 v227, 0
    v_mov_b32 v229, 0
    v_mov_b32 v232, 0
    v_mov_b32 v233, 0
    v_mov_b32 v252, 0
    s_mul_i32 s78, s7, 160
    v_add_u32 v204, 0, v245
    v_mul_u32_u24 v205, 6554, v204
    v_lshrrev_b32 v205, 16, v205
    v_mul_u32_u24 v206, 10, v205
    v_sub_u32 v206, v204, v206
    v_and_b32 v207, 3, v205
    v_bfe_u32 v208, v205, 2, 2
    v_lshrrev_b32 v204, 4, v205
    v_lshl_add_u32 v207, v208, 3, v207
    v_lshl_add_u32 v207, v204, 2, v207
    v_mul_u32_u24 v207, 1280, v207
    v_lshl_add_u32 v207, v206, 4, v207
    v_add_u32 v240, s78, v207
    v_add_u32 v204, 64, v245
    v_mul_u32_u24 v205, 6554, v204
    v_lshrrev_b32 v205, 16, v205
    v_mul_u32_u24 v206, 10, v205
    v_sub_u32 v206, v204, v206
    v_and_b32 v207, 3, v205
    v_bfe_u32 v208, v205, 2, 2
    v_lshrrev_b32 v204, 4, v205
    v_lshl_add_u32 v207, v208, 3, v207
    v_lshl_add_u32 v207, v204, 2, v207
    v_mul_u32_u24 v207, 1280, v207
    v_lshl_add_u32 v207, v206, 4, v207
    v_add_u32 v241, s78, v207
    v_add_u32 v204, 128, v245
    v_mul_u32_u24 v205, 6554, v204
    v_lshrrev_b32 v205, 16, v205
    v_mul_u32_u24 v206, 10, v205
    v_sub_u32 v206, v204, v206
    v_and_b32 v207, 3, v205
    v_bfe_u32 v208, v205, 2, 2
    v_lshrrev_b32 v204, 4, v205
    v_lshl_add_u32 v207, v208, 3, v207
    v_lshl_add_u32 v207, v204, 2, v207
    v_mul_u32_u24 v207, 1280, v207
    v_lshl_add_u32 v207, v206, 4, v207
    v_add_u32 v242, s78, v207
    v_add_u32 v204, 192, v245
    v_mul_u32_u24 v205, 6554, v204
    v_lshrrev_b32 v205, 16, v205
    v_mul_u32_u24 v206, 10, v205
    v_sub_u32 v206, v204, v206
    v_and_b32 v207, 3, v205
    v_bfe_u32 v208, v205, 2, 2
    v_lshrrev_b32 v204, 4, v205
    v_lshl_add_u32 v207, v208, 3, v207
    v_lshl_add_u32 v207, v204, 2, v207
    v_mul_u32_u24 v207, 1280, v207
    v_lshl_add_u32 v207, v206, 4, v207
    v_add_u32 v243, s78, v207
    v_add_u32 v204, 256, v245
    v_mul_u32_u24 v205, 6554, v204
    v_lshrrev_b32 v205, 16, v205
    v_mul_u32_u24 v206, 10, v205
    v_sub_u32 v206, v204, v206
    v_and_b32 v207, 3, v205
    v_bfe_u32 v208, v205, 2, 2
    v_lshrrev_b32 v204, 4, v205
    v_lshl_add_u32 v207, v208, 3, v207
    v_lshl_add_u32 v207, v204, 2, v207
    v_mul_u32_u24 v207, 1280, v207
    v_lshl_add_u32 v207, v206, 4, v207
    v_add_u32 v244, s78, v207
    s_mov_b32 s20, s60
    s_mov_b32 s21, s61
    s_mov_b32 s22, 819200
    s_mov_b32 s23, 0x00020000
    s_bitcmp1_b32 s3, 1
    s_cselect_b32 s24, s66, s64
    s_cselect_b32 s25, s67, s65
    s_mov_b32 s26, 1966080
    s_mov_b32 s27, 0x00020000
    s_mov_b32 s28, s68
    s_mov_b32 s29, s69
    s_mov_b32 s30, 1966080
    s_mov_b32 s31, 0x00020000
    s_mov_b32 s32, s70
    s_mov_b32 s33, s71
    s_mov_b32 s34, 2621440
    s_mov_b32 s35, 0x00020000
    s_mov_b32 s68, 0xAAAAAAAA
    s_mov_b32 s69, 0xAAAAAAAA
    s_mov_b32 s70, 0xCCCCCCCC
    s_mov_b32 s71, 0xCCCCCCCC
    v_and_b32 v212, 15, v245
    v_and_b32 v221, 31, v245
    v_lshrrev_b32 v222, 5, v245
    v_lshrrev_b32 v211, 1, v212
    v_xor_b32 v211, v211, v210
    v_lshlrev_b32 v211, 4, v211
    v_lshl_add_u32 v207, v212, 7, v211
    v_add_u32 v207, s51, v207
    v_xor_b32 v208, 64, v207
    s_lshl_b32 s78, s43, 8
    s_add_u32 s78, s78, 160768
    v_lshl_add_u32 v213, v212, 3, s78
    s_lshl_b32 s79, s44, 7
    v_add_u32 v214, s79, v213
    s_lshl_b32 s78, s3, 2
    s_add_u32 s78, s78, 161792
    v_mov_b32 v215, s78
    v_xor_b32 v217, 4, v215
    v_mov_b32 v216, 1
    v_mov_b32 v72, 0x3f803f80
    v_mov_b32 v73, 0x3f803f80
    v_mov_b32 v74, 0x3f803f80
    v_mov_b32 v75, 0x3f803f80
    v_and_b32 v247, 3, v245
    v_lshrrev_b32 v220, 2, v245
    v_mul_u32_u24 v220, 160, v220
    v_lshl_add_u32 v220, v247, 3, v220
    s_mul_i32 s79, s44, 5120
    v_add_u32 v218, s79, v220
    v_add_u32 v205, 61440, v218
    s_lshl_b32 s78, s43, 4
    v_add_u32 v206, s78, v212
    v_mul_u32_u24 v206, 336, v206
    v_lshl_add_u32 v206, v210, 4, v206
    s_mul_i32 s78, s44, 21504
    s_add_u32 s78, s78, 102400
    v_add_u32 v206, s78, v206
    s_lshl_b32 s78, s4, 12
    s_add_u32 s78, s78, 4096
    v_lshl_add_u32 v248, v221, 7, s78
    s_mov_b32 s54, 0
    s_cmp_ge_u32 s3, 4
    s_cbranch_scc1 L_b1n
    v_mul_u32_u24 v223, 336, v221
    s_mul_i32 s78, s46, 80
    s_add_u32 s78, s78, 102400
    v_add_u32 v223, s78, v223
    v_lshl_add_u32 v224, v222, 5, v223
    v_bfe_u32 v250, v245, 4, 1
    v_mul_u32_u24 v250, 1280, v250
    v_lshl_add_u32 v141, v212, 3, v250
    v_add_u32 v141, 512, v141
    v_lshl_add_u32 v140, v212, 4, v250
    v_lshl_add_u32 v140, v222, 8, v140
    v_and_b32 v250, 3, v245
    v_bfe_u32 v251, v245, 2, 1
    v_bfe_u32 v252, v245, 3, 1
    v_lshl_add_u32 v249, v251, 3, v250
    v_lshl_add_u32 v249, v252, 2, v249
    s_and_b32 s78, s46, 1
    s_lshl_b32 s79, s78, 2
    v_add_u32 v249, s79, v249
    s_lshl_b32 s79, s78, 4
    s_sub_u32 s79, 16, s79
    v_add_u32 v250, s79, v250
    v_cmp_gt_u32 vcc, 16, v221
    v_mul_u32_u24 v251, 20, v222
    s_nop 0
    v_cndmask_b32 v249, v250, v249, vcc
    v_add_u32 v249, v249, v251
    v_lshlrev_b32 v142, 4, v249
    v_add_u32 v142, 640, v142
    v_mov_b32 v143, 0xDDDDDDDD
    s_mov_b32 s76, 0x000fffff
    s_mov_b32 s77, 0x000fffff
    s_mov_b32 s52, 0x01100000
    s_mov_b32 s53, 0x01100000
    v_cndmask_b32 v96, 0, v72, s[52:53]
    v_mov_b32 v97, v96
    v_mov_b32 v98, v96
    v_mov_b32 v99, v96
    v_mov_b32 v100, v96
    v_mov_b32 v101, v96
    v_mov_b32 v102, v96
    v_mov_b32 v103, v96
    v_mov_b32 v104, v96
    v_mov_b32 v105, v96
    v_mov_b32 v106, v96
    v_mov_b32 v107, v96
    v_mov_b32 v108, v96
    v_mov_b32 v109, v96
    v_mov_b32 v110, v96
    v_mov_b32 v111, v96
    v_mov_b32 v112, v96
    v_mov_b32 v113, v96
    v_mov_b32 v114, v96
    v_mov_b32 v115, v96
    v_mov_b32 v116, v96
    v_mov_b32 v117, v96
    v_mov_b32 v118, v96
    v_mov_b32 v119, v96
    v_mov_b32 v120, v96
    v_mov_b32 v121, v96
    v_mov_b32 v122, v96
    v_mov_b32 v123, v96
    v_mov_b32 v124, v96
    v_mov_b32 v125, v96
    v_mov_b32 v126, v96
    v_mov_b32 v127, v96
    v_mov_b32 v0, 0
    v_mov_b32 v1, 0
    v_mov_b32 v2, 0
    v_mov_b32 v3, 0
    v_mov_b32 v4, 0
    v_mov_b32 v5, 0
    v_mov_b32 v6, 0
    v_mov_b32 v7, 0
    v_mov_b32 v8, 0
    v_mov_b32 v9, 0
    v_mov_b32 v10, 0
    v_mov_b32 v11, 0
    v_mov_b32 v12, 0
    v_mov_b32 v13, 0
    v_mov_b32 v14, 0
    v_mov_b32 v15, 0
    v_mov_b32 v16, 0
    v_mov_b32 v17, 0
    v_mov_b32 v18, 0
    v_mov_b32 v19, 0
    v_mov_b32 v20, 0
    v_mov_b32 v21, 0
    v_mov_b32 v22, 0
    v_mov_b32 v23, 0
    v_mov_b32 v24, 0
    v_mov_b32 v25, 0
    v_mov_b32 v26, 0
    v_mov_b32 v27, 0
    v_mov_b32 v28, 0
    v_mov_b32 v29, 0
    v_mov_b32 v30, 0
    v_mov_b32 v31, 0
    v_mul_u32_u24 v249, 1280, v212
    v_lshl_add_u32 v251, v210, 3, v249
    v_and_b32 v250, 1, v210
    v_lshl_add_u32 v249, v250, 5, v249
    v_lshl_add_u32 v250, v222, 4, v249
    s_lshl_b32 s63, s6, 2
    s_add_u32 s63, s63, s3
    s_mul_i32 s63, s63, 20480
    s_mul_i32 s57, s7, 160
    s_add_u32 s63, s63, s57
    v_bfe_u32 v226, v245, 4, 1
    v_mul_u32_u24 v226, 49152, v226
    v_lshl_add_u32 v226, v212, 4, v226
    v_lshl_add_u32 v227, v222, 8, v226
    s_mul_i32 s57, s6, 196608
    s_add_u32 s57, s57, 5767168
    s_lshl_b32 s58, s7, 2
    s_add_u32 s58, s58, s46
    s_lshl_b32 s62, s6, 7
    s_add_u32 s62, s62, 36864
    s_lshl_b32 s59, s58, 2
    s_add_u32 s56, s62, s59
    s_mul_i32 s58, s58, 20
    s_add_u32 s59, s58, 4
    s_lshr_b32 s59, s59, 3
    s_lshl_b32 s59, s59, 8
    s_add_u32 s59, s59, s57
    s_and_b32 s60, s46, 1
    s_lshl_b32 s61, s60, 4
    s_sub_u32 s58, s58, s61
    s_add_u32 s58, s58, 16
    s_lshr_b32 s58, s58, 3
    s_lshl_b32 s58, s58, 8
    s_lshl_b32 s60, s60, 3
    s_add_u32 s58, s58, s60
    s_add_u32 s58, s58, s57
    s_add_u32 s60, s58, 98304
    s_add_u32 s61, s59, 98304
    s_mul_i32 s64, s3, 49152
    s_add_u32 s57, s57, s64
    s_add_u32 s57, s57, 16384
    s_mov_b32 s64, 0
    s_mov_b32 s66, 0x21800000
    s_mov_b32 s67, 0x71800000
    s_mul_i32 s55, s46, 163840
    s_add_u32 s55, s55, 983040
    v_add_u32 v225, 51200, v220
    v_lshlrev_b32 v229, 2, v221
    s_branch L_b2n
L_b1n:
    s_mul_i32 s78, s5, 96
    s_mul_i32 s79, s44, 98304
    s_add_u32 s78, s78, s79
    v_add_u32 v0, 0, v221
    v_mul_u32_u24 v1, 10923, v0
    v_lshrrev_b32 v1, 16, v1
    v_mul_u32_u24 v2, 6, v1
    v_sub_u32 v2, v0, v2
    v_lshl_add_u32 v1, v222, 4, v1
    v_mul_u32_u24 v1, 3072, v1
    v_lshl_add_u32 v1, v2, 4, v1
    v_add_u32 v250, s78, v1
    v_add_u32 v0, 32, v221
    v_mul_u32_u24 v1, 10923, v0
    v_lshrrev_b32 v1, 16, v1
    v_mul_u32_u24 v2, 6, v1
    v_sub_u32 v2, v0, v2
    v_lshl_add_u32 v1, v222, 4, v1
    v_mul_u32_u24 v1, 3072, v1
    v_lshl_add_u32 v1, v2, 4, v1
    v_add_u32 v251, s78, v1
    v_add_u32 v0, 64, v221
    v_mul_u32_u24 v1, 10923, v0
    v_lshrrev_b32 v1, 16, v1
    v_mul_u32_u24 v2, 6, v1
    v_sub_u32 v2, v0, v2
    v_lshl_add_u32 v1, v222, 4, v1
    v_mul_u32_u24 v1, 3072, v1
    v_lshl_add_u32 v1, v2, 4, v1
    v_add_u32 v252, s78, v1
    s_mul_i32 s64, s46, 5120
    s_add_u32 s72, s4, 1
    s_and_b32 s72, s72, 7
    s_add_u32 s73, s4, s46
    s_add_u32 s73, s73, 2
    s_and_b32 s73, s73, 7
    s_lshr_b32 s57, s46, 1
    s_add_u32 s57, s57, 6
    s_add_u32 s74, s4, s57
    s_and_b32 s74, s74, 7
    s_add_u32 s78, s64, 65536
    s_mul_i32 s63, s4, 20480
    s_add_u32 s63, s63, s78
    s_mul_i32 s60, s72, 20480
    s_add_u32 s60, s60, s78
    s_mul_i32 s61, s73, 20480
    s_add_u32 s61, s61, 65536
    s_mul_i32 s78, s44, 10240
    s_mul_i32 s59, s74, 20480
    s_add_u32 s59, s59, s78
    s_add_u32 s59, s59, 65536
    s_mul_i32 s57, s57, 20480
    s_add_u32 s57, s57, s78
    s_mul_i32 s56, s46, 20480
    s_add_u32 s56, s56, 40960
    s_sub_u32 s73, s73, s72
    s_lshl_b32 s73, s73, 12
    s_lshl_b32 s72, s72, 12
    s_add_u32 s72, s72, 4096
    s_lshl_b32 s74, s74, 12
    s_add_u32 s74, s74, 4096
    v_lshl_add_u32 v233, v221, 7, s74
    v_mul_lo_u32 v232, v222, s73
    v_lshl_add_u32 v232, v221, 7, v232
    v_add_u32 v232, s72, v232
    s_mul_i32 s62, s5, 640
    s_add_u32 s62, s62, s61
    s_mul_i32 s58, s5, 320
    s_add_u32 s58, s58, s59
    s_andn2_b32 s65, s5, 1
    s_add_u32 s65, s65, s44
    s_mul_i32 s65, s65, 12288
    s_mov_b32 s79, 2147483647
    s_add_u32 s78, s5, 1
    s_bitcmp1_b32 s78, 1
    s_cselect_b32 s78, 8192, 0
    s_cselect_b32 s72, 4294967295, -1
    s_cselect_b32 s73, 0, -1
    s_add_u32 s65, s65, s78
    s_mul_i32 s74, s46, 192
    s_add_u32 s74, s74, s5
    s_mul_i32 s74, s74, 1280
    s_lshl_b32 s66, s5, 2
    s_add_u32 s66, s66, s46
    s_lshl_b32 s78, s66, 9
    v_add_u32 v255, s78, v253
    v_min_u32 v255, L_end-L_pc-4, v255
    s_mul_i32 s67, s66, 6400
    s_mul_i32 s66, s66, 7680
    s_mul_i32 s55, s46, 245760
    v_add_u32 v249, s64, v220
L_b2n:
    s_waitcnt lgkmcnt(0)
    s_cmp_eq_u32 s47, s43
    s_cbranch_scc1 L_c1
    s_barrier
    s_movk_i32 s79, 10240
    s_add_u32 m0, s51, 0
    s_nop 0
    buffer_load_dwordx4 v200, s[8:11], 0 offen offset:0 lds
    s_add_u32 m0, s51, 1024
    s_nop 0
    buffer_load_dwordx4 v201, s[8:11], s79 offen offset:0 lds
    s_add_u32 m0, s51, 1920
    s_nop 0
    buffer_load_dwordx4 v200, s[8:11], 0 offen offset:128 lds
    s_add_u32 m0, s51, 2944
    s_nop 0
    buffer_load_dwordx4 v201, s[8:11], s79 offen offset:128 lds
    s_add_u32 m0, s51, 3840
    s_nop 0
    buffer_load_dwordx4 v200, s[8:11], 0 offen offset:256 lds
    s_add_u32 m0, s51, 4864
    s_nop 0
    buffer_load_dwordx4 v201, s[8:11], s79 offen offset:256 lds
    s_add_u32 m0, s51, 5760
    s_nop 0
    buffer_load_dwordx4 v200, s[8:11], 0 offen offset:384 lds
    s_add_u32 m0, s51, 6784
    s_nop 0
    buffer_load_dwordx4 v201, s[8:11], s79 offen offset:384 lds
    s_add_u32 m0, s51, 7680
    s_nop 0
    buffer_load_dwordx4 v200, s[8:11], 0 offen offset:512 lds
    s_add_u32 m0, s51, 8704
    s_nop 0
    buffer_load_dwordx4 v201, s[8:11], s79 offen offset:512 lds
    buffer_load_dword v202, off, s[36:39], 0 sc1
    s_waitcnt vmcnt(0)
    s_mov_b64 exec, 0xffffff
    buffer_load_dword v203, v219, s[12:15], s75 offen
    s_mov_b64 exec, -1
    s_branch L_c3
L_c1:
    s_mul_i32 s78, s44, 12288
    s_add_u32 m0, s78, 102400
    s_nop 0
    buffer_load_dwordx4 v246, s[16:19], s78 offen offset:0 lds
    buffer_load_dwordx4 v246, s[16:19], s78 offen offset:1024 lds
    buffer_load_dwordx4 v246, s[16:19], s78 offen offset:2048 lds
    buffer_load_dwordx4 v246, s[16:19], s78 offen offset:3072 lds
    s_add_u32 s78, s78, 4096
    s_add_u32 m0, s78, 102400
    s_nop 0
    buffer_load_dwordx4 v246, s[16:19], s78 offen offset:0 lds
    buffer_load_dwordx4 v246, s[16:19], s78 offen offset:1024 lds
    buffer_load_dwordx4 v246, s[16:19], s78 offen offset:2048 lds
    buffer_load_dwordx4 v246, s[16:19], s78 offen offset:3072 lds
    s_add_u32 s78, s78, 4096
    s_add_u32 m0, s78, 102400
    s_nop 0
    buffer_load_dwordx4 v246, s[16:19], s78 offen offset:0 lds
    buffer_load_dwordx4 v246, s[16:19], s78 offen offset:1024 lds
    buffer_load_dwordx4 v246, s[16:19], s78 offen offset:2048 lds
    buffer_load_dwordx4 v246, s[16:19], s78 offen offset:3072 lds
    s_add_u32 s78, s78, 4096
    s_add_u32 m0, s78, 102400
    s_nop 0
    buffer_load_dwordx4 v246, s[16:19], s78 offen offset:0 lds
    s_barrier
    s_waitcnt vmcnt(13)
L_c3:
    ds_read_b128 v[144:147], v207 offset:0
    ds_read_b128 v[148:151], v208 offset:0
    ds_read_b128 v[152:155], v207 offset:2048
    ds_read_b128 v[156:159], v208 offset:2048
    ds_read_b128 v[160:163], v207 offset:4096
    ds_read_b128 v[164:167], v208 offset:4096
    ds_read_b128 v[168:171], v207 offset:6144
    ds_read_b128 v[172:175], v208 offset:6144
    ds_read_b128 v[176:179], v207 offset:8192
    ds_read_b128 v[180:183], v208 offset:8192
    v_readfirstlane_b32 s40, v202
    s_nop 0
    s_add_u32 s40, s40, 0x9E3779B9
    s_waitcnt lgkmcnt(9)
    v_mfma_f32_16x16x32_bf16 v[76:79], v[72:75], v[144:147], 0
    v_mfma_f32_16x16x32_bf16 v[80:83], v[144:147], v[144:147], 0
    s_waitcnt lgkmcnt(8)
    v_mfma_f32_16x16x32_bf16 v[76:79], v[72:75], v[148:151], v[76:79]
    v_mfma_f32_16x16x32_bf16 v[80:83], v[148:151], v[148:151], v[80:83]
    s_waitcnt lgkmcnt(7)
    v_mfma_f32_16x16x32_bf16 v[76:79], v[72:75], v[152:155], v[76:79]
    v_mfma_f32_16x16x32_bf16 v[80:83], v[152:155], v[152:155], v[80:83]
    s_waitcnt lgkmcnt(6)
    v_mfma_f32_16x16x32_bf16 v[76:79], v[72:75], v[156:159], v[76:79]
    v_mfma_f32_16x16x32_bf16 v[80:83], v[156:159], v[156:159], v[80:83]
    s_waitcnt lgkmcnt(5)
    v_mfma_f32_16x16x32_bf16 v[76:79], v[72:75], v[160:163], v[76:79]
    v_mfma_f32_16x16x32_bf16 v[80:83], v[160:163], v[160:163], v[80:83]
    s_waitcnt lgkmcnt(4)
    v_mfma_f32_16x16x32_bf16 v[76:79], v[72:75], v[164:167], v[76:79]
    v_mfma_f32_16x16x32_bf16 v[80:83], v[164:167], v[164:167], v[80:83]
    s_waitcnt lgkmcnt(3)
    v_mfma_f32_16x16x32_bf16 v[76:79], v[72:75], v[168:171], v[76:79]
    v_mfma_f32_16x16x32_bf16 v[80:83], v[168:171], v[168:171], v[80:83]
    s_waitcnt lgkmcnt(2)
    v_mfma_f32_16x16x32_bf16 v[76:79], v[72:75], v[172:175], v[76:79]
    v_mfma_f32_16x16x32_bf16 v[80:83], v[172:175], v[172:175], v[80:83]
    s_waitcnt lgkmcnt(1)
    v_mfma_f32_16x16x32_bf16 v[76:79], v[72:75], v[176:179], v[76:79]
    v_mfma_f32_16x16x32_bf16 v[80:83], v[176:179], v[176:179], v[80:83]
    s_waitcnt lgkmcnt(0)
    v_mfma_f32_16x16x32_bf16 v[76:79], v[72:75], v[180:183], v[76:79]
    v_mfma_f32_16x16x32_bf16 v[80:83], v[180:183], v[180:183], v[80:83]
    s_nop 7
    v_cndmask_b32 v80, v80, v81, s[68:69]
    v_cndmask_b32 v82, v82, v83, s[68:69]
    v_cndmask_b32 v77, v80, v82, s[70:71]
    s_mov_b32 exec_lo, 0x00F0000F
    s_mov_b32 exec_hi, 0xF0000F00
    ds_write_b64 v214, v[76:77]
    s_mov_b64 exec, -1
    ds_write_b32 v215, v216
    s_cmp_eq_u32 s47, s43
    s_cbranch_scc1 L_e1
    s_add_u32 m0, s48, 0
    s_nop 0
    buffer_load_dwordx4 v240, s[12:15], s49 offen lds
    s_add_u32 m0, s48, 1024
    s_nop 0
    buffer_load_dwordx4 v241, s[12:15], s49 offen lds
    s_add_u32 m0, s48, 2048
    s_nop 0
    buffer_load_dwordx4 v242, s[12:15], s49 offen lds
    s_add_u32 m0, s48, 3072
    s_nop 0
    buffer_load_dwordx4 v243, s[12:15], s49 offen lds
    s_add_u32 m0, s48, 4096
    s_nop 0
    buffer_load_dwordx4 v244, s[12:15], s49 offen lds
    s_add_u32 s49, s49, 122880
    s_add_u32 s48, s48, 30720
L_e1:
    s_mov_b32 s78, 0
L_spin1:
    ds_read_b32 v219, v217 offset:0
    s_add_u32 s78, s78, 1
    s_cmp_gt_u32 s78, 0x40000
    s_cbranch_scc1 L_spind2
    s_waitcnt lgkmcnt(0)
    v_cmp_ne_u32 vcc, 1, v219
    s_nop 4
    s_cbranch_vccnz L_spin1
L_spind2:
L_e2:
    ds_read2_b64 v[76:79], v213 offset1:16
    s_waitcnt lgkmcnt(0)
    v_add_f32 v76, v76, v78
    v_add_f32 v77, v77, v79
    v_mul_f32 v76, 0x3acccccd, v76
    v_mul_f32 v77, 0x3acccccd, v77
    v_fma_f32 v77, -v76, v76, v77
    v_max_f32 v77, 0, v77
    v_add_f32 v77, 0x3727c5ac, v77
    v_rsq_f32 v78, v77
    s_mov_b32 s79, 0xffff0000
    v_mul_f32 v79, v76, v78
    v_lshlrev_b32 v80, 16, v144
    v_and_b32 v81, s79, v144
    v_lshlrev_b32 v82, 16, v145
    v_and_b32 v83, s79, v145
    v_lshlrev_b32 v84, 16, v146
    v_and_b32 v85, s79, v146
    v_lshlrev_b32 v86, 16, v147
    v_and_b32 v87, s79, v147
    v_mov_b32 v76, v78
    v_mov_b32 v77, v78
    v_mul_f32 v78, -1.0, v79
    v_mul_f32 v79, -1.0, v79
    v_pk_fma_f32 v[80:81], v[80:81], v[76:77], v[78:79]
    v_pk_fma_f32 v[82:83], v[82:83], v[76:77], v[78:79]
    v_pk_fma_f32 v[84:85], v[84:85], v[76:77], v[78:79]
    v_pk_fma_f32 v[86:87], v[86:87], v[76:77], v[78:79]
    v_cvt_pk_bf16_f32 v144, v80, v81
    v_cvt_pk_bf16_f32 v145, v82, v83
    v_cvt_pk_bf16_f32 v146, v84, v85
    v_cvt_pk_bf16_f32 v147, v86, v87
    v_lshlrev_b32 v80, 16, v148
    v_and_b32 v81, s79, v148
    v_lshlrev_b32 v82, 16, v149
    v_and_b32 v83, s79, v149
    v_lshlrev_b32 v84, 16, v150
    v_and_b32 v85, s79, v150
    v_lshlrev_b32 v86, 16, v151
    v_and_b32 v87, s79, v151
    v_pk_fma_f32 v[80:81], v[80:81], v[76:77], v[78:79]
    v_pk_fma_f32 v[82:83], v[82:83], v[76:77], v[78:79]
    v_pk_fma_f32 v[84:85], v[84:85], v[76:77], v[78:79]
    v_pk_fma_f32 v[86:87], v[86:87], v[76:77], v[78:79]
    v_cvt_pk_bf16_f32 v148, v80, v81
    v_cvt_pk_bf16_f32 v149, v82, v83
    v_cvt_pk_bf16_f32 v150, v84, v85
    v_cvt_pk_bf16_f32 v151, v86, v87
    v_lshlrev_b32 v80, 16, v152
    v_and_b32 v81, s79, v152
    v_lshlrev_b32 v82, 16, v153
    v_and_b32 v83, s79, v153
    v_lshlrev_b32 v84, 16, v154
    v_and_b32 v85, s79, v154
    v_lshlrev_b32 v86, 16, v155
    v_and_b32 v87, s79, v155
    v_pk_fma_f32 v[80:81], v[80:81], v[76:77], v[78:79]
    v_pk_fma_f32 v[82:83], v[82:83], v[76:77], v[78:79]
    v_pk_fma_f32 v[84:85], v[84:85], v[76:77], v[78:79]
    v_pk_fma_f32 v[86:87], v[86:87], v[76:77], v[78:79]
    v_cvt_pk_bf16_f32 v152, v80, v81
    v_cvt_pk_bf16_f32 v153, v82, v83
    v_cvt_pk_bf16_f32 v154, v84, v85
    v_cvt_pk_bf16_f32 v155, v86, v87
    v_lshlrev_b32 v80, 16, v156
    v_and_b32 v81, s79, v156
    v_lshlrev_b32 v82, 16, v157
    v_and_b32 v83, s79, v157
    v_lshlrev_b32 v84, 16, v158
    v_and_b32 v85, s79, v158
    v_lshlrev_b32 v86, 16, v159
    v_and_b32 v87, s79, v159
    v_pk_fma_f32 v[80:81], v[80:81], v[76:77], v[78:79]
    v_pk_fma_f32 v[82:83], v[82:83], v[76:77], v[78:79]
    v_pk_fma_f32 v[84:85], v[84:85], v[76:77], v[78:79]
    v_pk_fma_f32 v[86:87], v[86:87], v[76:77], v[78:79]
    v_cvt_pk_bf16_f32 v156, v80, v81
    v_cvt_pk_bf16_f32 v157, v82, v83
    v_cvt_pk_bf16_f32 v158, v84, v85
    v_cvt_pk_bf16_f32 v159, v86, v87
    v_lshlrev_b32 v80, 16, v160
    v_and_b32 v81, s79, v160
    v_lshlrev_b32 v82, 16, v161
    v_and_b32 v83, s79, v161
    v_lshlrev_b32 v84, 16, v162
    v_and_b32 v85, s79, v162
    v_lshlrev_b32 v86, 16, v163
    v_and_b32 v87, s79, v163
    v_pk_fma_f32 v[80:81], v[80:81], v[76:77], v[78:79]
    v_pk_fma_f32 v[82:83], v[82:83], v[76:77], v[78:79]
    v_pk_fma_f32 v[84:85], v[84:85], v[76:77], v[78:79]
    v_pk_fma_f32 v[86:87], v[86:87], v[76:77], v[78:79]
    v_cvt_pk_bf16_f32 v160, v80, v81
    v_cvt_pk_bf16_f32 v161, v82, v83
    v_cvt_pk_bf16_f32 v162, v84, v85
    v_cvt_pk_bf16_f32 v163, v86, v87
    v_lshlrev_b32 v80, 16, v164
    v_and_b32 v81, s79, v164
    v_lshlrev_b32 v82, 16, v165
    v_and_b32 v83, s79, v165
    v_lshlrev_b32 v84, 16, v166
    v_and_b32 v85, s79, v166
    v_lshlrev_b32 v86, 16, v167
    v_and_b32 v87, s79, v167
    v_pk_fma_f32 v[80:81], v[80:81], v[76:77], v[78:79]
    v_pk_fma_f32 v[82:83], v[82:83], v[76:77], v[78:79]
    v_pk_fma_f32 v[84:85], v[84:85], v[76:77], v[78:79]
    v_pk_fma_f32 v[86:87], v[86:87], v[76:77], v[78:79]
    v_cvt_pk_bf16_f32 v164, v80, v81
    v_cvt_pk_bf16_f32 v165, v82, v83
    v_cvt_pk_bf16_f32 v166, v84, v85
    v_cvt_pk_bf16_f32 v167, v86, v87
    v_lshlrev_b32 v80, 16, v168
    v_and_b32 v81, s79, v168
    v_lshlrev_b32 v82, 16, v169
    v_and_b32 v83, s79, v169
    v_lshlrev_b32 v84, 16, v170
    v_and_b32 v85, s79, v170
    v_lshlrev_b32 v86, 16, v171
    v_and_b32 v87, s79, v171
    v_pk_fma_f32 v[80:81], v[80:81], v[76:77], v[78:79]
    v_pk_fma_f32 v[82:83], v[82:83], v[76:77], v[78:79]
    v_pk_fma_f32 v[84:85], v[84:85], v[76:77], v[78:79]
    v_pk_fma_f32 v[86:87], v[86:87], v[76:77], v[78:79]
    v_cvt_pk_bf16_f32 v168, v80, v81
    v_cvt_pk_bf16_f32 v169, v82, v83
    v_cvt_pk_bf16_f32 v170, v84, v85
    v_cvt_pk_bf16_f32 v171, v86, v87
    v_lshlrev_b32 v80, 16, v172
    v_and_b32 v81, s79, v172
    v_lshlrev_b32 v82, 16, v173
    v_and_b32 v83, s79, v173
    v_lshlrev_b32 v84, 16, v174
    v_and_b32 v85, s79, v174
    v_lshlrev_b32 v86, 16, v175
    v_and_b32 v87, s79, v175
    v_pk_fma_f32 v[80:81], v[80:81], v[76:77], v[78:79]
    v_pk_fma_f32 v[82:83], v[82:83], v[76:77], v[78:79]
    v_pk_fma_f32 v[84:85], v[84:85], v[76:77], v[78:79]
    v_pk_fma_f32 v[86:87], v[86:87], v[76:77], v[78:79]
    v_cvt_pk_bf16_f32 v172, v80, v81
    v_cvt_pk_bf16_f32 v173, v82, v83
    v_cvt_pk_bf16_f32 v174, v84, v85
    v_cvt_pk_bf16_f32 v175, v86, v87
    v_lshlrev_b32 v80, 16, v176
    v_and_b32 v81, s79, v176
    v_lshlrev_b32 v82, 16, v177
    v_and_b32 v83, s79, v177
    v_lshlrev_b32 v84, 16, v178
    v_and_b32 v85, s79, v178
    v_lshlrev_b32 v86, 16, v179
    v_and_b32 v87, s79, v179
    v_pk_fma_f32 v[80:81], v[80:81], v[76:77], v[78:79]
    v_pk_fma_f32 v[82:83], v[82:83], v[76:77], v[78:79]
    v_pk_fma_f32 v[84:85], v[84:85], v[76:77], v[78:79]
    v_pk_fma_f32 v[86:87], v[86:87], v[76:77], v[78:79]
    v_cvt_pk_bf16_f32 v176, v80, v81
    v_cvt_pk_bf16_f32 v177, v82, v83
    v_cvt_pk_bf16_f32 v178, v84, v85
    v_cvt_pk_bf16_f32 v179, v86, v87
    v_lshlrev_b32 v80, 16, v180
    v_and_b32 v81, s79, v180
    v_lshlrev_b32 v82, 16, v181
    v_and_b32 v83, s79, v181
    v_lshlrev_b32 v84, 16, v182
    v_and_b32 v85, s79, v182
    v_lshlrev_b32 v86, 16, v183
    v_and_b32 v87, s79, v183
    v_pk_fma_f32 v[80:81], v[80:81], v[76:77], v[78:79]
    v_pk_fma_f32 v[82:83], v[82:83], v[76:77], v[78:79]
    v_pk_fma_f32 v[84:85], v[84:85], v[76:77], v[78:79]
    v_pk_fma_f32 v[86:87], v[86:87], v[76:77], v[78:79]
    v_cvt_pk_bf16_f32 v180, v80, v81
    v_cvt_pk_bf16_f32 v181, v82, v83
    v_cvt_pk_bf16_f32 v182, v84, v85
    v_cvt_pk_bf16_f32 v183, v86, v87
    s_cmp_lg_u32 s47, s43
    s_cbranch_scc1 L_f1
L_n1:
    v_bfe_u32 v209, v245, 2, 2
    v_and_b32 v211, 3, v245
    v_lshl_add_u32 v219, v210, 3, v209
    v_mul_u32_u24 v219, 40, v219
    v_lshl_add_u32 v219, v211, 3, v219
    s_mul_i32 s78, s44, 12800
    s_add_u32 s78, s78, 102400
    v_add_u32 v219, s78, v219
    v_and_b32 v211, 1, v210
    v_add_u32 v204, 158720, v246
    s_waitcnt vmcnt(0)
    ds_read_b64_tr_b16 v[32:33], v219 offset:0
    ds_read_b64_tr_b16 v[34:35], v219 offset:160
    ds_read_b64_tr_b16 v[36:37], v219 offset:32
    ds_read_b64_tr_b16 v[38:39], v219 offset:192
    ds_read_b64_tr_b16 v[40:41], v219 offset:1280
    ds_read_b64_tr_b16 v[42:43], v219 offset:1440
    ds_read_b64_tr_b16 v[44:45], v219 offset:1312
    ds_read_b64_tr_b16 v[46:47], v219 offset:1472
    ds_read_b64_tr_b16 v[48:49], v219 offset:2560
    ds_read_b64_tr_b16 v[50:51], v219 offset:2720
    ds_read_b64_tr_b16 v[52:53], v219 offset:2592
    ds_read_b64_tr_b16 v[54:55], v219 offset:2752
    ds_read_b64_tr_b16 v[56:57], v219 offset:3840
    ds_read_b64_tr_b16 v[58:59], v219 offset:4000
    ds_read_b64_tr_b16 v[60:61], v219 offset:3872
    ds_read_b64_tr_b16 v[62:63], v219 offset:4032
    s_cmp_ge_u32 s7, 4
    s_cbranch_scc1 L_g1
    s_waitcnt lgkmcnt(12)
    v_mfma_f32_16x16x32_bf16 v[184:187], v[32:35], v[144:147], 0
    v_mfma_f32_16x16x32_bf16 v[188:191], v[36:39], v[144:147], 0
    ds_read_b64_tr_b16 v[64:65], v219 offset:5120
    ds_read_b64_tr_b16 v[66:67], v219 offset:5280
    ds_read_b64_tr_b16 v[68:69], v219 offset:5152
    ds_read_b64_tr_b16 v[70:71], v219 offset:5312
    s_waitcnt lgkmcnt(12)
    v_mfma_f32_16x16x32_bf16 v[184:187], v[40:43], v[148:151], v[184:187]
    v_mfma_f32_16x16x32_bf16 v[188:191], v[44:47], v[148:151], v[188:191]
    ds_read_b64_tr_b16 v[72:73], v219 offset:6400
    ds_read_b64_tr_b16 v[74:75], v219 offset:6560
    ds_read_b64_tr_b16 v[76:77], v219 offset:6432
    ds_read_b64_tr_b16 v[78:79], v219 offset:6592
    s_waitcnt lgkmcnt(12)
    v_mfma_f32_16x16x32_bf16 v[184:187], v[48:51], v[152:155], v[184:187]
    v_mfma_f32_16x16x32_bf16 v[188:191], v[52:55], v[152:155], v[188:191]
    ds_read_b64_tr_b16 v[80:81], v219 offset:7680
    ds_read_b64_tr_b16 v[82:83], v219 offset:7840
    ds_read_b64_tr_b16 v[84:85], v219 offset:7712
    ds_read_b64_tr_b16 v[86:87], v219 offset:7872
    s_waitcnt lgkmcnt(12)
    v_mfma_f32_16x16x32_bf16 v[184:187], v[56:59], v[156:159], v[184:187]
    v_mfma_f32_16x16x32_bf16 v[188:191], v[60:63], v[156:159], v[188:191]
    ds_read_b64_tr_b16 v[88:89], v219 offset:8960
    ds_read_b64_tr_b16 v[90:91], v219 offset:9120
    ds_read_b64_tr_b16 v[92:93], v219 offset:8992
    ds_read_b64_tr_b16 v[94:95], v219 offset:9152
    s_waitcnt lgkmcnt(12)
    v_mfma_f32_16x16x32_bf16 v[184:187], v[64:67], v[160:163], v[184:187]
    v_mfma_f32_16x16x32_bf16 v[188:191], v[68:71], v[160:163], v[188:191]
    ds_read_b64_tr_b16 v[32:33], v219 offset:10240
    ds_read_b64_tr_b16 v[34:35], v219 offset:10400
    ds_read_b64_tr_b16 v[36:37], v219 offset:10272
    ds_read_b64_tr_b16 v[38:39], v219 offset:10432
    s_waitcnt lgkmcnt(12)
    v_mfma_f32_16x16x32_bf16 v[184:187], v[72:75], v[164:167], v[184:187]
    v_mfma_f32_16x16x32_bf16 v[188:191], v[76:79], v[164:167], v[188:191]
    ds_read_b64_tr_b16 v[40:41], v219 offset:11520
    ds_read_b64_tr_b16 v[42:43], v219 offset:11680
    ds_read_b64_tr_b16 v[44:45], v219 offset:11552
    ds_read_b64_tr_b16 v[46:47], v219 offset:11712
    s_waitcnt lgkmcnt(12)
    v_mfma_f32_16x16x32_bf16 v[184:187], v[80:83], v[168:171], v[184:187]
    v_mfma_f32_16x16x32_bf16 v[188:191], v[84:87], v[168:171], v[188:191]
    s_waitcnt lgkmcnt(8)
    v_mfma_f32_16x16x32_bf16 v[184:187], v[88:91], v[172:175], v[184:187]
    v_mfma_f32_16x16x32_bf16 v[188:191], v[92:95], v[172:175], v[188:191]
    s_waitcnt lgkmcnt(4)
    v_mfma_f32_16x16x32_bf16 v[184:187], v[32:35], v[176:179], v[184:187]
    v_mfma_f32_16x16x32_bf16 v[188:191], v[36:39], v[176:179], v[188:191]
    s_waitcnt lgkmcnt(0)
    v_mfma_f32_16x16x32_bf16 v[184:187], v[40:43], v[180:183], v[184:187]
    v_mfma_f32_16x16x32_bf16 v[188:191], v[44:47], v[180:183], v[188:191]
    v_lshlrev_b32 v200, 8, v222
    v_lshl_add_u32 v200, v212, 4, v200
    v_lshl_add_u32 v200, v211, 3, v200
    v_add_u32 v200, 162048, v200
    v_lshlrev_b32 v201, 3, v212
    v_add_u32 v201, 162560, v201
    s_mov_b64 s[52:53], 0xffff
    s_branch L_g2
L_g1:
    s_waitcnt lgkmcnt(12)
    v_mfma_f32_16x16x32_bf16 v[184:187], v[144:147], v[32:35], 0
    v_mfma_f32_16x16x32_bf16 v[188:191], v[144:147], v[36:39], 0
    ds_read_b64_tr_b16 v[64:65], v219 offset:5120
    ds_read_b64_tr_b16 v[66:67], v219 offset:5280
    ds_read_b64_tr_b16 v[68:69], v219 offset:5152
    ds_read_b64_tr_b16 v[70:71], v219 offset:5312
    s_waitcnt lgkmcnt(12)
    v_mfma_f32_16x16x32_bf16 v[184:187], v[148:151], v[40:43], v[184:187]
    v_mfma_f32_16x16x32_bf16 v[188:191], v[148:151], v[44:47], v[188:191]
    ds_read_b64_tr_b16 v[72:73], v219 offset:6400
    ds_read_b64_tr_b16 v[74:75], v219 offset:6560
    ds_read_b64_tr_b16 v[76:77], v219 offset:6432
    ds_read_b64_tr_b16 v[78:79], v219 offset:6592
    s_waitcnt lgkmcnt(12)
    v_mfma_f32_16x16x32_bf16 v[184:187], v[152:155], v[48:51], v[184:187]
    v_mfma_f32_16x16x32_bf16 v[188:191], v[152:155], v[52:55], v[188:191]
    ds_read_b64_tr_b16 v[80:81], v219 offset:7680
    ds_read_b64_tr_b16 v[82:83], v219 offset:7840
    ds_read_b64_tr_b16 v[84:85], v219 offset:7712
    ds_read_b64_tr_b16 v[86:87], v219 offset:7872
    s_waitcnt lgkmcnt(12)
    v_mfma_f32_16x16x32_bf16 v[184:187], v[156:159], v[56:59], v[184:187]
    v_mfma_f32_16x16x32_bf16 v[188:191], v[156:159], v[60:63], v[188:191]
    ds_read_b64_tr_b16 v[88:89], v219 offset:8960
    ds_read_b64_tr_b16 v[90:91], v219 offset:9120
    ds_read_b64_tr_b16 v[92:93], v219 offset:8992
    ds_read_b64_tr_b16 v[94:95], v219 offset:9152
    s_waitcnt lgkmcnt(12)
    v_mfma_f32_16x16x32_bf16 v[184:187], v[160:163], v[64:67], v[184:187]
    v_mfma_f32_16x16x32_bf16 v[188:191], v[160:163], v[68:71], v[188:191]
    ds_read_b64_tr_b16 v[32:33], v219 offset:10240
    ds_read_b64_tr_b16 v[34:35], v219 offset:10400
    ds_read_b64_tr_b16 v[36:37], v219 offset:10272
    ds_read_b64_tr_b16 v[38:39], v219 offset:10432
    s_waitcnt lgkmcnt(12)
    v_mfma_f32_16x16x32_bf16 v[184:187], v[164:167], v[72:75], v[184:187]
    v_mfma_f32_16x16x32_bf16 v[188:191], v[164:167], v[76:79], v[188:191]
    ds_read_b64_tr_b16 v[40:41], v219 offset:11520
    ds_read_b64_tr_b16 v[42:43], v219 offset:11680
    ds_read_b64_tr_b16 v[44:45], v219 offset:11552
    ds_read_b64_tr_b16 v[46:47], v219 offset:11712
    s_waitcnt lgkmcnt(12)
    v_mfma_f32_16x16x32_bf16 v[184:187], v[168:171], v[80:83], v[184:187]
    v_mfma_f32_16x16x32_bf16 v[188:191], v[168:171], v[84:87], v[188:191]
    s_waitcnt lgkmcnt(8)
    v_mfma_f32_16x16x32_bf16 v[184:187], v[172:175], v[88:91], v[184:187]
    v_mfma_f32_16x16x32_bf16 v[188:191], v[172:175], v[92:95], v[188:191]
    s_waitcnt lgkmcnt(4)
    v_mfma_f32_16x16x32_bf16 v[184:187], v[176:179], v[32:35], v[184:187]
    v_mfma_f32_16x16x32_bf16 v[188:191], v[176:179], v[36:39], v[188:191]
    s_waitcnt lgkmcnt(0)
    v_mfma_f32_16x16x32_bf16 v[184:187], v[180:183], v[40:43], v[184:187]
    v_mfma_f32_16x16x32_bf16 v[188:191], v[180:183], v[44:47], v[188:191]
    v_mul_u32_u24 v200, 320, v222
    v_lshl_add_u32 v200, v212, 4, v200
    v_lshl_add_u32 v200, v211, 3, v200
    v_add_u32 v200, 162048, v200
    v_add_u32 v201, 256, v200
    s_mov_b32 s52, 0x000f000f
    s_mov_b32 s53, 0x000f000f
L_g2:
    s_cmp_eq_u32 s44, 0
    s_cbranch_scc1 L_g3
    ds_write_b128 v204, v[184:187]
    ds_write_b128 v204, v[188:191] offset:1024
    ds_write_b32 v215, v216 offset:32
    s_branch L_f3
L_g3:
    s_mov_b32 s78, 0
L_spin3:
    ds_read_b32 v219, v217 offset:32
    s_add_u32 s78, s78, 1
    s_cmp_gt_u32 s78, 0x40000
    s_cbranch_scc1 L_spind4
    s_waitcnt lgkmcnt(0)
    v_cmp_ne_u32 vcc, 1, v219
    s_nop 4
    s_cbranch_vccnz L_spin3
L_spind4:
    ds_read_b128 v[192:195], v204
    ds_read_b128 v[196:199], v204 offset:1024
    s_waitcnt lgkmcnt(0)
    v_add_f32 v184, v184, v192
    v_add_f32 v185, v185, v193
    v_add_f32 v186, v186, v194
    v_add_f32 v187, v187, v195
    v_add_f32 v188, v188, v196
    v_add_f32 v189, v189, v197
    v_add_f32 v190, v190, v198
    v_add_f32 v191, v191, v199
    v_cvt_pk_bf16_f32 v192, v184, v185
    v_cvt_pk_bf16_f32 v193, v186, v187
    v_cvt_pk_bf16_f32 v194, v188, v189
    v_cvt_pk_bf16_f32 v195, v190, v191
    ds_write_b64 v200, v[192:193]
    s_mov_b64 exec, s[52:53]
    ds_write_b64 v201, v[194:195]
    s_mov_b32 exec_lo, -1
    s_mov_b32 exec_hi, 0xff
    ds_read_b128 v[132:135], v204 offset:3328
    s_waitcnt lgkmcnt(0)
    buffer_store_dwordx4 v[132:135], v246, s[36:39], s50 offen sc1
    s_mov_b64 exec, -1
    v_mov_b32 v130, s40
    v_mov_b32 v131, s41
    s_mov_b64 exec, 1
    s_waitcnt vmcnt(0)
    buffer_store_dwordx2 v[130:131], off, s[36:39], s75 sc1
    s_mov_b64 exec, -1
L_f3:
    s_branch L_f2
L_f1:
    v_and_b32 v217, 7, v245
    v_lshlrev_b32 v217, 2, v217
    v_add_u32 v217, 161792, v217
    s_mov_b32 s78, 0
L_spin5:
    ds_read_b32 v219, v217 offset:0
    s_add_u32 s78, s78, 1
    s_cmp_gt_u32 s78, 0x40000
    s_cbranch_scc1 L_spind6
    s_waitcnt lgkmcnt(0)
    v_cmp_ne_u32 vcc, 1, v219
    s_nop 4
    s_cbranch_vccnz L_spin5
L_spind6:
    s_add_u32 m0, s48, 0
    s_nop 0
    buffer_load_dwordx4 v240, s[12:15], s49 offen lds
    s_add_u32 m0, s48, 1024
    s_nop 0
    buffer_load_dwordx4 v241, s[12:15], s49 offen lds
    s_add_u32 m0, s48, 2048
    s_nop 0
    buffer_load_dwordx4 v242, s[12:15], s49 offen lds
    s_add_u32 m0, s48, 3072
    s_nop 0
    buffer_load_dwordx4 v243, s[12:15], s49 offen lds
    s_add_u32 m0, s48, 4096
    s_nop 0
    buffer_load_dwordx4 v244, s[12:15], s49 offen lds
    s_add_u32 s49, s49, 122880
    s_add_u32 s48, s48, 30720
    s_waitcnt vmcnt(5)
L_f2:
    s_setprio 0
    s_cmp_lt_u32 s3, 4
    s_cbranch_scc1 L_f4
    s_setprio 1
    s_branch L_f5
L_f4:
    buffer_load_dwordx4 v[230:233], v250, s[8:11], s63 offen
    buffer_load_dwordx2 v[234:235], v251, s[8:11], s63 offen offset:64
    buffer_load_dwordx4 v[236:239], v250, s[8:11], s63 offen offset:96
L_f5:
    s_barrier
    ds_read_b64_tr_b16 v[32:33], v218 offset:0
    ds_read_b64_tr_b16 v[34:35], v218 offset:2560
    ds_read_b64_tr_b16 v[36:37], v218 offset:32
    ds_read_b64_tr_b16 v[38:39], v218 offset:2592
    ds_read_b64_tr_b16 v[40:41], v218 offset:64
    ds_read_b64_tr_b16 v[42:43], v218 offset:2624
    ds_read_b64_tr_b16 v[44:45], v218 offset:96
    ds_read_b64_tr_b16 v[46:47], v218 offset:2656
    ds_read_b64_tr_b16 v[48:49], v218 offset:128
    ds_read_b64_tr_b16 v[50:51], v218 offset:2688
    ds_read_b64_tr_b16 v[52:53], v218 offset:10240
    ds_read_b64_tr_b16 v[54:55], v218 offset:12800
    s_waitcnt lgkmcnt(10)
    v_mfma_f32_16x16x32_bf16 v[184:187], v[32:35], v[144:147], 0
    ds_read_b64_tr_b16 v[56:57], v218 offset:10272
    ds_read_b64_tr_b16 v[58:59], v218 offset:12832
    s_waitcnt lgkmcnt(10)
    v_mfma_f32_16x16x32_bf16 v[188:191], v[36:39], v[144:147], 0
    ds_read_b64_tr_b16 v[60:61], v218 offset:10304
    ds_read_b64_tr_b16 v[62:63], v218 offset:12864
    s_waitcnt lgkmcnt(10)
    v_mfma_f32_16x16x32_bf16 v[192:195], v[40:43], v[144:147], 0
    ds_read_b64_tr_b16 v[64:65], v218 offset:10336
    ds_read_b64_tr_b16 v[66:67], v218 offset:12896
    s_waitcnt lgkmcnt(10)
    v_mfma_f32_16x16x32_bf16 v[196:199], v[44:47], v[144:147], 0
    ds_read_b64_tr_b16 v[68:69], v218 offset:10368
    ds_read_b64_tr_b16 v[70:71], v218 offset:12928
    s_waitcnt lgkmcnt(10)
    v_mfma_f32_16x16x32_bf16 v[200:203], v[48:51], v[144:147], 0
    s_add_u32 m0, s48, 0
    s_nop 0
    buffer_load_dwordx4 v240, s[12:15], s49 offen lds
    s_add_u32 m0, s48, 1024
    s_nop 0
    buffer_load_dwordx4 v241, s[12:15], s49 offen lds
    s_add_u32 m0, s48, 2048
    s_nop 0
    buffer_load_dwordx4 v242, s[12:15], s49 offen lds
    s_add_u32 m0, s48, 3072
    s_nop 0
    buffer_load_dwordx4 v243, s[12:15], s49 offen lds
    s_add_u32 m0, s48, 4096
    s_nop 0
    buffer_load_dwordx4 v244, s[12:15], s49 offen lds
    s_add_u32 s49, s49, 122880
    s_add_u32 s48, s48, 30720
    ds_read_b64_tr_b16 v[32:33], v218 offset:20480
    ds_read_b64_tr_b16 v[34:35], v218 offset:23040
    s_waitcnt lgkmcnt(10)
    v_mfma_f32_16x16x32_bf16 v[184:187], v[52:55], v[148:151], v[184:187]
    ds_read_b64_tr_b16 v[36:37], v218 offset:20512
    ds_read_b64_tr_b16 v[38:39], v218 offset:23072
    s_waitcnt lgkmcnt(10)
    v_mfma_f32_16x16x32_bf16 v[188:191], v[56:59], v[148:151], v[188:191]
    ds_read_b64_tr_b16 v[40:41], v218 offset:20544
    ds_read_b64_tr_b16 v[42:43], v218 offset:23104
    s_waitcnt lgkmcnt(10)
    v_mfma_f32_16x16x32_bf16 v[192:195], v[60:63], v[148:151], v[192:195]
    ds_read_b64_tr_b16 v[44:45], v218 offset:20576
    ds_read_b64_tr_b16 v[46:47], v218 offset:23136
    s_waitcnt lgkmcnt(10)
    v_mfma_f32_16x16x32_bf16 v[196:199], v[64:67], v[148:151], v[196:199]
    ds_read_b64_tr_b16 v[48:49], v218 offset:20608
    ds_read_b64_tr_b16 v[50:51], v218 offset:23168
    s_waitcnt lgkmcnt(10)
    v_mfma_f32_16x16x32_bf16 v[200:203], v[68:71], v[148:151], v[200:203]
    s_waitcnt lgkmcnt(8)
    v_mfma_f32_16x16x32_bf16 v[184:187], v[32:35], v[152:155], v[184:187]
    s_waitcnt lgkmcnt(6)
    v_mfma_f32_16x16x32_bf16 v[188:191], v[36:39], v[152:155], v[188:191]
    s_waitcnt lgkmcnt(4)
    v_mfma_f32_16x16x32_bf16 v[192:195], v[40:43], v[152:155], v[192:195]
    s_waitcnt lgkmcnt(2)
    v_mfma_f32_16x16x32_bf16 v[196:199], v[44:47], v[152:155], v[196:199]
    s_waitcnt lgkmcnt(0)
    v_mfma_f32_16x16x32_bf16 v[200:203], v[48:51], v[152:155], v[200:203]
    s_waitcnt vmcnt(5)
    s_barrier
    ds_read_b64_tr_b16 v[52:53], v218 offset:30720
    ds_read_b64_tr_b16 v[54:55], v218 offset:33280
    ds_read_b64_tr_b16 v[56:57], v218 offset:30752
    ds_read_b64_tr_b16 v[58:59], v218 offset:33312
    ds_read_b64_tr_b16 v[60:61], v218 offset:30784
    ds_read_b64_tr_b16 v[62:63], v218 offset:33344
    ds_read_b64_tr_b16 v[64:65], v218 offset:30816
    ds_read_b64_tr_b16 v[66:67], v218 offset:33376
    ds_read_b64_tr_b16 v[68:69], v218 offset:30848
    ds_read_b64_tr_b16 v[70:71], v218 offset:33408
    ds_read_b64_tr_b16 v[32:33], v218 offset:40960
    ds_read_b64_tr_b16 v[34:35], v218 offset:43520
    s_waitcnt lgkmcnt(10)
    v_mfma_f32_16x16x32_bf16 v[184:187], v[52:55], v[156:159], v[184:187]
    ds_read_b64_tr_b16 v[36:37], v218 offset:40992
    ds_read_b64_tr_b16 v[38:39], v218 offset:43552
    s_waitcnt lgkmcnt(10)
    v_mfma_f32_16x16x32_bf16 v[188:191], v[56:59], v[156:159], v[188:191]
    ds_read_b64_tr_b16 v[40:41], v218 offset:41024
    ds_read_b64_tr_b16 v[42:43], v218 offset:43584
    s_waitcnt lgkmcnt(10)
    v_mfma_f32_16x16x32_bf16 v[192:195], v[60:63], v[156:159], v[192:195]
    ds_read_b64_tr_b16 v[44:45], v218 offset:41056
    ds_read_b64_tr_b16 v[46:47], v218 offset:43616
    s_waitcnt lgkmcnt(10)
    v_mfma_f32_16x16x32_bf16 v[196:199], v[64:67], v[156:159], v[196:199]
    ds_read_b64_tr_b16 v[48:49], v218 offset:41088
    ds_read_b64_tr_b16 v[50:51], v218 offset:43648
    s_waitcnt lgkmcnt(10)
    v_mfma_f32_16x16x32_bf16 v[200:203], v[68:71], v[156:159], v[200:203]
    ds_read_b64_tr_b16 v[52:53], v218 offset:51200
    ds_read_b64_tr_b16 v[54:55], v218 offset:53760
    s_waitcnt lgkmcnt(10)
    v_mfma_f32_16x16x32_bf16 v[184:187], v[32:35], v[160:163], v[184:187]
    ds_read_b64_tr_b16 v[56:57], v218 offset:51232
    ds_read_b64_tr_b16 v[58:59], v218 offset:53792
    s_waitcnt lgkmcnt(10)
    v_mfma_f32_16x16x32_bf16 v[188:191], v[36:39], v[160:163], v[188:191]
    ds_read_b64_tr_b16 v[60:61], v218 offset:51264
    ds_read_b64_tr_b16 v[62:63], v218 offset:53824
    s_waitcnt lgkmcnt(10)
    v_mfma_f32_16x16x32_bf16 v[192:195], v[40:43], v[160:163], v[192:195]
    ds_read_b64_tr_b16 v[64:65], v218 offset:51296
    ds_read_b64_tr_b16 v[66:67], v218 offset:53856
    s_waitcnt lgkmcnt(10)
    v_mfma_f32_16x16x32_bf16 v[196:199], v[44:47], v[160:163], v[196:199]
    ds_read_b64_tr_b16 v[68:69], v218 offset:51328
    ds_read_b64_tr_b16 v[70:71], v218 offset:53888
    s_waitcnt lgkmcnt(10)
    v_mfma_f32_16x16x32_bf16 v[200:203], v[48:51], v[160:163], v[200:203]
    s_cmp_lt_u32 s3, 4
    s_cbranch_scc1 L_h1
    buffer_load_dwordx2 v[234:235], v248, s[36:39], 0 offen sc1
L_h1:
    s_waitcnt lgkmcnt(8)
    v_mfma_f32_16x16x32_bf16 v[184:187], v[52:55], v[164:167], v[184:187]
    s_waitcnt lgkmcnt(6)
    v_mfma_f32_16x16x32_bf16 v[188:191], v[56:59], v[164:167], v[188:191]
    s_waitcnt lgkmcnt(4)
    v_mfma_f32_16x16x32_bf16 v[192:195], v[60:63], v[164:167], v[192:195]
    s_waitcnt lgkmcnt(2)
    v_mfma_f32_16x16x32_bf16 v[196:199], v[64:67], v[164:167], v[196:199]
    s_waitcnt lgkmcnt(0)
    v_mfma_f32_16x16x32_bf16 v[200:203], v[68:71], v[164:167], v[200:203]
    s_waitcnt vmcnt(1)
    s_cmp_ge_u32 s3, 4
    s_cbranch_scc1 L_k2
    s_waitcnt vmcnt(0)
L_k2:
    s_barrier
    ds_read_b64_tr_b16 v[32:33], v205 offset:0
    ds_read_b64_tr_b16 v[34:35], v205 offset:2560
    ds_read_b64_tr_b16 v[36:37], v205 offset:32
    ds_read_b64_tr_b16 v[38:39], v205 offset:2592
    ds_read_b64_tr_b16 v[40:41], v205 offset:64
    ds_read_b64_tr_b16 v[42:43], v205 offset:2624
    ds_read_b64_tr_b16 v[44:45], v205 offset:96
    ds_read_b64_tr_b16 v[46:47], v205 offset:2656
    ds_read_b64_tr_b16 v[48:49], v205 offset:128
    ds_read_b64_tr_b16 v[50:51], v205 offset:2688
    ds_read_b64_tr_b16 v[52:53], v205 offset:10240
    ds_read_b64_tr_b16 v[54:55], v205 offset:12800
    s_waitcnt lgkmcnt(10)
    v_mfma_f32_16x16x32_bf16 v[184:187], v[32:35], v[168:171], v[184:187]
    ds_read_b64_tr_b16 v[56:57], v205 offset:10272
    ds_read_b64_tr_b16 v[58:59], v205 offset:12832
    s_waitcnt lgkmcnt(10)
    v_mfma_f32_16x16x32_bf16 v[188:191], v[36:39], v[168:171], v[188:191]
    ds_read_b64_tr_b16 v[60:61], v205 offset:10304
    ds_read_b64_tr_b16 v[62:63], v205 offset:12864
    s_waitcnt lgkmcnt(10)
    v_mfma_f32_16x16x32_bf16 v[192:195], v[40:43], v[168:171], v[192:195]
    ds_read_b64_tr_b16 v[64:65], v205 offset:10336
    ds_read_b64_tr_b16 v[66:67], v205 offset:12896
    s_waitcnt lgkmcnt(10)
    v_mfma_f32_16x16x32_bf16 v[196:199], v[44:47], v[168:171], v[196:199]
    ds_read_b64_tr_b16 v[68:69], v205 offset:10368
    ds_read_b64_tr_b16 v[70:71], v205 offset:12928
    s_waitcnt lgkmcnt(10)
    v_mfma_f32_16x16x32_bf16 v[200:203], v[48:51], v[168:171], v[200:203]
    ds_read_b64_tr_b16 v[32:33], v205 offset:20480
    ds_read_b64_tr_b16 v[34:35], v205 offset:23040
    s_waitcnt lgkmcnt(10)
    v_mfma_f32_16x16x32_bf16 v[184:187], v[52:55], v[172:175], v[184:187]
    ds_read_b64_tr_b16 v[36:37], v205 offset:20512
    ds_read_b64_tr_b16 v[38:39], v205 offset:23072
    s_waitcnt lgkmcnt(10)
    v_mfma_f32_16x16x32_bf16 v[188:191], v[56:59], v[172:175], v[188:191]
    ds_read_b64_tr_b16 v[40:41], v205 offset:20544
    ds_read_b64_tr_b16 v[42:43], v205 offset:23104
    s_waitcnt lgkmcnt(10)
    v_mfma_f32_16x16x32_bf16 v[192:195], v[60:63], v[172:175], v[192:195]
    ds_read_b64_tr_b16 v[44:45], v205 offset:20576
    ds_read_b64_tr_b16 v[46:47], v205 offset:23136
    s_waitcnt lgkmcnt(10)
    v_mfma_f32_16x16x32_bf16 v[196:199], v[64:67], v[172:175], v[196:199]
    ds_read_b64_tr_b16 v[48:49], v205 offset:20608
    ds_read_b64_tr_b16 v[50:51], v205 offset:23168
    s_waitcnt lgkmcnt(10)
    v_mfma_f32_16x16x32_bf16 v[200:203], v[68:71], v[172:175], v[200:203]
    s_cmp_lt_u32 s3, 4
    s_cbranch_scc1 L_k0
    s_waitcnt vmcnt(0)
    v_cmp_ne_u32 vcc, s40, v234
    s_nop 4
    s_cbranch_vccnz L_k1
    s_add_u32 m0, s64, 0
    s_nop 0
    buffer_load_dwordx4 v246, s[36:39], s63 offen offset:0 sc1 lds
    buffer_load_dwordx4 v246, s[36:39], s63 offen offset:1024 sc1 lds
    buffer_load_dwordx4 v246, s[36:39], s63 offen offset:2048 sc1 lds
    buffer_load_dwordx4 v246, s[36:39], s63 offen offset:3072 sc1 lds
    s_add_u32 s63, s63, 4096
    s_add_u32 m0, s64, 4096
    s_nop 0
    buffer_load_dwordx4 v246, s[36:39], s63 offen offset:0 sc1 lds
    buffer_load_dword v236, v232, s[36:39], 0 offen sc1
    s_mov_b32 s54, 1
    s_add_u32 s78, s65, 0
    s_mov_b64 exec, s[72:73]
    buffer_load_dword v254, v253, s[24:27], s78 offen
    s_mov_b64 exec, -1
L_k0:
L_k1:
    ds_read_b64_tr_b16 v[52:53], v205 offset:30720
    ds_read_b64_tr_b16 v[54:55], v205 offset:33280
    s_waitcnt lgkmcnt(10)
    v_mfma_f32_16x16x32_bf16 v[184:187], v[32:35], v[176:179], v[184:187]
    ds_read_b64_tr_b16 v[56:57], v205 offset:30752
    ds_read_b64_tr_b16 v[58:59], v205 offset:33312
    s_waitcnt lgkmcnt(10)
    v_mfma_f32_16x16x32_bf16 v[188:191], v[36:39], v[176:179], v[188:191]
    ds_read_b64_tr_b16 v[60:61], v205 offset:30784
    ds_read_b64_tr_b16 v[62:63], v205 offset:33344
    s_waitcnt lgkmcnt(10)
    v_mfma_f32_16x16x32_bf16 v[192:195], v[40:43], v[176:179], v[192:195]
    ds_read_b64_tr_b16 v[64:65], v205 offset:30816
    ds_read_b64_tr_b16 v[66:67], v205 offset:33376
    s_waitcnt lgkmcnt(10)
    v_mfma_f32_16x16x32_bf16 v[196:199], v[44:47], v[176:179], v[196:199]
    ds_read_b64_tr_b16 v[68:69], v205 offset:30848
    ds_read_b64_tr_b16 v[70:71], v205 offset:33408
    s_waitcnt lgkmcnt(10)
    v_mfma_f32_16x16x32_bf16 v[200:203], v[48:51], v[176:179], v[200:203]
    s_cmp_ge_u32 s3, 4
    s_cbranch_scc1 L_k5
    buffer_load_dwordx2 v[254:255], v248, s[36:39], 0 offen sc1
L_k5:
    s_waitcnt lgkmcnt(8)
    v_mfma_f32_16x16x32_bf16 v[184:187], v[52:55], v[180:183], v[184:187]
    s_waitcnt lgkmcnt(6)
    v_mfma_f32_16x16x32_bf16 v[188:191], v[56:59], v[180:183], v[188:191]
    s_waitcnt lgkmcnt(4)
    v_mfma_f32_16x16x32_bf16 v[192:195], v[60:63], v[180:183], v[192:195]
    s_waitcnt lgkmcnt(2)
    v_mfma_f32_16x16x32_bf16 v[196:199], v[64:67], v[180:183], v[196:199]
    s_waitcnt lgkmcnt(0)
    v_mfma_f32_16x16x32_bf16 v[200:203], v[68:71], v[180:183], v[200:203]
    ds_write_b128 v206, v[184:187] offset:0
    s_nop 0
    ds_write_b128 v206, v[188:191] offset:64
    s_nop 0
    ds_write_b128 v206, v[192:195] offset:128
    s_nop 0
    ds_write_b128 v206, v[196:199] offset:192
    s_nop 0
    ds_write_b128 v206, v[200:203] offset:256
    s_waitcnt lgkmcnt(0)
    s_barrier
    s_cmp_ge_u32 s3, 4
    s_cbranch_scc1 L_loader
    s_setprio 1
    ds_read_b128 v[144:147], v224 offset:0
    ds_read_b128 v[148:151], v224 offset:16
    ds_read_b128 v[152:155], v223 offset:64
    ds_read_b128 v[156:159], v224 offset:21504
    ds_read_b128 v[160:163], v224 offset:21520
    ds_read_b128 v[164:167], v223 offset:21568
    ds_read_b128 v[168:171], v224 offset:10752
    ds_read_b128 v[172:175], v224 offset:10768
    ds_read_b128 v[176:179], v223 offset:10816
    ds_read_b128 v[180:183], v224 offset:32256
    ds_read_b128 v[184:187], v224 offset:32272
    ds_read_b128 v[188:191], v223 offset:32320
    s_mov_b32 s48, 0
    s_mov_b32 s49, -1
    v_mov_b32 v192, 0x3ea52b5c
    v_cndmask_b32 v194, v192, 0, s[48:49]
    v_mov_b32 v193, v192
    v_mov_b32 v195, v194
    s_waitcnt lgkmcnt(6)
    v_pk_add_f32 v[144:145], v[144:145], v[156:157]
    v_pk_add_f32 v[146:147], v[146:147], v[158:159]
    v_pk_add_f32 v[148:149], v[148:149], v[160:161]
    v_pk_add_f32 v[150:151], v[150:151], v[162:163]
    v_pk_add_f32 v[152:153], v[152:153], v[164:165]
    v_pk_add_f32 v[154:155], v[154:155], v[166:167]
    v_pk_mul_f32 v[144:145], v[144:145], v[192:193]
    v_pk_mul_f32 v[146:147], v[146:147], v[192:193]
    v_pk_mul_f32 v[148:149], v[148:149], v[192:193]
    v_pk_mul_f32 v[150:151], v[150:151], v[192:193]
    v_pk_mul_f32 v[152:153], v[152:153], v[194:195]
    v_pk_mul_f32 v[154:155], v[154:155], v[194:195]
    v_cvt_pk_bf16_f32 v128, v144, v145
    v_cvt_pk_bf16_f32 v129, v146, v147
    v_cvt_pk_bf16_f32 v130, v148, v149
    v_cvt_pk_bf16_f32 v131, v150, v151
    v_cvt_pk_bf16_f32 v132, v152, v153
    v_cvt_pk_bf16_f32 v133, v154, v155
    s_waitcnt lgkmcnt(0)
    v_pk_add_f32 v[168:169], v[168:169], v[180:181]
    v_pk_add_f32 v[170:171], v[170:171], v[182:183]
    v_pk_add_f32 v[172:173], v[172:173], v[184:185]
    v_pk_add_f32 v[174:175], v[174:175], v[186:187]
    v_pk_add_f32 v[176:177], v[176:177], v[188:189]
    v_pk_add_f32 v[178:179], v[178:179], v[190:191]
    v_pk_mul_f32 v[168:169], v[168:169], v[192:193]
    v_pk_mul_f32 v[170:171], v[170:171], v[192:193]
    v_pk_mul_f32 v[172:173], v[172:173], v[192:193]
    v_pk_mul_f32 v[174:175], v[174:175], v[192:193]
    v_pk_mul_f32 v[176:177], v[176:177], v[194:195]
    v_pk_mul_f32 v[178:179], v[178:179], v[194:195]
    v_cvt_pk_bf16_f32 v134, v168, v169
    v_cvt_pk_bf16_f32 v135, v170, v171
    v_cvt_pk_bf16_f32 v136, v172, v173
    v_cvt_pk_bf16_f32 v137, v174, v175
    v_cvt_pk_bf16_f32 v138, v176, v177
    v_cvt_pk_bf16_f32 v139, v178, v179
    s_barrier
    ds_read_b128 v[80:83], v140 offset:0
    ds_read2st64_b64 v[88:91], v141 offset0:0 offset1:5
    ds_read_b128 v[84:87], v140 offset:2560
    s_mov_b64 exec, s[76:77]
    ds_read_b128 v[96:99], v142 offset:0
    ds_read_b128 v[100:103], v142 offset:1280
    ds_read_b128 v[104:107], v142 offset:2560
    ds_read_b128 v[108:111], v142 offset:3840
    s_mov_b64 exec, -1
    s_waitcnt lgkmcnt(6)
    v_mfma_f32_32x32x16_bf16 v[32:47], v[80:83], v[128:131], 0
    s_waitcnt lgkmcnt(5)
    v_mfma_f32_32x32x8_bf16 v[32:47], v[88:89], v[132:133], v[32:47]
    v_mfma_f32_32x32x16_bf16 v[48:63], v[80:83], v[134:137], 0
    ds_read_b128 v[80:83], v140 offset:5120
    s_nop 9
    v_exp_f32 v32, v32
    v_exp_f32 v33, v33
    v_exp_f32 v34, v34
    v_exp_f32 v35, v35
    v_mfma_f32_32x32x8_bf16 v[48:63], v[88:89], v[138:139], v[48:63]
    ds_read2st64_b64 v[92:95], v141 offset0:10 offset1:15
    v_exp_f32 v36, v36
    v_exp_f32 v37, v37
    v_exp_f32 v38, v38
    v_exp_f32 v39, v39
    v_exp_f32 v40, v40
    v_exp_f32 v41, v41
    v_exp_f32 v42, v42
    v_exp_f32 v43, v43
    s_mov_b64 exec, s[76:77]
    ds_read_b128 v[112:115], v142 offset:5120
    ds_read_b128 v[116:119], v142 offset:6400
    ds_read_b128 v[120:123], v142 offset:7680
    ds_read_b128 v[124:127], v142 offset:8960
    s_mov_b64 exec, -1
    v_exp_f32 v44, v44
    v_exp_f32 v45, v45
    v_exp_f32 v46, v46
    v_exp_f32 v47, v47
    s_waitcnt lgkmcnt(10)
    v_mfma_f32_32x32x16_bf16 v[64:79], v[84:87], v[128:131], 0
    v_exp_f32 v48, v48
    v_exp_f32 v49, v49
    v_exp_f32 v50, v50
    v_exp_f32 v51, v51
    v_mfma_f32_32x32x8_bf16 v[64:79], v[90:91], v[132:133], v[64:79]
    v_exp_f32 v52, v52
    v_exp_f32 v53, v53
    v_exp_f32 v54, v54
    v_exp_f32 v55, v55
    s_waitcnt lgkmcnt(6)
    v_smfmac_f32_32x32x32_bf16 v[0:15], v[96:99], v[32:39], v143
    v_exp_f32 v56, v56
    v_exp_f32 v57, v57
    v_exp_f32 v58, v58
    v_exp_f32 v59, v59
    v_smfmac_f32_32x32x32_bf16 v[0:15], v[100:103], v[40:47], v143
    v_exp_f32 v60, v60
    v_exp_f32 v61, v61
    v_exp_f32 v62, v62
    v_exp_f32 v63, v63
    v_mfma_f32_32x32x16_bf16 v[32:47], v[84:87], v[134:137], 0
    ds_read_b128 v[84:87], v140 offset:7680
    v_exp_f32 v64, v64
    v_exp_f32 v65, v65
    v_exp_f32 v66, v66
    v_exp_f32 v67, v67
    v_mfma_f32_32x32x8_bf16 v[32:47], v[90:91], v[138:139], v[32:47]
    v_exp_f32 v68, v68
    v_exp_f32 v69, v69
    v_exp_f32 v70, v70
    v_exp_f32 v71, v71
    v_smfmac_f32_32x32x32_bf16 v[16:31], v[96:99], v[48:55], v143
    v_exp_f32 v72, v72
    v_exp_f32 v73, v73
    v_exp_f32 v74, v74
    v_exp_f32 v75, v75
    v_smfmac_f32_32x32x32_bf16 v[16:31], v[100:103], v[56:63], v143
    v_exp_f32 v76, v76
    v_exp_f32 v77, v77
    v_exp_f32 v78, v78
    v_exp_f32 v79, v79
    s_waitcnt lgkmcnt(6)
    v_mfma_f32_32x32x16_bf16 v[48:63], v[80:83], v[128:131], 0
    v_exp_f32 v32, v32
    v_exp_f32 v33, v33
    v_exp_f32 v34, v34
    v_exp_f32 v35, v35
    s_waitcnt lgkmcnt(5)
    v_mfma_f32_32x32x8_bf16 v[48:63], v[92:93], v[132:133], v[48:63]
    v_exp_f32 v36, v36
    v_exp_f32 v37, v37
    v_exp_f32 v38, v38
    v_exp_f32 v39, v39
    v_smfmac_f32_32x32x32_bf16 v[0:15], v[104:107], v[64:71], v143
    v_exp_f32 v40, v40
    v_exp_f32 v41, v41
    v_exp_f32 v42, v42
    v_exp_f32 v43, v43
    v_smfmac_f32_32x32x32_bf16 v[0:15], v[108:111], v[72:79], v143
    v_exp_f32 v44, v44
    v_exp_f32 v45, v45
    v_exp_f32 v46, v46
    v_exp_f32 v47, v47
    v_mfma_f32_32x32x16_bf16 v[64:79], v[80:83], v[134:137], 0
    ds_read_b128 v[80:83], v140 offset:10240
    v_exp_f32 v48, v48
    v_exp_f32 v49, v49
    v_exp_f32 v50, v50
    v_exp_f32 v51, v51
    v_mfma_f32_32x32x8_bf16 v[64:79], v[92:93], v[138:139], v[64:79]
    ds_read2st64_b64 v[88:91], v141 offset0:20 offset1:25
    v_exp_f32 v52, v52
    v_exp_f32 v53, v53
    v_exp_f32 v54, v54
    v_exp_f32 v55, v55
    v_smfmac_f32_32x32x32_bf16 v[16:31], v[104:107], v[32:39], v143
    v_exp_f32 v56, v56
    v_exp_f32 v57, v57
    v_exp_f32 v58, v58
    v_exp_f32 v59, v59
    v_smfmac_f32_32x32x32_bf16 v[16:31], v[108:111], v[40:47], v143
    s_mov_b64 exec, s[76:77]
    ds_read_b128 v[96:99], v142 offset:10240
    ds_read_b128 v[100:103], v142 offset:11520
    ds_read_b128 v[104:107], v142 offset:12800
    ds_read_b128 v[108:111], v142 offset:14080
    s_mov_b64 exec, -1
    v_exp_f32 v60, v60
    v_exp_f32 v61, v61
    v_exp_f32 v62, v62
    v_exp_f32 v63, v63
    s_waitcnt lgkmcnt(6)
    v_mfma_f32_32x32x16_bf16 v[32:47], v[84:87], v[128:131], 0
    v_exp_f32 v64, v64
    v_exp_f32 v65, v65
    v_exp_f32 v66, v66
    v_exp_f32 v67, v67
    v_mfma_f32_32x32x8_bf16 v[32:47], v[94:95], v[132:133], v[32:47]
    v_exp_f32 v68, v68
    v_exp_f32 v69, v69
    v_exp_f32 v70, v70
    v_exp_f32 v71, v71
    v_smfmac_f32_32x32x32_bf16 v[0:15], v[112:115], v[48:55], v143
    v_exp_f32 v72, v72
    v_exp_f32 v73, v73
    v_exp_f32 v74, v74
    v_exp_f32 v75, v75
    v_smfmac_f32_32x32x32_bf16 v[0:15], v[116:119], v[56:63], v143
    v_exp_f32 v76, v76
    v_exp_f32 v77, v77
    v_exp_f32 v78, v78
    v_exp_f32 v79, v79
    v_mfma_f32_32x32x16_bf16 v[48:63], v[84:87], v[134:137], 0
    ds_read_b128 v[84:87], v140 offset:12800
    v_exp_f32 v32, v32
    v_exp_f32 v33, v33
    v_exp_f32 v34, v34
    v_exp_f32 v35, v35
    v_mfma_f32_32x32x8_bf16 v[48:63], v[94:95], v[138:139], v[48:63]
    v_exp_f32 v36, v36
    v_exp_f32 v37, v37
    v_exp_f32 v38, v38
    v_exp_f32 v39, v39
    v_smfmac_f32_32x32x32_bf16 v[16:31], v[112:115], v[64:71], v143
    v_exp_f32 v40, v40
    v_exp_f32 v41, v41
    v_exp_f32 v42, v42
    v_exp_f32 v43, v43
    v_smfmac_f32_32x32x32_bf16 v[16:31], v[116:119], v[72:79], v143
    v_exp_f32 v44, v44
    v_exp_f32 v45, v45
    v_exp_f32 v46, v46
    v_exp_f32 v47, v47
    s_waitcnt lgkmcnt(6)
    v_mfma_f32_32x32x16_bf16 v[64:79], v[80:83], v[128:131], 0
    v_exp_f32 v48, v48
    v_exp_f32 v49, v49
    v_exp_f32 v50, v50
    v_exp_f32 v51, v51
    s_waitcnt lgkmcnt(5)
    v_mfma_f32_32x32x8_bf16 v[64:79], v[88:89], v[132:133], v[64:79]
    v_exp_f32 v52, v52
    v_exp_f32 v53, v53
    v_exp_f32 v54, v54
    v_exp_f32 v55, v55
    v_smfmac_f32_32x32x32_bf16 v[0:15], v[120:123], v[32:39], v143
    v_exp_f32 v56, v56
    v_exp_f32 v57, v57
    v_exp_f32 v58, v58
    v_exp_f32 v59, v59
    v_smfmac_f32_32x32x32_bf16 v[0:15], v[124:127], v[40:47], v143
    v_exp_f32 v60, v60
    v_exp_f32 v61, v61
    v_exp_f32 v62, v62
    v_exp_f32 v63, v63
    v_mfma_f32_32x32x16_bf16 v[32:47], v[80:83], v[134:137], 0
    ds_read_b128 v[80:83], v140 offset:15360
    v_exp_f32 v64, v64
    v_exp_f32 v65, v65
    v_exp_f32 v66, v66
    v_exp_f32 v67, v67
    v_mfma_f32_32x32x8_bf16 v[32:47], v[88:89], v[138:139], v[32:47]
    ds_read2st64_b64 v[92:95], v141 offset0:30 offset1:35
    v_exp_f32 v68, v68
    v_exp_f32 v69, v69
    v_exp_f32 v70, v70
    v_exp_f32 v71, v71
    v_smfmac_f32_32x32x32_bf16 v[16:31], v[120:123], v[48:55], v143
    v_exp_f32 v72, v72
    v_exp_f32 v73, v73
    v_exp_f32 v74, v74
    v_exp_f32 v75, v75
    v_smfmac_f32_32x32x32_bf16 v[16:31], v[124:127], v[56:63], v143
    s_mov_b64 exec, s[76:77]
    ds_read_b128 v[112:115], v142 offset:15360
    ds_read_b128 v[116:119], v142 offset:16640
    ds_read_b128 v[120:123], v142 offset:17920
    ds_read_b128 v[124:127], v142 offset:19200
    s_mov_b64 exec, -1
    v_exp_f32 v76, v76
    v_exp_f32 v77, v77
    v_exp_f32 v78, v78
    v_exp_f32 v79, v79
    s_waitcnt lgkmcnt(6)
    v_mfma_f32_32x32x16_bf16 v[48:63], v[84:87], v[128:131], 0
    v_exp_f32 v32, v32
    v_exp_f32 v33, v33
    v_exp_f32 v34, v34
    v_exp_f32 v35, v35
    v_mfma_f32_32x32x8_bf16 v[48:63], v[90:91], v[132:133], v[48:63]
    v_exp_f32 v36, v36
    v_exp_f32 v37, v37
    v_exp_f32 v38, v38
    v_exp_f32 v39, v39
    v_smfmac_f32_32x32x32_bf16 v[0:15], v[96:99], v[64:71], v143
    v_exp_f32 v40, v40
    v_exp_f32 v41, v41
    v_exp_f32 v42, v42
    v_exp_f32 v43, v43
    v_smfmac_f32_32x32x32_bf16 v[0:15], v[100:103], v[72:79], v143
    v_exp_f32 v44, v44
    v_exp_f32 v45, v45
    v_exp_f32 v46, v46
    v_exp_f32 v47, v47
    v_mfma_f32_32x32x16_bf16 v[64:79], v[84:87], v[134:137], 0
    ds_read_b128 v[84:87], v140 offset:17920
    v_exp_f32 v48, v48
    v_exp_f32 v49, v49
    v_exp_f32 v50, v50
    v_exp_f32 v51, v51
    v_mfma_f32_32x32x8_bf16 v[64:79], v[90:91], v[138:139], v[64:79]
    v_exp_f32 v52, v52
    v_exp_f32 v53, v53
    v_exp_f32 v54, v54
    v_exp_f32 v55, v55
    v_smfmac_f32_32x32x32_bf16 v[16:31], v[96:99], v[32:39], v143
    v_exp_f32 v56, v56
    v_exp_f32 v57, v57
    v_exp_f32 v58, v58
    v_exp_f32 v59, v59
    v_smfmac_f32_32x32x32_bf16 v[16:31], v[100:103], v[40:47], v143
    v_exp_f32 v60, v60
    v_exp_f32 v61, v61
    v_exp_f32 v62, v62
    v_exp_f32 v63, v63
    s_waitcnt lgkmcnt(6)
    v_mfma_f32_32x32x16_bf16 v[32:47], v[80:83], v[128:131], 0
    v_exp_f32 v64, v64
    v_exp_f32 v65, v65
    v_exp_f32 v66, v66
    v_exp_f32 v67, v67
    s_waitcnt lgkmcnt(5)
    v_mfma_f32_32x32x8_bf16 v[32:47], v[92:93], v[132:133], v[32:47]
    v_exp_f32 v68, v68
    v_exp_f32 v69, v69
    v_exp_f32 v70, v70
    v_exp_f32 v71, v71
    v_smfmac_f32_32x32x32_bf16 v[0:15], v[104:107], v[48:55], v143
    v_exp_f32 v72, v72
    v_exp_f32 v73, v73
    v_exp_f32 v74, v74
    v_exp_f32 v75, v75
    v_smfmac_f32_32x32x32_bf16 v[0:15], v[108:111], v[56:63], v143
    v_exp_f32 v76, v76
    v_exp_f32 v77, v77
    v_exp_f32 v78, v78
    v_exp_f32 v79, v79
    s_barrier
    v_mfma_f32_32x32x16_bf16 v[48:63], v[80:83], v[134:137], 0
    ds_read_b128 v[80:83], v140 offset:20480
    v_exp_f32 v32, v32
    v_exp_f32 v33, v33
    v_exp_f32 v34, v34
    v_exp_f32 v35, v35
    v_mfma_f32_32x32x8_bf16 v[48:63], v[92:93], v[138:139], v[48:63]
    ds_read2st64_b64 v[88:91], v141 offset0:40 offset1:45
    v_exp_f32 v36, v36
    v_exp_f32 v37, v37
    v_exp_f32 v38, v38
    v_exp_f32 v39, v39
    v_smfmac_f32_32x32x32_bf16 v[16:31], v[104:107], v[64:71], v143
    v_exp_f32 v40, v40
    v_exp_f32 v41, v41
    v_exp_f32 v42, v42
    v_exp_f32 v43, v43
    v_smfmac_f32_32x32x32_bf16 v[16:31], v[108:111], v[72:79], v143
    s_mov_b64 exec, s[76:77]
    ds_read_b128 v[96:99], v142 offset:20480
    ds_read_b128 v[100:103], v142 offset:21760
    ds_read_b128 v[104:107], v142 offset:23040
    ds_read_b128 v[108:111], v142 offset:24320
    s_mov_b64 exec, -1
    v_exp_f32 v44, v44
    v_exp_f32 v45, v45
    v_exp_f32 v46, v46
    v_exp_f32 v47, v47
    s_waitcnt lgkmcnt(6)
    v_mfma_f32_32x32x16_bf16 v[64:79], v[84:87], v[128:131], 0
    v_exp_f32 v48, v48
    v_exp_f32 v49, v49
    v_exp_f32 v50, v50
    v_exp_f32 v51, v51
    v_mfma_f32_32x32x8_bf16 v[64:79], v[94:95], v[132:133], v[64:79]
    v_exp_f32 v52, v52
    v_exp_f32 v53, v53
    v_exp_f32 v54, v54
    v_exp_f32 v55, v55
    v_smfmac_f32_32x32x32_bf16 v[0:15], v[112:115], v[32:39], v143
    v_exp_f32 v56, v56
    v_exp_f32 v57, v57
    v_exp_f32 v58, v58
    v_exp_f32 v59, v59
    v_smfmac_f32_32x32x32_bf16 v[0:15], v[116:119], v[40:47], v143
    v_exp_f32 v60, v60
    v_exp_f32 v61, v61
    v_exp_f32 v62, v62
    v_exp_f32 v63, v63
    v_mfma_f32_32x32x16_bf16 v[32:47], v[84:87], v[134:137], 0
    ds_read_b128 v[84:87], v140 offset:23040
    v_exp_f32 v64, v64
    v_exp_f32 v65, v65
    v_exp_f32 v66, v66
    v_exp_f32 v67, v67
    v_mfma_f32_32x32x8_bf16 v[32:47], v[94:95], v[138:139], v[32:47]
    v_exp_f32 v68, v68
    v_exp_f32 v69, v69
    v_exp_f32 v70, v70
    v_exp_f32 v71, v71
    v_smfmac_f32_32x32x32_bf16 v[16:31], v[112:115], v[48:55], v143
    v_exp_f32 v72, v72
    v_exp_f32 v73, v73
    v_exp_f32 v74, v74
    v_exp_f32 v75, v75
    v_smfmac_f32_32x32x32_bf16 v[16:31], v[116:119], v[56:63], v143
    v_exp_f32 v76, v76
    v_exp_f32 v77, v77
    v_exp_f32 v78, v78
    v_exp_f32 v79, v79
    s_waitcnt lgkmcnt(6)
    v_mfma_f32_32x32x16_bf16 v[48:63], v[80:83], v[128:131], 0
    v_exp_f32 v32, v32
    v_exp_f32 v33, v33
    v_exp_f32 v34, v34
    v_exp_f32 v35, v35
    s_waitcnt lgkmcnt(5)
    v_mfma_f32_32x32x8_bf16 v[48:63], v[88:89], v[132:133], v[48:63]
    v_exp_f32 v36, v36
    v_exp_f32 v37, v37
    v_exp_f32 v38, v38
    v_exp_f32 v39, v39
    v_smfmac_f32_32x32x32_bf16 v[0:15], v[120:123], v[64:71], v143
    v_exp_f32 v40, v40
    v_exp_f32 v41, v41
    v_exp_f32 v42, v42
    v_exp_f32 v43, v43
    v_smfmac_f32_32x32x32_bf16 v[0:15], v[124:127], v[72:79], v143
    v_exp_f32 v44, v44
    v_exp_f32 v45, v45
    v_exp_f32 v46, v46
    v_exp_f32 v47, v47
    v_mfma_f32_32x32x16_bf16 v[64:79], v[80:83], v[134:137], 0
    ds_read_b128 v[80:83], v140 offset:25600
    v_exp_f32 v48, v48
    v_exp_f32 v49, v49
    v_exp_f32 v50, v50
    v_exp_f32 v51, v51
    v_mfma_f32_32x32x8_bf16 v[64:79], v[88:89], v[138:139], v[64:79]
    ds_read2st64_b64 v[92:95], v141 offset0:50 offset1:55
    v_exp_f32 v52, v52
    v_exp_f32 v53, v53
    v_exp_f32 v54, v54
    v_exp_f32 v55, v55
    v_smfmac_f32_32x32x32_bf16 v[16:31], v[120:123], v[32:39], v143
    v_exp_f32 v56, v56
    v_exp_f32 v57, v57
    v_exp_f32 v58, v58
    v_exp_f32 v59, v59
    v_smfmac_f32_32x32x32_bf16 v[16:31], v[124:127], v[40:47], v143
    s_mov_b64 exec, s[76:77]
    ds_read_b128 v[112:115], v142 offset:25600
    ds_read_b128 v[116:119], v142 offset:26880
    ds_read_b128 v[120:123], v142 offset:28160
    ds_read_b128 v[124:127], v142 offset:29440
    s_mov_b64 exec, -1
    v_exp_f32 v60, v60
    v_exp_f32 v61, v61
    v_exp_f32 v62, v62
    v_exp_f32 v63, v63
    s_waitcnt lgkmcnt(6)
    v_mfma_f32_32x32x16_bf16 v[32:47], v[84:87], v[128:131], 0
    v_exp_f32 v64, v64
    v_exp_f32 v65, v65
    v_exp_f32 v66, v66
    v_exp_f32 v67, v67
    v_mfma_f32_32x32x8_bf16 v[32:47], v[90:91], v[132:133], v[32:47]
    v_exp_f32 v68, v68
    v_exp_f32 v69, v69
    v_exp_f32 v70, v70
    v_exp_f32 v71, v71
    v_smfmac_f32_32x32x32_bf16 v[0:15], v[96:99], v[48:55], v143
    v_exp_f32 v72, v72
    v_exp_f32 v73, v73
    v_exp_f32 v74, v74
    v_exp_f32 v75, v75
    v_smfmac_f32_32x32x32_bf16 v[0:15], v[100:103], v[56:63], v143
    v_exp_f32 v76, v76
    v_exp_f32 v77, v77
    v_exp_f32 v78, v78
    v_exp_f32 v79, v79
    v_mfma_f32_32x32x16_bf16 v[48:63], v[84:87], v[134:137], 0
    ds_read_b128 v[84:87], v140 offset:28160
    v_exp_f32 v32, v32
    v_exp_f32 v33, v33
    v_exp_f32 v34, v34
    v_exp_f32 v35, v35
    v_mfma_f32_32x32x8_bf16 v[48:63], v[90:91], v[138:139], v[48:63]
    v_exp_f32 v36, v36
    v_exp_f32 v37, v37
    v_exp_f32 v38, v38
    v_exp_f32 v39, v39
    v_smfmac_f32_32x32x32_bf16 v[16:31], v[96:99], v[64:71], v143
    v_exp_f32 v40, v40
    v_exp_f32 v41, v41
    v_exp_f32 v42, v42
    v_exp_f32 v43, v43
    v_smfmac_f32_32x32x32_bf16 v[16:31], v[100:103], v[72:79], v143
    v_exp_f32 v44, v44
    v_exp_f32 v45, v45
    v_exp_f32 v46, v46
    v_exp_f32 v47, v47
    s_waitcnt lgkmcnt(6)
    v_mfma_f32_32x32x16_bf16 v[64:79], v[80:83], v[128:131], 0
    v_exp_f32 v48, v48
    v_exp_f32 v49, v49
    v_exp_f32 v50, v50
    v_exp_f32 v51, v51
    s_waitcnt lgkmcnt(5)
    v_mfma_f32_32x32x8_bf16 v[64:79], v[92:93], v[132:133], v[64:79]
    v_exp_f32 v52, v52
    v_exp_f32 v53, v53
    v_exp_f32 v54, v54
    v_exp_f32 v55, v55
    v_smfmac_f32_32x32x32_bf16 v[0:15], v[104:107], v[32:39], v143
    v_exp_f32 v56, v56
    v_exp_f32 v57, v57
    v_exp_f32 v58, v58
    v_exp_f32 v59, v59
    v_smfmac_f32_32x32x32_bf16 v[0:15], v[108:111], v[40:47], v143
    v_exp_f32 v60, v60
    v_exp_f32 v61, v61
    v_exp_f32 v62, v62
    v_exp_f32 v63, v63
    v_mfma_f32_32x32x16_bf16 v[32:47], v[80:83], v[134:137], 0
    ds_read_b128 v[80:83], v140 offset:30720
    v_exp_f32 v64, v64
    v_exp_f32 v65, v65
    v_exp_f32 v66, v66
    v_exp_f32 v67, v67
    v_mfma_f32_32x32x8_bf16 v[32:47], v[92:93], v[138:139], v[32:47]
    ds_read2st64_b64 v[88:91], v141 offset0:60 offset1:65
    v_exp_f32 v68, v68
    v_exp_f32 v69, v69
    v_exp_f32 v70, v70
    v_exp_f32 v71, v71
    v_smfmac_f32_32x32x32_bf16 v[16:31], v[104:107], v[48:55], v143
    v_exp_f32 v72, v72
    v_exp_f32 v73, v73
    v_exp_f32 v74, v74
    v_exp_f32 v75, v75
    v_smfmac_f32_32x32x32_bf16 v[16:31], v[108:111], v[56:63], v143
    s_mov_b64 exec, s[76:77]
    ds_read_b128 v[96:99], v142 offset:30720
    ds_read_b128 v[100:103], v142 offset:32000
    ds_read_b128 v[104:107], v142 offset:33280
    ds_read_b128 v[108:111], v142 offset:34560
    s_mov_b64 exec, -1
    v_exp_f32 v76, v76
    v_exp_f32 v77, v77
    v_exp_f32 v78, v78
    v_exp_f32 v79, v79
    s_waitcnt lgkmcnt(6)
    v_mfma_f32_32x32x16_bf16 v[48:63], v[84:87], v[128:131], 0
    v_exp_f32 v32, v32
    v_exp_f32 v33, v33
    v_exp_f32 v34, v34
    v_exp_f32 v35, v35
    v_mfma_f32_32x32x8_bf16 v[48:63], v[94:95], v[132:133], v[48:63]
    v_exp_f32 v36, v36
    v_exp_f32 v37, v37
    v_exp_f32 v38, v38
    v_exp_f32 v39, v39
    v_smfmac_f32_32x32x32_bf16 v[0:15], v[112:115], v[64:71], v143
    v_exp_f32 v40, v40
    v_exp_f32 v41, v41
    v_exp_f32 v42, v42
    v_exp_f32 v43, v43
    v_smfmac_f32_32x32x32_bf16 v[0:15], v[116:119], v[72:79], v143
    v_exp_f32 v44, v44
    v_exp_f32 v45, v45
    v_exp_f32 v46, v46
    v_exp_f32 v47, v47
    v_mfma_f32_32x32x16_bf16 v[64:79], v[84:87], v[134:137], 0
    ds_read_b128 v[84:87], v140 offset:33280
    v_exp_f32 v48, v48
    v_exp_f32 v49, v49
    v_exp_f32 v50, v50
    v_exp_f32 v51, v51
    v_mfma_f32_32x32x8_bf16 v[64:79], v[94:95], v[138:139], v[64:79]
    v_exp_f32 v52, v52
    v_exp_f32 v53, v53
    v_exp_f32 v54, v54
    v_exp_f32 v55, v55
    v_smfmac_f32_32x32x32_bf16 v[16:31], v[112:115], v[32:39], v143
    v_exp_f32 v56, v56
    v_exp_f32 v57, v57
    v_exp_f32 v58, v58
    v_exp_f32 v59, v59
    v_smfmac_f32_32x32x32_bf16 v[16:31], v[116:119], v[40:47], v143
    v_exp_f32 v60, v60
    v_exp_f32 v61, v61
    v_exp_f32 v62, v62
    v_exp_f32 v63, v63
    s_waitcnt lgkmcnt(6)
    v_mfma_f32_32x32x16_bf16 v[32:47], v[80:83], v[128:131], 0
    v_exp_f32 v64, v64
    v_exp_f32 v65, v65
    v_exp_f32 v66, v66
    v_exp_f32 v67, v67
    s_waitcnt lgkmcnt(5)
    v_mfma_f32_32x32x8_bf16 v[32:47], v[88:89], v[132:133], v[32:47]
    v_exp_f32 v68, v68
    v_exp_f32 v69, v69
    v_exp_f32 v70, v70
    v_exp_f32 v71, v71
    v_smfmac_f32_32x32x32_bf16 v[0:15], v[120:123], v[48:55], v143
    v_exp_f32 v72, v72
    v_exp_f32 v73, v73
    v_exp_f32 v74, v74
    v_exp_f32 v75, v75
    v_smfmac_f32_32x32x32_bf16 v[0:15], v[124:127], v[56:63], v143
    v_exp_f32 v76, v76
    v_exp_f32 v77, v77
    v_exp_f32 v78, v78
    v_exp_f32 v79, v79
    v_mfma_f32_32x32x16_bf16 v[48:63], v[80:83], v[134:137], 0
    ds_read_b128 v[80:83], v140 offset:35840
    v_exp_f32 v32, v32
    v_exp_f32 v33, v33
    v_exp_f32 v34, v34
    v_exp_f32 v35, v35
    v_mfma_f32_32x32x8_bf16 v[48:63], v[88:89], v[138:139], v[48:63]
    ds_read2st64_b64 v[92:95], v141 offset0:70 offset1:75
    v_exp_f32 v36, v36
    v_exp_f32 v37, v37
    v_exp_f32 v38, v38
    v_exp_f32 v39, v39
    v_smfmac_f32_32x32x32_bf16 v[16:31], v[120:123], v[64:71], v143
    v_exp_f32 v40, v40
    v_exp_f32 v41, v41
    v_exp_f32 v42, v42
    v_exp_f32 v43, v43
    v_smfmac_f32_32x32x32_bf16 v[16:31], v[124:127], v[72:79], v143
    s_mov_b64 exec, s[76:77]
    ds_read_b128 v[112:115], v142 offset:35840
    ds_read_b128 v[116:119], v142 offset:37120
    ds_read_b128 v[120:123], v142 offset:38400
    ds_read_b128 v[124:127], v142 offset:39680
    s_mov_b64 exec, -1
    v_exp_f32 v44, v44
    v_exp_f32 v45, v45
    v_exp_f32 v46, v46
    v_exp_f32 v47, v47
    s_waitcnt lgkmcnt(6)
    v_mfma_f32_32x32x16_bf16 v[64:79], v[84:87], v[128:131], 0
    v_exp_f32 v48, v48
    v_exp_f32 v49, v49
    v_exp_f32 v50, v50
    v_exp_f32 v51, v51
    v_mfma_f32_32x32x8_bf16 v[64:79], v[90:91], v[132:133], v[64:79]
    v_exp_f32 v52, v52
    v_exp_f32 v53, v53
    v_exp_f32 v54, v54
    v_exp_f32 v55, v55
    v_smfmac_f32_32x32x32_bf16 v[0:15], v[96:99], v[32:39], v143
    v_exp_f32 v56, v56
    v_exp_f32 v57, v57
    v_exp_f32 v58, v58
    v_exp_f32 v59, v59
    v_smfmac_f32_32x32x32_bf16 v[0:15], v[100:103], v[40:47], v143
    v_exp_f32 v60, v60
    v_exp_f32 v61, v61
    v_exp_f32 v62, v62
    v_exp_f32 v63, v63
    v_mfma_f32_32x32x16_bf16 v[32:47], v[84:87], v[134:137], 0
    ds_read_b128 v[84:87], v140 offset:38400
    v_exp_f32 v64, v64
    v_exp_f32 v65, v65
    v_exp_f32 v66, v66
    v_exp_f32 v67, v67
    v_mfma_f32_32x32x8_bf16 v[32:47], v[90:91], v[138:139], v[32:47]
    v_exp_f32 v68, v68
    v_exp_f32 v69, v69
    v_exp_f32 v70, v70
    v_exp_f32 v71, v71
    v_smfmac_f32_32x32x32_bf16 v[16:31], v[96:99], v[48:55], v143
    v_exp_f32 v72, v72
    v_exp_f32 v73, v73
    v_exp_f32 v74, v74
    v_exp_f32 v75, v75
    v_smfmac_f32_32x32x32_bf16 v[16:31], v[100:103], v[56:63], v143
    v_exp_f32 v76, v76
    v_exp_f32 v77, v77
    v_exp_f32 v78, v78
    v_exp_f32 v79, v79
    s_waitcnt lgkmcnt(6)
    v_mfma_f32_32x32x16_bf16 v[48:63], v[80:83], v[128:131], 0
    v_exp_f32 v32, v32
    v_exp_f32 v33, v33
    v_exp_f32 v34, v34
    v_exp_f32 v35, v35
    s_waitcnt lgkmcnt(5)
    v_mfma_f32_32x32x8_bf16 v[48:63], v[92:93], v[132:133], v[48:63]
    v_exp_f32 v36, v36
    v_exp_f32 v37, v37
    v_exp_f32 v38, v38
    v_exp_f32 v39, v39
    v_smfmac_f32_32x32x32_bf16 v[0:15], v[104:107], v[64:71], v143
    v_exp_f32 v40, v40
    v_exp_f32 v41, v41
    v_exp_f32 v42, v42
    v_exp_f32 v43, v43
    v_smfmac_f32_32x32x32_bf16 v[0:15], v[108:111], v[72:79], v143
    v_exp_f32 v44, v44
    v_exp_f32 v45, v45
    v_exp_f32 v46, v46
    v_exp_f32 v47, v47
    s_waitcnt vmcnt(0)
    v_cmp_ne_u32 vcc, s40, v254
    s_nop 4
    s_cbranch_vccz L_xok
    buffer_load_dword v255, v248, s[36:39], 0 offen offset:4 sc1
    s_waitcnt vmcnt(0)
L_xok:
    v_cmp_ne_u32 vcc, s41, v255
    s_nop 0
    s_cmp_eq_u64 vcc, 0
    s_cselect_b32 s42, 1, 0
    s_barrier
    v_mfma_f32_32x32x16_bf16 v[64:79], v[80:83], v[134:137], 0
    ds_read_b128 v[80:83], v140 offset:40960
    v_exp_f32 v48, v48
    v_exp_f32 v49, v49
    v_exp_f32 v50, v50
    v_exp_f32 v51, v51
    v_mfma_f32_32x32x8_bf16 v[64:79], v[92:93], v[138:139], v[64:79]
    ds_read2st64_b64 v[88:91], v141 offset0:80 offset1:85
    v_exp_f32 v52, v52
    v_exp_f32 v53, v53
    v_exp_f32 v54, v54
    v_exp_f32 v55, v55
    v_smfmac_f32_32x32x32_bf16 v[16:31], v[104:107], v[32:39], v143
    v_exp_f32 v56, v56
    v_exp_f32 v57, v57
    v_exp_f32 v58, v58
    v_exp_f32 v59, v59
    v_smfmac_f32_32x32x32_bf16 v[16:31], v[108:111], v[40:47], v143
    s_mov_b64 exec, s[76:77]
    ds_read_b128 v[96:99], v142 offset:40960
    ds_read_b128 v[100:103], v142 offset:42240
    ds_read_b128 v[104:107], v142 offset:43520
    ds_read_b128 v[108:111], v142 offset:44800
    s_mov_b64 exec, -1
    v_exp_f32 v60, v60
    v_exp_f32 v61, v61
    v_exp_f32 v62, v62
    v_exp_f32 v63, v63
    s_waitcnt lgkmcnt(6)
    v_mfma_f32_32x32x16_bf16 v[32:47], v[84:87], v[128:131], 0
    v_exp_f32 v64, v64
    v_exp_f32 v65, v65
    v_exp_f32 v66, v66
    v_exp_f32 v67, v67
    v_mfma_f32_32x32x8_bf16 v[32:47], v[94:95], v[132:133], v[32:47]
    v_exp_f32 v68, v68
    v_exp_f32 v69, v69
    v_exp_f32 v70, v70
    v_exp_f32 v71, v71
    v_smfmac_f32_32x32x32_bf16 v[0:15], v[112:115], v[48:55], v143
    v_exp_f32 v72, v72
    v_exp_f32 v73, v73
    v_exp_f32 v74, v74
    v_exp_f32 v75, v75
    v_smfmac_f32_32x32x32_bf16 v[0:15], v[116:119], v[56:63], v143
    v_exp_f32 v76, v76
    v_exp_f32 v77, v77
    v_exp_f32 v78, v78
    v_exp_f32 v79, v79
    v_mfma_f32_32x32x16_bf16 v[48:63], v[84:87], v[134:137], 0
    ds_read_b128 v[84:87], v140 offset:43520
    v_exp_f32 v32, v32
    v_exp_f32 v33, v33
    v_exp_f32 v34, v34
    v_exp_f32 v35, v35
    v_mfma_f32_32x32x8_bf16 v[48:63], v[94:95], v[138:139], v[48:63]
    v_exp_f32 v36, v36
    v_exp_f32 v37, v37
    v_exp_f32 v38, v38
    v_exp_f32 v39, v39
    v_smfmac_f32_32x32x32_bf16 v[16:31], v[112:115], v[64:71], v143
    v_exp_f32 v40, v40
    v_exp_f32 v41, v41
    v_exp_f32 v42, v42
    v_exp_f32 v43, v43
    v_smfmac_f32_32x32x32_bf16 v[16:31], v[116:119], v[72:79], v143
    v_exp_f32 v44, v44
    v_exp_f32 v45, v45
    v_exp_f32 v46, v46
    v_exp_f32 v47, v47
    s_waitcnt lgkmcnt(6)
    v_mfma_f32_32x32x16_bf16 v[64:79], v[80:83], v[128:131], 0
    v_exp_f32 v48, v48
    v_exp_f32 v49, v49
    v_exp_f32 v50, v50
    v_exp_f32 v51, v51
    s_waitcnt lgkmcnt(5)
    v_mfma_f32_32x32x8_bf16 v[64:79], v[88:89], v[132:133], v[64:79]
    v_exp_f32 v52, v52
    v_exp_f32 v53, v53
    v_exp_f32 v54, v54
    v_exp_f32 v55, v55
    v_smfmac_f32_32x32x32_bf16 v[0:15], v[120:123], v[32:39], v143
    v_exp_f32 v56, v56
    v_exp_f32 v57, v57
    v_exp_f32 v58, v58
    v_exp_f32 v59, v59
    v_smfmac_f32_32x32x32_bf16 v[0:15], v[124:127], v[40:47], v143
    v_exp_f32 v60, v60
    v_exp_f32 v61, v61
    v_exp_f32 v62, v62
    v_exp_f32 v63, v63
    v_mfma_f32_32x32x16_bf16 v[32:47], v[80:83], v[134:137], 0
    ds_read_b128 v[80:83], v140 offset:46080
    v_exp_f32 v64, v64
    v_exp_f32 v65, v65
    v_exp_f32 v66, v66
    v_exp_f32 v67, v67
    v_mfma_f32_32x32x8_bf16 v[32:47], v[88:89], v[138:139], v[32:47]
    ds_read2st64_b64 v[92:95], v141 offset0:90 offset1:95
    v_exp_f32 v68, v68
    v_exp_f32 v69, v69
    v_exp_f32 v70, v70
    v_exp_f32 v71, v71
    v_smfmac_f32_32x32x32_bf16 v[16:31], v[120:123], v[48:55], v143
    v_exp_f32 v72, v72
    v_exp_f32 v73, v73
    v_exp_f32 v74, v74
    v_exp_f32 v75, v75
    v_smfmac_f32_32x32x32_bf16 v[16:31], v[124:127], v[56:63], v143
    s_mov_b64 exec, s[76:77]
    ds_read_b128 v[112:115], v142 offset:46080
    ds_read_b128 v[116:119], v142 offset:47360
    ds_read_b128 v[120:123], v142 offset:48640
    ds_read_b128 v[124:127], v142 offset:49920
    s_mov_b64 exec, -1
    v_exp_f32 v76, v76
    v_exp_f32 v77, v77
    v_exp_f32 v78, v78
    v_exp_f32 v79, v79
    s_waitcnt lgkmcnt(6)
    v_mfma_f32_32x32x16_bf16 v[48:63], v[84:87], v[128:131], 0
    v_exp_f32 v32, v32
    v_exp_f32 v33, v33
    v_exp_f32 v34, v34
    v_exp_f32 v35, v35
    v_mfma_f32_32x32x8_bf16 v[48:63], v[90:91], v[132:133], v[48:63]
    v_exp_f32 v36, v36
    v_exp_f32 v37, v37
    v_exp_f32 v38, v38
    v_exp_f32 v39, v39
    v_smfmac_f32_32x32x32_bf16 v[0:15], v[96:99], v[64:71], v143
    v_exp_f32 v40, v40
    v_exp_f32 v41, v41
    v_exp_f32 v42, v42
    v_exp_f32 v43, v43
    v_smfmac_f32_32x32x32_bf16 v[0:15], v[100:103], v[72:79], v143
    v_exp_f32 v44, v44
    v_exp_f32 v45, v45
    v_exp_f32 v46, v46
    v_exp_f32 v47, v47
    v_mfma_f32_32x32x16_bf16 v[64:79], v[84:87], v[134:137], 0
    ds_read_b128 v[84:87], v140 offset:48640
    v_exp_f32 v48, v48
    v_exp_f32 v49, v49
    v_exp_f32 v50, v50
    v_exp_f32 v51, v51
    v_mfma_f32_32x32x8_bf16 v[64:79], v[90:91], v[138:139], v[64:79]
    v_exp_f32 v52, v52
    v_exp_f32 v53, v53
    v_exp_f32 v54, v54
    v_exp_f32 v55, v55
    v_smfmac_f32_32x32x32_bf16 v[16:31], v[96:99], v[32:39], v143
    v_exp_f32 v56, v56
    v_exp_f32 v57, v57
    v_exp_f32 v58, v58
    v_exp_f32 v59, v59
    v_smfmac_f32_32x32x32_bf16 v[16:31], v[100:103], v[40:47], v143
    v_exp_f32 v60, v60
    v_exp_f32 v61, v61
    v_exp_f32 v62, v62
    v_exp_f32 v63, v63
    s_waitcnt lgkmcnt(6)
    v_mfma_f32_32x32x16_bf16 v[32:47], v[80:83], v[128:131], 0
    v_exp_f32 v64, v64
    v_exp_f32 v65, v65
    v_exp_f32 v66, v66
    v_exp_f32 v67, v67
    s_waitcnt lgkmcnt(5)
    v_mfma_f32_32x32x8_bf16 v[32:47], v[92:93], v[132:133], v[32:47]
    v_exp_f32 v68, v68
    v_exp_f32 v69, v69
    v_exp_f32 v70, v70
    v_exp_f32 v71, v71
    v_smfmac_f32_32x32x32_bf16 v[0:15], v[104:107], v[48:55], v143
    v_exp_f32 v72, v72
    v_exp_f32 v73, v73
    v_exp_f32 v74, v74
    v_exp_f32 v75, v75
    v_smfmac_f32_32x32x32_bf16 v[0:15], v[108:111], v[56:63], v143
    v_exp_f32 v76, v76
    v_exp_f32 v77, v77
    v_exp_f32 v78, v78
    v_exp_f32 v79, v79
    v_mfma_f32_32x32x16_bf16 v[48:63], v[80:83], v[134:137], 0
    ds_read_b128 v[80:83], v140 offset:51200
    v_exp_f32 v32, v32
    v_exp_f32 v33, v33
    v_exp_f32 v34, v34
    v_exp_f32 v35, v35
    v_mfma_f32_32x32x8_bf16 v[48:63], v[92:93], v[138:139], v[48:63]
    ds_read2st64_b64 v[88:91], v141 offset0:100 offset1:105
    v_exp_f32 v36, v36
    v_exp_f32 v37, v37
    v_exp_f32 v38, v38
    v_exp_f32 v39, v39
    v_smfmac_f32_32x32x32_bf16 v[16:31], v[104:107], v[64:71], v143
    v_exp_f32 v40, v40
    v_exp_f32 v41, v41
    v_exp_f32 v42, v42
    v_exp_f32 v43, v43
    v_smfmac_f32_32x32x32_bf16 v[16:31], v[108:111], v[72:79], v143
    s_mov_b64 exec, s[76:77]
    ds_read_b128 v[96:99], v142 offset:51200
    ds_read_b128 v[100:103], v142 offset:52480
    ds_read_b128 v[104:107], v142 offset:53760
    ds_read_b128 v[108:111], v142 offset:55040
    s_mov_b64 exec, -1
    v_exp_f32 v44, v44
    v_exp_f32 v45, v45
    v_exp_f32 v46, v46
    v_exp_f32 v47, v47
    s_waitcnt lgkmcnt(6)
    v_mfma_f32_32x32x16_bf16 v[64:79], v[84:87], v[128:131], 0
    v_exp_f32 v48, v48
    v_exp_f32 v49, v49
    v_exp_f32 v50, v50
    v_exp_f32 v51, v51
    v_mfma_f32_32x32x8_bf16 v[64:79], v[94:95], v[132:133], v[64:79]
    v_exp_f32 v52, v52
    v_exp_f32 v53, v53
    v_exp_f32 v54, v54
    v_exp_f32 v55, v55
    v_smfmac_f32_32x32x32_bf16 v[0:15], v[112:115], v[32:39], v143
    v_exp_f32 v56, v56
    v_exp_f32 v57, v57
    v_exp_f32 v58, v58
    v_exp_f32 v59, v59
    v_smfmac_f32_32x32x32_bf16 v[0:15], v[116:119], v[40:47], v143
    v_exp_f32 v60, v60
    v_exp_f32 v61, v61
    v_exp_f32 v62, v62
    v_exp_f32 v63, v63
    v_mfma_f32_32x32x16_bf16 v[32:47], v[84:87], v[134:137], 0
    ds_read_b128 v[84:87], v140 offset:53760
    v_exp_f32 v64, v64
    v_exp_f32 v65, v65
    v_exp_f32 v66, v66
    v_exp_f32 v67, v67
    v_mfma_f32_32x32x8_bf16 v[32:47], v[94:95], v[138:139], v[32:47]
    v_exp_f32 v68, v68
    v_exp_f32 v69, v69
    v_exp_f32 v70, v70
    v_exp_f32 v71, v71
    v_smfmac_f32_32x32x32_bf16 v[16:31], v[112:115], v[48:55], v143
    v_exp_f32 v72, v72
    v_exp_f32 v73, v73
    v_exp_f32 v74, v74
    v_exp_f32 v75, v75
    v_smfmac_f32_32x32x32_bf16 v[16:31], v[116:119], v[56:63], v143
    v_exp_f32 v76, v76
    v_exp_f32 v77, v77
    v_exp_f32 v78, v78
    v_exp_f32 v79, v79
    s_waitcnt lgkmcnt(6)
    v_mfma_f32_32x32x16_bf16 v[48:63], v[80:83], v[128:131], 0
    v_exp_f32 v32, v32
    v_exp_f32 v33, v33
    v_exp_f32 v34, v34
    v_exp_f32 v35, v35
    s_waitcnt lgkmcnt(5)
    v_mfma_f32_32x32x8_bf16 v[48:63], v[88:89], v[132:133], v[48:63]
    v_exp_f32 v36, v36
    v_exp_f32 v37, v37
    v_exp_f32 v38, v38
    v_exp_f32 v39, v39
    v_smfmac_f32_32x32x32_bf16 v[0:15], v[120:123], v[64:71], v143
    v_exp_f32 v40, v40
    v_exp_f32 v41, v41
    v_exp_f32 v42, v42
    v_exp_f32 v43, v43
    v_smfmac_f32_32x32x32_bf16 v[0:15], v[124:127], v[72:79], v143
    v_exp_f32 v44, v44
    v_exp_f32 v45, v45
    v_exp_f32 v46, v46
    v_exp_f32 v47, v47
    v_mfma_f32_32x32x16_bf16 v[64:79], v[80:83], v[134:137], 0
    ds_read_b128 v[80:83], v140 offset:56320
    v_exp_f32 v48, v48
    v_exp_f32 v49, v49
    v_exp_f32 v50, v50
    v_exp_f32 v51, v51
    v_mfma_f32_32x32x8_bf16 v[64:79], v[88:89], v[138:139], v[64:79]
    ds_read2st64_b64 v[92:95], v141 offset0:110 offset1:115
    v_exp_f32 v52, v52
    v_exp_f32 v53, v53
    v_exp_f32 v54, v54
    v_exp_f32 v55, v55
    v_smfmac_f32_32x32x32_bf16 v[16:31], v[120:123], v[32:39], v143
    v_exp_f32 v56, v56
    v_exp_f32 v57, v57
    v_exp_f32 v58, v58
    v_exp_f32 v59, v59
    v_smfmac_f32_32x32x32_bf16 v[16:31], v[124:127], v[40:47], v143
    s_mov_b64 exec, s[76:77]
    ds_read_b128 v[112:115], v142 offset:56320
    ds_read_b128 v[116:119], v142 offset:57600
    ds_read_b128 v[120:123], v142 offset:58880
    ds_read_b128 v[124:127], v142 offset:60160
    s_mov_b64 exec, -1
    v_exp_f32 v60, v60
    v_exp_f32 v61, v61
    v_exp_f32 v62, v62
    v_exp_f32 v63, v63
    s_waitcnt lgkmcnt(6)
    v_mfma_f32_32x32x16_bf16 v[32:47], v[84:87], v[128:131], 0
    v_exp_f32 v64, v64
    v_exp_f32 v65, v65
    v_exp_f32 v66, v66
    v_exp_f32 v67, v67
    v_mfma_f32_32x32x8_bf16 v[32:47], v[90:91], v[132:133], v[32:47]
    v_exp_f32 v68, v68
    v_exp_f32 v69, v69
    v_exp_f32 v70, v70
    v_exp_f32 v71, v71
    v_smfmac_f32_32x32x32_bf16 v[0:15], v[96:99], v[48:55], v143
    v_exp_f32 v72, v72
    v_exp_f32 v73, v73
    v_exp_f32 v74, v74
    v_exp_f32 v75, v75
    v_smfmac_f32_32x32x32_bf16 v[0:15], v[100:103], v[56:63], v143
    v_exp_f32 v76, v76
    v_exp_f32 v77, v77
    v_exp_f32 v78, v78
    v_exp_f32 v79, v79
    v_mfma_f32_32x32x16_bf16 v[48:63], v[84:87], v[134:137], 0
    ds_read_b128 v[84:87], v140 offset:58880
    v_exp_f32 v32, v32
    v_exp_f32 v33, v33
    v_exp_f32 v34, v34
    v_exp_f32 v35, v35
    v_mfma_f32_32x32x8_bf16 v[48:63], v[90:91], v[138:139], v[48:63]
    v_exp_f32 v36, v36
    v_exp_f32 v37, v37
    v_exp_f32 v38, v38
    v_exp_f32 v39, v39
    v_smfmac_f32_32x32x32_bf16 v[16:31], v[96:99], v[64:71], v143
    v_exp_f32 v40, v40
    v_exp_f32 v41, v41
    v_exp_f32 v42, v42
    v_exp_f32 v43, v43
    v_smfmac_f32_32x32x32_bf16 v[16:31], v[100:103], v[72:79], v143
    v_exp_f32 v44, v44
    v_exp_f32 v45, v45
    v_exp_f32 v46, v46
    v_exp_f32 v47, v47
    s_waitcnt lgkmcnt(6)
    v_mfma_f32_32x32x16_bf16 v[64:79], v[80:83], v[128:131], 0
    v_exp_f32 v48, v48
    v_exp_f32 v49, v49
    v_exp_f32 v50, v50
    v_exp_f32 v51, v51
    s_waitcnt lgkmcnt(5)
    v_mfma_f32_32x32x8_bf16 v[64:79], v[92:93], v[132:133], v[64:79]
    v_exp_f32 v52, v52
    v_exp_f32 v53, v53
    v_exp_f32 v54, v54
    v_exp_f32 v55, v55
    v_smfmac_f32_32x32x32_bf16 v[0:15], v[104:107], v[32:39], v143
    v_exp_f32 v56, v56
    v_exp_f32 v57, v57
    v_exp_f32 v58, v58
    v_exp_f32 v59, v59
    v_smfmac_f32_32x32x32_bf16 v[0:15], v[108:111], v[40:47], v143
    v_exp_f32 v60, v60
    v_exp_f32 v61, v61
    v_exp_f32 v62, v62
    v_exp_f32 v63, v63
    v_mfma_f32_32x32x16_bf16 v[32:47], v[80:83], v[134:137], 0
    ds_read_b128 v[80:83], v140 offset:61440
    v_exp_f32 v64, v64
    v_exp_f32 v65, v65
    v_exp_f32 v66, v66
    v_exp_f32 v67, v67
    v_mfma_f32_32x32x8_bf16 v[32:47], v[92:93], v[138:139], v[32:47]
    ds_read2st64_b64 v[88:91], v141 offset0:120 offset1:125
    v_exp_f32 v68, v68
    v_exp_f32 v69, v69
    v_exp_f32 v70, v70
    v_exp_f32 v71, v71
    v_smfmac_f32_32x32x32_bf16 v[16:31], v[104:107], v[48:55], v143
    v_exp_f32 v72, v72
    v_exp_f32 v73, v73
    v_exp_f32 v74, v74
    v_exp_f32 v75, v75
    v_smfmac_f32_32x32x32_bf16 v[16:31], v[108:111], v[56:63], v143
    s_mov_b64 exec, s[76:77]
    ds_read_b128 v[96:99], v142 offset:61440
    ds_read_b128 v[100:103], v142 offset:62720
    ds_read_b128 v[104:107], v142 offset:64000
    ds_read_b128 v[108:111], v142 offset:65280
    s_mov_b64 exec, -1
    v_exp_f32 v76, v76
    v_exp_f32 v77, v77
    v_exp_f32 v78, v78
    v_exp_f32 v79, v79
    s_waitcnt lgkmcnt(6)
    v_mfma_f32_32x32x16_bf16 v[48:63], v[84:87], v[128:131], 0
    v_exp_f32 v32, v32
    v_exp_f32 v33, v33
    v_exp_f32 v34, v34
    v_exp_f32 v35, v35
    v_mfma_f32_32x32x8_bf16 v[48:63], v[94:95], v[132:133], v[48:63]
    v_exp_f32 v36, v36
    v_exp_f32 v37, v37
    v_exp_f32 v38, v38
    v_exp_f32 v39, v39
    v_smfmac_f32_32x32x32_bf16 v[0:15], v[112:115], v[64:71], v143
    v_exp_f32 v40, v40
    v_exp_f32 v41, v41
    v_exp_f32 v42, v42
    v_exp_f32 v43, v43
    v_smfmac_f32_32x32x32_bf16 v[0:15], v[116:119], v[72:79], v143
    v_exp_f32 v44, v44
    v_exp_f32 v45, v45
    v_exp_f32 v46, v46
    v_exp_f32 v47, v47
    v_mfma_f32_32x32x16_bf16 v[64:79], v[84:87], v[134:137], 0
    ds_read_b128 v[84:87], v140 offset:64000
    v_exp_f32 v48, v48
    v_exp_f32 v49, v49
    v_exp_f32 v50, v50
    v_exp_f32 v51, v51
    v_mfma_f32_32x32x8_bf16 v[64:79], v[94:95], v[138:139], v[64:79]
    v_exp_f32 v52, v52
    v_exp_f32 v53, v53
    v_exp_f32 v54, v54
    v_exp_f32 v55, v55
    v_smfmac_f32_32x32x32_bf16 v[16:31], v[112:115], v[32:39], v143
    v_exp_f32 v56, v56
    v_exp_f32 v57, v57
    v_exp_f32 v58, v58
    v_exp_f32 v59, v59
    v_smfmac_f32_32x32x32_bf16 v[16:31], v[116:119], v[40:47], v143
    v_exp_f32 v60, v60
    v_exp_f32 v61, v61
    v_exp_f32 v62, v62
    v_exp_f32 v63, v63
    s_waitcnt lgkmcnt(6)
    v_mfma_f32_32x32x16_bf16 v[32:47], v[80:83], v[128:131], 0
    v_exp_f32 v64, v64
    v_exp_f32 v65, v65
    v_exp_f32 v66, v66
    v_exp_f32 v67, v67
    s_waitcnt lgkmcnt(5)
    v_mfma_f32_32x32x8_bf16 v[32:47], v[88:89], v[132:133], v[32:47]
    v_exp_f32 v68, v68
    v_exp_f32 v69, v69
    v_exp_f32 v70, v70
    v_exp_f32 v71, v71
    v_smfmac_f32_32x32x32_bf16 v[0:15], v[120:123], v[48:55], v143
    v_exp_f32 v72, v72
    v_exp_f32 v73, v73
    v_exp_f32 v74, v74
    v_exp_f32 v75, v75
    v_smfmac_f32_32x32x32_bf16 v[0:15], v[124:127], v[56:63], v143
    v_exp_f32 v76, v76
    v_exp_f32 v77, v77
    v_exp_f32 v78, v78
    v_exp_f32 v79, v79
    v_mfma_f32_32x32x16_bf16 v[48:63], v[80:83], v[134:137], 0
    v_add_u32 v140, 66560, v140
    ds_read_b128 v[80:83], v140 offset:0
    v_exp_f32 v32, v32
    v_exp_f32 v33, v33
    v_exp_f32 v34, v34
    v_exp_f32 v35, v35
    v_mfma_f32_32x32x8_bf16 v[48:63], v[88:89], v[138:139], v[48:63]
    ds_read2st64_b64 v[92:95], v141 offset0:130 offset1:135
    v_exp_f32 v36, v36
    v_exp_f32 v37, v37
    v_exp_f32 v38, v38
    v_exp_f32 v39, v39
    v_smfmac_f32_32x32x32_bf16 v[16:31], v[120:123], v[64:71], v143
    v_exp_f32 v40, v40
    v_exp_f32 v41, v41
    v_exp_f32 v42, v42
    v_exp_f32 v43, v43
    v_smfmac_f32_32x32x32_bf16 v[16:31], v[124:127], v[72:79], v143
    v_add_u32 v142, 66560, v142
    s_mov_b64 exec, s[76:77]
    ds_read_b128 v[112:115], v142 offset:0
    ds_read_b128 v[116:119], v142 offset:1280
    ds_read_b128 v[120:123], v142 offset:2560
    ds_read_b128 v[124:127], v142 offset:3840
    s_mov_b64 exec, -1
    v_exp_f32 v44, v44
    v_exp_f32 v45, v45
    v_exp_f32 v46, v46
    v_exp_f32 v47, v47
    s_waitcnt lgkmcnt(6)
    v_mfma_f32_32x32x16_bf16 v[64:79], v[84:87], v[128:131], 0
    v_exp_f32 v48, v48
    v_exp_f32 v49, v49
    v_exp_f32 v50, v50
    v_exp_f32 v51, v51
    v_mfma_f32_32x32x8_bf16 v[64:79], v[90:91], v[132:133], v[64:79]
    v_exp_f32 v52, v52
    v_exp_f32 v53, v53
    v_exp_f32 v54, v54
    v_exp_f32 v55, v55
    v_smfmac_f32_32x32x32_bf16 v[0:15], v[96:99], v[32:39], v143
    v_exp_f32 v56, v56
    v_exp_f32 v57, v57
    v_exp_f32 v58, v58
    v_exp_f32 v59, v59
    v_smfmac_f32_32x32x32_bf16 v[0:15], v[100:103], v[40:47], v143
    v_exp_f32 v60, v60
    v_exp_f32 v61, v61
    v_exp_f32 v62, v62
    v_exp_f32 v63, v63
    v_mfma_f32_32x32x16_bf16 v[32:47], v[84:87], v[134:137], 0
    ds_read_b128 v[84:87], v140 offset:2560
    v_exp_f32 v64, v64
    v_exp_f32 v65, v65
    v_exp_f32 v66, v66
    v_exp_f32 v67, v67
    v_mfma_f32_32x32x8_bf16 v[32:47], v[90:91], v[138:139], v[32:47]
    v_exp_f32 v68, v68
    v_exp_f32 v69, v69
    v_exp_f32 v70, v70
    v_exp_f32 v71, v71
    v_smfmac_f32_32x32x32_bf16 v[16:31], v[96:99], v[48:55], v143
    v_exp_f32 v72, v72
    v_exp_f32 v73, v73
    v_exp_f32 v74, v74
    v_exp_f32 v75, v75
    v_smfmac_f32_32x32x32_bf16 v[16:31], v[100:103], v[56:63], v143
    v_exp_f32 v76, v76
    v_exp_f32 v77, v77
    v_exp_f32 v78, v78
    v_exp_f32 v79, v79
    s_waitcnt lgkmcnt(6)
    v_mfma_f32_32x32x16_bf16 v[48:63], v[80:83], v[128:131], 0
    v_exp_f32 v32, v32
    v_exp_f32 v33, v33
    v_exp_f32 v34, v34
    v_exp_f32 v35, v35
    s_waitcnt lgkmcnt(5)
    v_mfma_f32_32x32x8_bf16 v[48:63], v[92:93], v[132:133], v[48:63]
    v_exp_f32 v36, v36
    v_exp_f32 v37, v37
    v_exp_f32 v38, v38
    v_exp_f32 v39, v39
    v_smfmac_f32_32x32x32_bf16 v[0:15], v[104:107], v[64:71], v143
    v_exp_f32 v40, v40
    v_exp_f32 v41, v41
    v_exp_f32 v42, v42
    v_exp_f32 v43, v43
    v_smfmac_f32_32x32x32_bf16 v[0:15], v[108:111], v[72:79], v143
    v_exp_f32 v44, v44
    v_exp_f32 v45, v45
    v_exp_f32 v46, v46
    v_exp_f32 v47, v47
    v_mfma_f32_32x32x16_bf16 v[64:79], v[80:83], v[134:137], 0
    ds_read_b128 v[80:83], v140 offset:5120
    v_exp_f32 v48, v48
    v_exp_f32 v49, v49
    v_exp_f32 v50, v50
    v_exp_f32 v51, v51
    v_mfma_f32_32x32x8_bf16 v[64:79], v[92:93], v[138:139], v[64:79]
    ds_read2st64_b64 v[88:91], v141 offset0:140 offset1:145
    v_exp_f32 v52, v52
    v_exp_f32 v53, v53
    v_exp_f32 v54, v54
    v_exp_f32 v55, v55
    v_smfmac_f32_32x32x32_bf16 v[16:31], v[104:107], v[32:39], v143
    v_exp_f32 v56, v56
    v_exp_f32 v57, v57
    v_exp_f32 v58, v58
    v_exp_f32 v59, v59
    v_smfmac_f32_32x32x32_bf16 v[16:31], v[108:111], v[40:47], v143
    s_mov_b64 exec, s[76:77]
    ds_read_b128 v[96:99], v142 offset:5120
    ds_read_b128 v[100:103], v142 offset:6400
    ds_read_b128 v[104:107], v142 offset:7680
    ds_read_b128 v[108:111], v142 offset:8960
    s_mov_b64 exec, -1
    v_exp_f32 v60, v60
    v_exp_f32 v61, v61
    v_exp_f32 v62, v62
    v_exp_f32 v63, v63
    s_waitcnt lgkmcnt(6)
    v_mfma_f32_32x32x16_bf16 v[32:47], v[84:87], v[128:131], 0
    v_exp_f32 v64, v64
    v_exp_f32 v65, v65
    v_exp_f32 v66, v66
    v_exp_f32 v67, v67
    v_mfma_f32_32x32x8_bf16 v[32:47], v[94:95], v[132:133], v[32:47]
    v_exp_f32 v68, v68
    v_exp_f32 v69, v69
    v_exp_f32 v70, v70
    v_exp_f32 v71, v71
    v_smfmac_f32_32x32x32_bf16 v[0:15], v[112:115], v[48:55], v143
    v_exp_f32 v72, v72
    v_exp_f32 v73, v73
    v_exp_f32 v74, v74
    v_exp_f32 v75, v75
    v_smfmac_f32_32x32x32_bf16 v[0:15], v[116:119], v[56:63], v143
    v_exp_f32 v76, v76
    v_exp_f32 v77, v77
    v_exp_f32 v78, v78
    v_exp_f32 v79, v79
    v_mfma_f32_32x32x16_bf16 v[48:63], v[84:87], v[134:137], 0
    ds_read_b128 v[84:87], v140 offset:7680
    v_exp_f32 v32, v32
    v_exp_f32 v33, v33
    v_exp_f32 v34, v34
    v_exp_f32 v35, v35
    v_mfma_f32_32x32x8_bf16 v[48:63], v[94:95], v[138:139], v[48:63]
    v_exp_f32 v36, v36
    v_exp_f32 v37, v37
    v_exp_f32 v38, v38
    v_exp_f32 v39, v39
    v_smfmac_f32_32x32x32_bf16 v[16:31], v[112:115], v[64:71], v143
    v_exp_f32 v40, v40
    v_exp_f32 v41, v41
    v_exp_f32 v42, v42
    v_exp_f32 v43, v43
    v_smfmac_f32_32x32x32_bf16 v[16:31], v[116:119], v[72:79], v143
    v_exp_f32 v44, v44
    v_exp_f32 v45, v45
    v_exp_f32 v46, v46
    v_exp_f32 v47, v47
    s_waitcnt lgkmcnt(6)
    v_mfma_f32_32x32x16_bf16 v[64:79], v[80:83], v[128:131], 0
    v_exp_f32 v48, v48
    v_exp_f32 v49, v49
    v_exp_f32 v50, v50
    v_exp_f32 v51, v51
    s_waitcnt lgkmcnt(5)
    v_mfma_f32_32x32x8_bf16 v[64:79], v[88:89], v[132:133], v[64:79]
    v_exp_f32 v52, v52
    v_exp_f32 v53, v53
    v_exp_f32 v54, v54
    v_exp_f32 v55, v55
    v_smfmac_f32_32x32x32_bf16 v[0:15], v[120:123], v[32:39], v143
    v_exp_f32 v56, v56
    v_exp_f32 v57, v57
    v_exp_f32 v58, v58
    v_exp_f32 v59, v59
    v_smfmac_f32_32x32x32_bf16 v[0:15], v[124:127], v[40:47], v143
    v_exp_f32 v60, v60
    v_exp_f32 v61, v61
    v_exp_f32 v62, v62
    v_exp_f32 v63, v63
    v_mfma_f32_32x32x16_bf16 v[32:47], v[80:83], v[134:137], 0
    ds_read_b128 v[80:83], v140 offset:10240
    v_exp_f32 v64, v64
    v_exp_f32 v65, v65
    v_exp_f32 v66, v66
    v_exp_f32 v67, v67
    v_mfma_f32_32x32x8_bf16 v[32:47], v[88:89], v[138:139], v[32:47]
    ds_read2st64_b64 v[92:95], v141 offset0:150 offset1:155
    v_exp_f32 v68, v68
    v_exp_f32 v69, v69
    v_exp_f32 v70, v70
    v_exp_f32 v71, v71
    v_smfmac_f32_32x32x32_bf16 v[16:31], v[120:123], v[48:55], v143
    v_exp_f32 v72, v72
    v_exp_f32 v73, v73
    v_exp_f32 v74, v74
    v_exp_f32 v75, v75
    v_smfmac_f32_32x32x32_bf16 v[16:31], v[124:127], v[56:63], v143
    s_mov_b64 exec, s[76:77]
    ds_read_b128 v[112:115], v142 offset:10240
    ds_read_b128 v[116:119], v142 offset:11520
    ds_read_b128 v[120:123], v142 offset:12800
    ds_read_b128 v[124:127], v142 offset:14080
    s_mov_b64 exec, -1
    v_exp_f32 v76, v76
    v_exp_f32 v77, v77
    v_exp_f32 v78, v78
    v_exp_f32 v79, v79
    s_waitcnt lgkmcnt(6)
    v_mfma_f32_32x32x16_bf16 v[48:63], v[84:87], v[128:131], 0
    v_exp_f32 v32, v32
    v_exp_f32 v33, v33
    v_exp_f32 v34, v34
    v_exp_f32 v35, v35
    v_mfma_f32_32x32x8_bf16 v[48:63], v[90:91], v[132:133], v[48:63]
    v_exp_f32 v36, v36
    v_exp_f32 v37, v37
    v_exp_f32 v38, v38
    v_exp_f32 v39, v39
    v_smfmac_f32_32x32x32_bf16 v[0:15], v[96:99], v[64:71], v143
    v_exp_f32 v40, v40
    v_exp_f32 v41, v41
    v_exp_f32 v42, v42
    v_exp_f32 v43, v43
    v_smfmac_f32_32x32x32_bf16 v[0:15], v[100:103], v[72:79], v143
    v_exp_f32 v44, v44
    v_exp_f32 v45, v45
    v_exp_f32 v46, v46
    v_exp_f32 v47, v47
    v_mfma_f32_32x32x16_bf16 v[64:79], v[84:87], v[134:137], 0
    ds_read_b128 v[84:87], v140 offset:12800
    v_exp_f32 v48, v48
    v_exp_f32 v49, v49
    v_exp_f32 v50, v50
    v_exp_f32 v51, v51
    v_mfma_f32_32x32x8_bf16 v[64:79], v[90:91], v[138:139], v[64:79]
    v_exp_f32 v52, v52
    v_exp_f32 v53, v53
    v_exp_f32 v54, v54
    v_exp_f32 v55, v55
    v_smfmac_f32_32x32x32_bf16 v[16:31], v[96:99], v[32:39], v143
    v_exp_f32 v56, v56
    v_exp_f32 v57, v57
    v_exp_f32 v58, v58
    v_exp_f32 v59, v59
    v_smfmac_f32_32x32x32_bf16 v[16:31], v[100:103], v[40:47], v143
    v_exp_f32 v60, v60
    v_exp_f32 v61, v61
    v_exp_f32 v62, v62
    v_exp_f32 v63, v63
    s_waitcnt lgkmcnt(6)
    v_mfma_f32_32x32x16_bf16 v[32:47], v[80:83], v[128:131], 0
    v_exp_f32 v64, v64
    v_exp_f32 v65, v65
    v_exp_f32 v66, v66
    v_exp_f32 v67, v67
    s_waitcnt lgkmcnt(5)
    v_mfma_f32_32x32x8_bf16 v[32:47], v[92:93], v[132:133], v[32:47]
    v_exp_f32 v68, v68
    v_exp_f32 v69, v69
    v_exp_f32 v70, v70
    v_exp_f32 v71, v71
    v_smfmac_f32_32x32x32_bf16 v[0:15], v[104:107], v[48:55], v143
    v_exp_f32 v72, v72
    v_exp_f32 v73, v73
    v_exp_f32 v74, v74
    v_exp_f32 v75, v75
    v_smfmac_f32_32x32x32_bf16 v[0:15], v[108:111], v[56:63], v143
    v_exp_f32 v76, v76
    v_exp_f32 v77, v77
    v_exp_f32 v78, v78
    v_exp_f32 v79, v79
    v_mfma_f32_32x32x16_bf16 v[48:63], v[80:83], v[134:137], 0
    ds_read_b128 v[80:83], v140 offset:15360
    v_exp_f32 v32, v32
    v_exp_f32 v33, v33
    v_exp_f32 v34, v34
    v_exp_f32 v35, v35
    v_mfma_f32_32x32x8_bf16 v[48:63], v[92:93], v[138:139], v[48:63]
    ds_read2st64_b64 v[88:91], v141 offset0:160 offset1:165
    v_exp_f32 v36, v36
    v_exp_f32 v37, v37
    v_exp_f32 v38, v38
    v_exp_f32 v39, v39
    v_smfmac_f32_32x32x32_bf16 v[16:31], v[104:107], v[64:71], v143
    v_exp_f32 v40, v40
    v_exp_f32 v41, v41
    v_exp_f32 v42, v42
    v_exp_f32 v43, v43
    v_smfmac_f32_32x32x32_bf16 v[16:31], v[108:111], v[72:79], v143
    s_mov_b64 exec, s[76:77]
    ds_read_b128 v[96:99], v142 offset:15360
    ds_read_b128 v[100:103], v142 offset:16640
    ds_read_b128 v[104:107], v142 offset:17920
    ds_read_b128 v[108:111], v142 offset:19200
    s_mov_b64 exec, -1
    v_exp_f32 v44, v44
    v_exp_f32 v45, v45
    v_exp_f32 v46, v46
    v_exp_f32 v47, v47
    s_waitcnt lgkmcnt(6)
    v_mfma_f32_32x32x16_bf16 v[64:79], v[84:87], v[128:131], 0
    v_exp_f32 v48, v48
    v_exp_f32 v49, v49
    v_exp_f32 v50, v50
    v_exp_f32 v51, v51
    v_mfma_f32_32x32x8_bf16 v[64:79], v[94:95], v[132:133], v[64:79]
    v_exp_f32 v52, v52
    v_exp_f32 v53, v53
    v_exp_f32 v54, v54
    v_exp_f32 v55, v55
    v_smfmac_f32_32x32x32_bf16 v[0:15], v[112:115], v[32:39], v143
    v_exp_f32 v56, v56
    v_exp_f32 v57, v57
    v_exp_f32 v58, v58
    v_exp_f32 v59, v59
    v_smfmac_f32_32x32x32_bf16 v[0:15], v[116:119], v[40:47], v143
    v_exp_f32 v60, v60
    v_exp_f32 v61, v61
    v_exp_f32 v62, v62
    v_exp_f32 v63, v63
    v_mfma_f32_32x32x16_bf16 v[32:47], v[84:87], v[134:137], 0
    ds_read_b128 v[84:87], v140 offset:17920
    v_exp_f32 v64, v64
    v_exp_f32 v65, v65
    v_exp_f32 v66, v66
    v_exp_f32 v67, v67
    v_mfma_f32_32x32x8_bf16 v[32:47], v[94:95], v[138:139], v[32:47]
    v_exp_f32 v68, v68
    v_exp_f32 v69, v69
    v_exp_f32 v70, v70
    v_exp_f32 v71, v71
    v_smfmac_f32_32x32x32_bf16 v[16:31], v[112:115], v[48:55], v143
    v_exp_f32 v72, v72
    v_exp_f32 v73, v73
    v_exp_f32 v74, v74
    v_exp_f32 v75, v75
    v_smfmac_f32_32x32x32_bf16 v[16:31], v[116:119], v[56:63], v143
    v_exp_f32 v76, v76
    v_exp_f32 v77, v77
    v_exp_f32 v78, v78
    v_exp_f32 v79, v79
    s_waitcnt lgkmcnt(6)
    v_mfma_f32_32x32x16_bf16 v[48:63], v[80:83], v[128:131], 0
    v_exp_f32 v32, v32
    v_exp_f32 v33, v33
    v_exp_f32 v34, v34
    v_exp_f32 v35, v35
    s_waitcnt lgkmcnt(5)
    v_mfma_f32_32x32x8_bf16 v[48:63], v[88:89], v[132:133], v[48:63]
    v_exp_f32 v36, v36
    v_exp_f32 v37, v37
    v_exp_f32 v38, v38
    v_exp_f32 v39, v39
    v_smfmac_f32_32x32x32_bf16 v[0:15], v[120:123], v[64:71], v143
    v_exp_f32 v40, v40
    v_exp_f32 v41, v41
    v_exp_f32 v42, v42
    v_exp_f32 v43, v43
    v_smfmac_f32_32x32x32_bf16 v[0:15], v[124:127], v[72:79], v143
    v_exp_f32 v44, v44
    v_exp_f32 v45, v45
    v_exp_f32 v46, v46
    v_exp_f32 v47, v47
    v_mfma_f32_32x32x16_bf16 v[64:79], v[80:83], v[134:137], 0
    ds_read_b128 v[80:83], v140 offset:20480
    v_exp_f32 v48, v48
    v_exp_f32 v49, v49
    v_exp_f32 v50, v50
    v_exp_f32 v51, v51
    v_mfma_f32_32x32x8_bf16 v[64:79], v[88:89], v[138:139], v[64:79]
    ds_read2st64_b64 v[92:95], v141 offset0:170 offset1:175
    v_exp_f32 v52, v52
    v_exp_f32 v53, v53
    v_exp_f32 v54, v54
    v_exp_f32 v55, v55
    v_smfmac_f32_32x32x32_bf16 v[16:31], v[120:123], v[32:39], v143
    v_exp_f32 v56, v56
    v_exp_f32 v57, v57
    v_exp_f32 v58, v58
    v_exp_f32 v59, v59
    v_smfmac_f32_32x32x32_bf16 v[16:31], v[124:127], v[40:47], v143
    s_mov_b64 exec, s[76:77]
    ds_read_b128 v[112:115], v142 offset:20480
    ds_read_b128 v[116:119], v142 offset:21760
    ds_read_b128 v[120:123], v142 offset:23040
    ds_read_b128 v[124:127], v142 offset:24320
    s_mov_b64 exec, -1
    v_exp_f32 v60, v60
    v_exp_f32 v61, v61
    v_exp_f32 v62, v62
    v_exp_f32 v63, v63
    s_waitcnt lgkmcnt(6)
    v_mfma_f32_32x32x16_bf16 v[32:47], v[84:87], v[128:131], 0
    v_exp_f32 v64, v64
    v_exp_f32 v65, v65
    v_exp_f32 v66, v66
    v_exp_f32 v67, v67
    v_mfma_f32_32x32x8_bf16 v[32:47], v[90:91], v[132:133], v[32:47]
    v_exp_f32 v68, v68
    v_exp_f32 v69, v69
    v_exp_f32 v70, v70
    v_exp_f32 v71, v71
    v_smfmac_f32_32x32x32_bf16 v[0:15], v[96:99], v[48:55], v143
    v_exp_f32 v72, v72
    v_exp_f32 v73, v73
    v_exp_f32 v74, v74
    v_exp_f32 v75, v75
    v_smfmac_f32_32x32x32_bf16 v[0:15], v[100:103], v[56:63], v143
    v_exp_f32 v76, v76
    v_exp_f32 v77, v77
    v_exp_f32 v78, v78
    v_exp_f32 v79, v79
    v_mfma_f32_32x32x16_bf16 v[48:63], v[84:87], v[134:137], 0
    ds_read_b128 v[84:87], v140 offset:23040
    v_exp_f32 v32, v32
    v_exp_f32 v33, v33
    v_exp_f32 v34, v34
    v_exp_f32 v35, v35
    v_mfma_f32_32x32x8_bf16 v[48:63], v[90:91], v[138:139], v[48:63]
    v_exp_f32 v36, v36
    v_exp_f32 v37, v37
    v_exp_f32 v38, v38
    v_exp_f32 v39, v39
    v_smfmac_f32_32x32x32_bf16 v[16:31], v[96:99], v[64:71], v143
    v_exp_f32 v40, v40
    v_exp_f32 v41, v41
    v_exp_f32 v42, v42
    v_exp_f32 v43, v43
    v_smfmac_f32_32x32x32_bf16 v[16:31], v[100:103], v[72:79], v143
    v_exp_f32 v44, v44
    v_exp_f32 v45, v45
    v_exp_f32 v46, v46
    v_exp_f32 v47, v47
    s_waitcnt lgkmcnt(6)
    v_mfma_f32_32x32x16_bf16 v[64:79], v[80:83], v[128:131], 0
    v_exp_f32 v48, v48
    v_exp_f32 v49, v49
    v_exp_f32 v50, v50
    v_exp_f32 v51, v51
    s_waitcnt lgkmcnt(5)
    v_mfma_f32_32x32x8_bf16 v[64:79], v[92:93], v[132:133], v[64:79]
    v_exp_f32 v52, v52
    v_exp_f32 v53, v53
    v_exp_f32 v54, v54
    v_exp_f32 v55, v55
    v_smfmac_f32_32x32x32_bf16 v[0:15], v[104:107], v[32:39], v143
    v_exp_f32 v56, v56
    v_exp_f32 v57, v57
    v_exp_f32 v58, v58
    v_exp_f32 v59, v59
    v_smfmac_f32_32x32x32_bf16 v[0:15], v[108:111], v[40:47], v143
    v_exp_f32 v60, v60
    v_exp_f32 v61, v61
    v_exp_f32 v62, v62
    v_exp_f32 v63, v63
    v_mfma_f32_32x32x16_bf16 v[32:47], v[80:83], v[134:137], 0
    ds_read_b128 v[80:83], v140 offset:25600
    v_exp_f32 v64, v64
    v_exp_f32 v65, v65
    v_exp_f32 v66, v66
    v_exp_f32 v67, v67
    v_mfma_f32_32x32x8_bf16 v[32:47], v[92:93], v[138:139], v[32:47]
    ds_read2st64_b64 v[88:91], v141 offset0:180 offset1:185
    v_exp_f32 v68, v68
    v_exp_f32 v69, v69
    v_exp_f32 v70, v70
    v_exp_f32 v71, v71
    v_smfmac_f32_32x32x32_bf16 v[16:31], v[104:107], v[48:55], v143
    v_exp_f32 v72, v72
    v_exp_f32 v73, v73
    v_exp_f32 v74, v74
    v_exp_f32 v75, v75
    v_smfmac_f32_32x32x32_bf16 v[16:31], v[108:111], v[56:63], v143
    s_mov_b64 exec, s[76:77]
    ds_read_b128 v[96:99], v142 offset:25600
    ds_read_b128 v[100:103], v142 offset:26880
    ds_read_b128 v[104:107], v142 offset:28160
    ds_read_b128 v[108:111], v142 offset:29440
    s_mov_b64 exec, -1
    v_exp_f32 v76, v76
    v_exp_f32 v77, v77
    v_exp_f32 v78, v78
    v_exp_f32 v79, v79
    s_waitcnt lgkmcnt(6)
    v_mfma_f32_32x32x16_bf16 v[48:63], v[84:87], v[128:131], 0
    v_exp_f32 v32, v32
    v_exp_f32 v33, v33
    v_exp_f32 v34, v34
    v_exp_f32 v35, v35
    v_mfma_f32_32x32x8_bf16 v[48:63], v[94:95], v[132:133], v[48:63]
    v_exp_f32 v36, v36
    v_exp_f32 v37, v37
    v_exp_f32 v38, v38
    v_exp_f32 v39, v39
    v_smfmac_f32_32x32x32_bf16 v[0:15], v[112:115], v[64:71], v143
    v_exp_f32 v40, v40
    v_exp_f32 v41, v41
    v_exp_f32 v42, v42
    v_exp_f32 v43, v43
    v_smfmac_f32_32x32x32_bf16 v[0:15], v[116:119], v[72:79], v143
    v_exp_f32 v44, v44
    v_exp_f32 v45, v45
    v_exp_f32 v46, v46
    v_exp_f32 v47, v47
    v_mfma_f32_32x32x16_bf16 v[64:79], v[84:87], v[134:137], 0
    ds_read_b128 v[84:87], v140 offset:28160
    v_exp_f32 v48, v48
    v_exp_f32 v49, v49
    v_exp_f32 v50, v50
    v_exp_f32 v51, v51
    v_mfma_f32_32x32x8_bf16 v[64:79], v[94:95], v[138:139], v[64:79]
    v_exp_f32 v52, v52
    v_exp_f32 v53, v53
    v_exp_f32 v54, v54
    v_exp_f32 v55, v55
    v_smfmac_f32_32x32x32_bf16 v[16:31], v[112:115], v[32:39], v143
    v_exp_f32 v56, v56
    v_exp_f32 v57, v57
    v_exp_f32 v58, v58
    v_exp_f32 v59, v59
    v_smfmac_f32_32x32x32_bf16 v[16:31], v[116:119], v[40:47], v143
    v_exp_f32 v60, v60
    v_exp_f32 v61, v61
    v_exp_f32 v62, v62
    v_exp_f32 v63, v63
    s_waitcnt lgkmcnt(6)
    v_mfma_f32_32x32x16_bf16 v[32:47], v[80:83], v[128:131], 0
    v_exp_f32 v64, v64
    v_exp_f32 v65, v65
    v_exp_f32 v66, v66
    v_exp_f32 v67, v67
    s_waitcnt lgkmcnt(5)
    v_mfma_f32_32x32x8_bf16 v[32:47], v[88:89], v[132:133], v[32:47]
    v_exp_f32 v68, v68
    v_exp_f32 v69, v69
    v_exp_f32 v70, v70
    v_exp_f32 v71, v71
    v_smfmac_f32_32x32x32_bf16 v[0:15], v[120:123], v[48:55], v143
    v_exp_f32 v72, v72
    v_exp_f32 v73, v73
    v_exp_f32 v74, v74
    v_exp_f32 v75, v75
    v_smfmac_f32_32x32x32_bf16 v[0:15], v[124:127], v[56:63], v143
    v_exp_f32 v76, v76
    v_exp_f32 v77, v77
    v_exp_f32 v78, v78
    v_exp_f32 v79, v79
    v_mfma_f32_32x32x16_bf16 v[48:63], v[80:83], v[134:137], 0
    ds_read_b128 v[80:83], v140 offset:30720
    v_exp_f32 v32, v32
    v_exp_f32 v33, v33
    v_exp_f32 v34, v34
    v_exp_f32 v35, v35
    v_mfma_f32_32x32x8_bf16 v[48:63], v[88:89], v[138:139], v[48:63]
    ds_read2st64_b64 v[92:95], v141 offset0:190 offset1:195
    v_exp_f32 v36, v36
    v_exp_f32 v37, v37
    v_exp_f32 v38, v38
    v_exp_f32 v39, v39
    v_smfmac_f32_32x32x32_bf16 v[16:31], v[120:123], v[64:71], v143
    v_exp_f32 v40, v40
    v_exp_f32 v41, v41
    v_exp_f32 v42, v42
    v_exp_f32 v43, v43
    v_smfmac_f32_32x32x32_bf16 v[16:31], v[124:127], v[72:79], v143
    s_mov_b64 exec, s[76:77]
    ds_read_b128 v[112:115], v142 offset:30720
    ds_read_b128 v[116:119], v142 offset:32000
    ds_read_b128 v[120:123], v142 offset:33280
    ds_read_b128 v[124:127], v142 offset:34560
    s_mov_b64 exec, -1
    v_exp_f32 v44, v44
    v_exp_f32 v45, v45
    v_exp_f32 v46, v46
    v_exp_f32 v47, v47
    s_waitcnt lgkmcnt(6)
    v_mfma_f32_32x32x16_bf16 v[64:79], v[84:87], v[128:131], 0
    v_exp_f32 v48, v48
    v_exp_f32 v49, v49
    v_exp_f32 v50, v50
    v_exp_f32 v51, v51
    v_mfma_f32_32x32x8_bf16 v[64:79], v[90:91], v[132:133], v[64:79]
    v_exp_f32 v52, v52
    v_exp_f32 v53, v53
    v_exp_f32 v54, v54
    v_exp_f32 v55, v55
    v_smfmac_f32_32x32x32_bf16 v[0:15], v[96:99], v[32:39], v143
    v_exp_f32 v56, v56
    v_exp_f32 v57, v57
    v_exp_f32 v58, v58
    v_exp_f32 v59, v59
    v_smfmac_f32_32x32x32_bf16 v[0:15], v[100:103], v[40:47], v143
    v_exp_f32 v60, v60
    v_exp_f32 v61, v61
    v_exp_f32 v62, v62
    v_exp_f32 v63, v63
    v_mfma_f32_32x32x16_bf16 v[32:47], v[84:87], v[134:137], 0
    ds_read_b128 v[84:87], v140 offset:33280
    v_exp_f32 v64, v64
    v_exp_f32 v65, v65
    v_exp_f32 v66, v66
    v_exp_f32 v67, v67
    v_mfma_f32_32x32x8_bf16 v[32:47], v[90:91], v[138:139], v[32:47]
    v_exp_f32 v68, v68
    v_exp_f32 v69, v69
    v_exp_f32 v70, v70
    v_exp_f32 v71, v71
    v_smfmac_f32_32x32x32_bf16 v[16:31], v[96:99], v[48:55], v143
    v_exp_f32 v72, v72
    v_exp_f32 v73, v73
    v_exp_f32 v74, v74
    v_exp_f32 v75, v75
    v_smfmac_f32_32x32x32_bf16 v[16:31], v[100:103], v[56:63], v143
    v_exp_f32 v76, v76
    v_exp_f32 v77, v77
    v_exp_f32 v78, v78
    v_exp_f32 v79, v79
    s_waitcnt lgkmcnt(6)
    v_mfma_f32_32x32x16_bf16 v[48:63], v[80:83], v[128:131], 0
    v_exp_f32 v32, v32
    v_exp_f32 v33, v33
    v_exp_f32 v34, v34
    v_exp_f32 v35, v35
    s_waitcnt lgkmcnt(5)
    v_mfma_f32_32x32x8_bf16 v[48:63], v[92:93], v[132:133], v[48:63]
    v_exp_f32 v36, v36
    v_exp_f32 v37, v37
    v_exp_f32 v38, v38
    v_exp_f32 v39, v39
    v_smfmac_f32_32x32x32_bf16 v[0:15], v[104:107], v[64:71], v143
    v_exp_f32 v40, v40
    v_exp_f32 v41, v41
    v_exp_f32 v42, v42
    v_exp_f32 v43, v43
    v_smfmac_f32_32x32x32_bf16 v[0:15], v[108:111], v[72:79], v143
    v_exp_f32 v44, v44
    v_exp_f32 v45, v45
    v_exp_f32 v46, v46
    v_exp_f32 v47, v47
    v_mfma_f32_32x32x16_bf16 v[64:79], v[80:83], v[134:137], 0
    ds_read_b128 v[80:83], v140 offset:35840
    v_exp_f32 v48, v48
    v_exp_f32 v49, v49
    v_exp_f32 v50, v50
    v_exp_f32 v51, v51
    v_mfma_f32_32x32x8_bf16 v[64:79], v[92:93], v[138:139], v[64:79]
    ds_read2st64_b64 v[88:91], v141 offset0:200 offset1:205
    v_exp_f32 v52, v52
    v_exp_f32 v53, v53
    v_exp_f32 v54, v54
    v_exp_f32 v55, v55
    v_smfmac_f32_32x32x32_bf16 v[16:31], v[104:107], v[32:39], v143
    v_exp_f32 v56, v56
    v_exp_f32 v57, v57
    v_exp_f32 v58, v58
    v_exp_f32 v59, v59
    v_smfmac_f32_32x32x32_bf16 v[16:31], v[108:111], v[40:47], v143
    s_mov_b64 exec, s[76:77]
    ds_read_b128 v[96:99], v142 offset:35840
    ds_read_b128 v[100:103], v142 offset:37120
    ds_read_b128 v[104:107], v142 offset:38400
    ds_read_b128 v[108:111], v142 offset:39680
    s_mov_b64 exec, -1
    v_exp_f32 v60, v60
    v_exp_f32 v61, v61
    v_exp_f32 v62, v62
    v_exp_f32 v63, v63
    s_waitcnt lgkmcnt(6)
    v_mfma_f32_32x32x16_bf16 v[32:47], v[84:87], v[128:131], 0
    v_exp_f32 v64, v64
    v_exp_f32 v65, v65
    v_exp_f32 v66, v66
    v_exp_f32 v67, v67
    v_mfma_f32_32x32x8_bf16 v[32:47], v[94:95], v[132:133], v[32:47]
    v_exp_f32 v68, v68
    v_exp_f32 v69, v69
    v_exp_f32 v70, v70
    v_exp_f32 v71, v71
    v_smfmac_f32_32x32x32_bf16 v[0:15], v[112:115], v[48:55], v143
    v_exp_f32 v72, v72
    v_exp_f32 v73, v73
    v_exp_f32 v74, v74
    v_exp_f32 v75, v75
    v_smfmac_f32_32x32x32_bf16 v[0:15], v[116:119], v[56:63], v143
    v_exp_f32 v76, v76
    v_exp_f32 v77, v77
    v_exp_f32 v78, v78
    v_exp_f32 v79, v79
    v_mfma_f32_32x32x16_bf16 v[48:63], v[84:87], v[134:137], 0
    ds_read_b128 v[84:87], v140 offset:38400
    v_exp_f32 v32, v32
    v_exp_f32 v33, v33
    v_exp_f32 v34, v34
    v_exp_f32 v35, v35
    v_mfma_f32_32x32x8_bf16 v[48:63], v[94:95], v[138:139], v[48:63]
    v_exp_f32 v36, v36
    v_exp_f32 v37, v37
    v_exp_f32 v38, v38
    v_exp_f32 v39, v39
    v_smfmac_f32_32x32x32_bf16 v[16:31], v[112:115], v[64:71], v143
    v_exp_f32 v40, v40
    v_exp_f32 v41, v41
    v_exp_f32 v42, v42
    v_exp_f32 v43, v43
    v_smfmac_f32_32x32x32_bf16 v[16:31], v[116:119], v[72:79], v143
    v_exp_f32 v44, v44
    v_exp_f32 v45, v45
    v_exp_f32 v46, v46
    v_exp_f32 v47, v47
    s_waitcnt lgkmcnt(6)
    v_mfma_f32_32x32x16_bf16 v[64:79], v[80:83], v[128:131], 0
    v_exp_f32 v48, v48
    v_exp_f32 v49, v49
    v_exp_f32 v50, v50
    v_exp_f32 v51, v51
    s_waitcnt lgkmcnt(5)
    v_mfma_f32_32x32x8_bf16 v[64:79], v[88:89], v[132:133], v[64:79]
    v_exp_f32 v52, v52
    v_exp_f32 v53, v53
    v_exp_f32 v54, v54
    v_exp_f32 v55, v55
    v_smfmac_f32_32x32x32_bf16 v[0:15], v[120:123], v[32:39], v143
    v_exp_f32 v56, v56
    v_exp_f32 v57, v57
    v_exp_f32 v58, v58
    v_exp_f32 v59, v59
    v_smfmac_f32_32x32x32_bf16 v[0:15], v[124:127], v[40:47], v143
    v_exp_f32 v60, v60
    v_exp_f32 v61, v61
    v_exp_f32 v62, v62
    v_exp_f32 v63, v63
    v_mfma_f32_32x32x16_bf16 v[32:47], v[80:83], v[134:137], 0
    ds_read_b128 v[80:83], v140 offset:40960
    v_exp_f32 v64, v64
    v_exp_f32 v65, v65
    v_exp_f32 v66, v66
    v_exp_f32 v67, v67
    v_mfma_f32_32x32x8_bf16 v[32:47], v[88:89], v[138:139], v[32:47]
    ds_read2st64_b64 v[92:95], v141 offset0:210 offset1:215
    v_exp_f32 v68, v68
    v_exp_f32 v69, v69
    v_exp_f32 v70, v70
    v_exp_f32 v71, v71
    v_smfmac_f32_32x32x32_bf16 v[16:31], v[120:123], v[48:55], v143
    v_exp_f32 v72, v72
    v_exp_f32 v73, v73
    v_exp_f32 v74, v74
    v_exp_f32 v75, v75
    v_smfmac_f32_32x32x32_bf16 v[16:31], v[124:127], v[56:63], v143
    s_mov_b64 exec, s[76:77]
    ds_read_b128 v[112:115], v142 offset:40960
    ds_read_b128 v[116:119], v142 offset:42240
    ds_read_b128 v[120:123], v142 offset:43520
    ds_read_b128 v[124:127], v142 offset:44800
    s_mov_b64 exec, -1
    v_exp_f32 v76, v76
    v_exp_f32 v77, v77
    v_exp_f32 v78, v78
    v_exp_f32 v79, v79
    s_waitcnt lgkmcnt(6)
    v_mfma_f32_32x32x16_bf16 v[48:63], v[84:87], v[128:131], 0
    v_exp_f32 v32, v32
    v_exp_f32 v33, v33
    v_exp_f32 v34, v34
    v_exp_f32 v35, v35
    v_mfma_f32_32x32x8_bf16 v[48:63], v[90:91], v[132:133], v[48:63]
    v_exp_f32 v36, v36
    v_exp_f32 v37, v37
    v_exp_f32 v38, v38
    v_exp_f32 v39, v39
    v_smfmac_f32_32x32x32_bf16 v[0:15], v[96:99], v[64:71], v143
    v_exp_f32 v40, v40
    v_exp_f32 v41, v41
    v_exp_f32 v42, v42
    v_exp_f32 v43, v43
    v_smfmac_f32_32x32x32_bf16 v[0:15], v[100:103], v[72:79], v143
    v_exp_f32 v44, v44
    v_exp_f32 v45, v45
    v_exp_f32 v46, v46
    v_exp_f32 v47, v47
    v_mfma_f32_32x32x16_bf16 v[64:79], v[84:87], v[134:137], 0
    ds_read_b128 v[84:87], v140 offset:43520
    v_exp_f32 v48, v48
    v_exp_f32 v49, v49
    v_exp_f32 v50, v50
    v_exp_f32 v51, v51
    v_mfma_f32_32x32x8_bf16 v[64:79], v[90:91], v[138:139], v[64:79]
    v_exp_f32 v52, v52
    v_exp_f32 v53, v53
    v_exp_f32 v54, v54
    v_exp_f32 v55, v55
    v_smfmac_f32_32x32x32_bf16 v[16:31], v[96:99], v[32:39], v143
    v_exp_f32 v56, v56
    v_exp_f32 v57, v57
    v_exp_f32 v58, v58
    v_exp_f32 v59, v59
    v_smfmac_f32_32x32x32_bf16 v[16:31], v[100:103], v[40:47], v143
    v_exp_f32 v60, v60
    v_exp_f32 v61, v61
    v_exp_f32 v62, v62
    v_exp_f32 v63, v63
    s_waitcnt lgkmcnt(6)
    v_mfma_f32_32x32x16_bf16 v[32:47], v[80:83], v[128:131], 0
    v_exp_f32 v64, v64
    v_exp_f32 v65, v65
    v_exp_f32 v66, v66
    v_exp_f32 v67, v67
    s_waitcnt lgkmcnt(5)
    v_mfma_f32_32x32x8_bf16 v[32:47], v[92:93], v[132:133], v[32:47]
    v_exp_f32 v68, v68
    v_exp_f32 v69, v69
    v_exp_f32 v70, v70
    v_exp_f32 v71, v71
    v_smfmac_f32_32x32x32_bf16 v[0:15], v[104:107], v[48:55], v143
    v_exp_f32 v72, v72
    v_exp_f32 v73, v73
    v_exp_f32 v74, v74
    v_exp_f32 v75, v75
    v_smfmac_f32_32x32x32_bf16 v[0:15], v[108:111], v[56:63], v143
    v_exp_f32 v76, v76
    v_exp_f32 v77, v77
    v_exp_f32 v78, v78
    v_exp_f32 v79, v79
    v_mfma_f32_32x32x16_bf16 v[48:63], v[80:83], v[134:137], 0
    ds_read_b128 v[80:83], v140 offset:46080
    v_exp_f32 v32, v32
    v_exp_f32 v33, v33
    v_exp_f32 v34, v34
    v_exp_f32 v35, v35
    v_mfma_f32_32x32x8_bf16 v[48:63], v[92:93], v[138:139], v[48:63]
    ds_read2st64_b64 v[88:91], v141 offset0:220 offset1:225
    v_exp_f32 v36, v36
    v_exp_f32 v37, v37
    v_exp_f32 v38, v38
    v_exp_f32 v39, v39
    v_smfmac_f32_32x32x32_bf16 v[16:31], v[104:107], v[64:71], v143
    v_exp_f32 v40, v40
    v_exp_f32 v41, v41
    v_exp_f32 v42, v42
    v_exp_f32 v43, v43
    v_smfmac_f32_32x32x32_bf16 v[16:31], v[108:111], v[72:79], v143
    s_mov_b64 exec, s[76:77]
    ds_read_b128 v[96:99], v142 offset:46080
    ds_read_b128 v[100:103], v142 offset:47360
    ds_read_b128 v[104:107], v142 offset:48640
    ds_read_b128 v[108:111], v142 offset:49920
    s_mov_b64 exec, -1
    v_exp_f32 v44, v44
    v_exp_f32 v45, v45
    v_exp_f32 v46, v46
    v_exp_f32 v47, v47
    s_waitcnt lgkmcnt(6)
    v_mfma_f32_32x32x16_bf16 v[64:79], v[84:87], v[128:131], 0
    v_exp_f32 v48, v48
    v_exp_f32 v49, v49
    v_exp_f32 v50, v50
    v_exp_f32 v51, v51
    v_mfma_f32_32x32x8_bf16 v[64:79], v[94:95], v[132:133], v[64:79]
    v_exp_f32 v52, v52
    v_exp_f32 v53, v53
    v_exp_f32 v54, v54
    v_exp_f32 v55, v55
    v_smfmac_f32_32x32x32_bf16 v[0:15], v[112:115], v[32:39], v143
    v_exp_f32 v56, v56
    v_exp_f32 v57, v57
    v_exp_f32 v58, v58
    v_exp_f32 v59, v59
    v_smfmac_f32_32x32x32_bf16 v[0:15], v[116:119], v[40:47], v143
    v_exp_f32 v60, v60
    v_exp_f32 v61, v61
    v_exp_f32 v62, v62
    v_exp_f32 v63, v63
    v_mfma_f32_32x32x16_bf16 v[32:47], v[84:87], v[134:137], 0
    ds_read_b128 v[84:87], v140 offset:48640
    v_exp_f32 v64, v64
    v_exp_f32 v65, v65
    v_exp_f32 v66, v66
    v_exp_f32 v67, v67
    v_mfma_f32_32x32x8_bf16 v[32:47], v[94:95], v[138:139], v[32:47]
    v_exp_f32 v68, v68
    v_exp_f32 v69, v69
    v_exp_f32 v70, v70
    v_exp_f32 v71, v71
    v_smfmac_f32_32x32x32_bf16 v[16:31], v[112:115], v[48:55], v143
    v_exp_f32 v72, v72
    v_exp_f32 v73, v73
    v_exp_f32 v74, v74
    v_exp_f32 v75, v75
    v_smfmac_f32_32x32x32_bf16 v[16:31], v[116:119], v[56:63], v143
    v_exp_f32 v76, v76
    v_exp_f32 v77, v77
    v_exp_f32 v78, v78
    v_exp_f32 v79, v79
    s_waitcnt lgkmcnt(6)
    v_mfma_f32_32x32x16_bf16 v[48:63], v[80:83], v[128:131], 0
    v_exp_f32 v32, v32
    v_exp_f32 v33, v33
    v_exp_f32 v34, v34
    v_exp_f32 v35, v35
    s_waitcnt lgkmcnt(5)
    v_mfma_f32_32x32x8_bf16 v[48:63], v[88:89], v[132:133], v[48:63]
    v_exp_f32 v36, v36
    v_exp_f32 v37, v37
    v_exp_f32 v38, v38
    v_exp_f32 v39, v39
    v_smfmac_f32_32x32x32_bf16 v[0:15], v[120:123], v[64:71], v143
    v_exp_f32 v40, v40
    v_exp_f32 v41, v41
    v_exp_f32 v42, v42
    v_exp_f32 v43, v43
    v_smfmac_f32_32x32x32_bf16 v[0:15], v[124:127], v[72:79], v143
    v_exp_f32 v44, v44
    v_exp_f32 v45, v45
    v_exp_f32 v46, v46
    v_exp_f32 v47, v47
    v_mfma_f32_32x32x16_bf16 v[64:79], v[80:83], v[134:137], 0
    ds_read_b128 v[80:83], v140 offset:51200
    v_exp_f32 v48, v48
    v_exp_f32 v49, v49
    v_exp_f32 v50, v50
    v_exp_f32 v51, v51
    v_mfma_f32_32x32x8_bf16 v[64:79], v[88:89], v[138:139], v[64:79]
    ds_read2st64_b64 v[92:95], v141 offset0:230 offset1:235
    v_exp_f32 v52, v52
    v_exp_f32 v53, v53
    v_exp_f32 v54, v54
    v_exp_f32 v55, v55
    v_smfmac_f32_32x32x32_bf16 v[16:31], v[120:123], v[32:39], v143
    v_exp_f32 v56, v56
    v_exp_f32 v57, v57
    v_exp_f32 v58, v58
    v_exp_f32 v59, v59
    v_smfmac_f32_32x32x32_bf16 v[16:31], v[124:127], v[40:47], v143
    s_mov_b64 exec, s[76:77]
    ds_read_b128 v[112:115], v142 offset:51200
    ds_read_b128 v[116:119], v142 offset:52480
    ds_read_b128 v[120:123], v142 offset:53760
    ds_read_b128 v[124:127], v142 offset:55040
    s_mov_b64 exec, -1
    v_exp_f32 v60, v60
    v_exp_f32 v61, v61
    v_exp_f32 v62, v62
    v_exp_f32 v63, v63
    s_waitcnt lgkmcnt(6)
    v_mfma_f32_32x32x16_bf16 v[32:47], v[84:87], v[128:131], 0
    v_exp_f32 v64, v64
    v_exp_f32 v65, v65
    v_exp_f32 v66, v66
    v_exp_f32 v67, v67
    v_mfma_f32_32x32x8_bf16 v[32:47], v[90:91], v[132:133], v[32:47]
    v_exp_f32 v68, v68
    v_exp_f32 v69, v69
    v_exp_f32 v70, v70
    v_exp_f32 v71, v71
    v_smfmac_f32_32x32x32_bf16 v[0:15], v[96:99], v[48:55], v143
    v_exp_f32 v72, v72
    v_exp_f32 v73, v73
    v_exp_f32 v74, v74
    v_exp_f32 v75, v75
    v_smfmac_f32_32x32x32_bf16 v[0:15], v[100:103], v[56:63], v143
    v_exp_f32 v76, v76
    v_exp_f32 v77, v77
    v_exp_f32 v78, v78
    v_exp_f32 v79, v79
    v_mfma_f32_32x32x16_bf16 v[48:63], v[84:87], v[134:137], 0
    ds_read_b128 v[84:87], v140 offset:53760
    v_exp_f32 v32, v32
    v_exp_f32 v33, v33
    v_exp_f32 v34, v34
    v_exp_f32 v35, v35
    v_mfma_f32_32x32x8_bf16 v[48:63], v[90:91], v[138:139], v[48:63]
    v_exp_f32 v36, v36
    v_exp_f32 v37, v37
    v_exp_f32 v38, v38
    v_exp_f32 v39, v39
    v_smfmac_f32_32x32x32_bf16 v[16:31], v[96:99], v[64:71], v143
    v_exp_f32 v40, v40
    v_exp_f32 v41, v41
    v_exp_f32 v42, v42
    v_exp_f32 v43, v43
    v_smfmac_f32_32x32x32_bf16 v[16:31], v[100:103], v[72:79], v143
    v_exp_f32 v44, v44
    v_exp_f32 v45, v45
    v_exp_f32 v46, v46
    v_exp_f32 v47, v47
    s_waitcnt lgkmcnt(6)
    v_mfma_f32_32x32x16_bf16 v[64:79], v[80:83], v[128:131], 0
    v_exp_f32 v48, v48
    v_exp_f32 v49, v49
    v_exp_f32 v50, v50
    v_exp_f32 v51, v51
    s_waitcnt lgkmcnt(5)
    v_mfma_f32_32x32x8_bf16 v[64:79], v[92:93], v[132:133], v[64:79]
    v_exp_f32 v52, v52
    v_exp_f32 v53, v53
    v_exp_f32 v54, v54
    v_exp_f32 v55, v55
    v_smfmac_f32_32x32x32_bf16 v[0:15], v[104:107], v[32:39], v143
    v_exp_f32 v56, v56
    v_exp_f32 v57, v57
    v_exp_f32 v58, v58
    v_exp_f32 v59, v59
    v_smfmac_f32_32x32x32_bf16 v[0:15], v[108:111], v[40:47], v143
    v_exp_f32 v60, v60
    v_exp_f32 v61, v61
    v_exp_f32 v62, v62
    v_exp_f32 v63, v63
    v_mfma_f32_32x32x16_bf16 v[32:47], v[80:83], v[134:137], 0
    ds_read_b128 v[80:83], v140 offset:56320
    v_exp_f32 v64, v64
    v_exp_f32 v65, v65
    v_exp_f32 v66, v66
    v_exp_f32 v67, v67
    v_mfma_f32_32x32x8_bf16 v[32:47], v[92:93], v[138:139], v[32:47]
    ds_read2st64_b64 v[88:91], v141 offset0:240 offset1:245
    v_exp_f32 v68, v68
    v_exp_f32 v69, v69
    v_exp_f32 v70, v70
    v_exp_f32 v71, v71
    v_smfmac_f32_32x32x32_bf16 v[16:31], v[104:107], v[48:55], v143
    v_exp_f32 v72, v72
    v_exp_f32 v73, v73
    v_exp_f32 v74, v74
    v_exp_f32 v75, v75
    v_smfmac_f32_32x32x32_bf16 v[16:31], v[108:111], v[56:63], v143
    s_mov_b64 exec, s[76:77]
    ds_read_b128 v[96:99], v142 offset:56320
    ds_read_b128 v[100:103], v142 offset:57600
    ds_read_b128 v[104:107], v142 offset:58880
    ds_read_b128 v[108:111], v142 offset:60160
    s_mov_b64 exec, -1
    v_exp_f32 v76, v76
    v_exp_f32 v77, v77
    v_exp_f32 v78, v78
    v_exp_f32 v79, v79
    s_waitcnt lgkmcnt(6)
    v_mfma_f32_32x32x16_bf16 v[48:63], v[84:87], v[128:131], 0
    v_exp_f32 v32, v32
    v_exp_f32 v33, v33
    v_exp_f32 v34, v34
    v_exp_f32 v35, v35
    v_mfma_f32_32x32x8_bf16 v[48:63], v[94:95], v[132:133], v[48:63]
    v_exp_f32 v36, v36
    v_exp_f32 v37, v37
    v_exp_f32 v38, v38
    v_exp_f32 v39, v39
    v_smfmac_f32_32x32x32_bf16 v[0:15], v[112:115], v[64:71], v143
    v_exp_f32 v40, v40
    v_exp_f32 v41, v41
    v_exp_f32 v42, v42
    v_exp_f32 v43, v43
    v_smfmac_f32_32x32x32_bf16 v[0:15], v[116:119], v[72:79], v143
    v_exp_f32 v44, v44
    v_exp_f32 v45, v45
    v_exp_f32 v46, v46
    v_exp_f32 v47, v47
    s_barrier
    v_mfma_f32_32x32x16_bf16 v[64:79], v[84:87], v[134:137], 0
    ds_read_b128 v[84:87], v140 offset:58880
    v_exp_f32 v48, v48
    v_exp_f32 v49, v49
    v_exp_f32 v50, v50
    v_exp_f32 v51, v51
    v_mfma_f32_32x32x8_bf16 v[64:79], v[94:95], v[138:139], v[64:79]
    v_exp_f32 v52, v52
    v_exp_f32 v53, v53
    v_exp_f32 v54, v54
    v_exp_f32 v55, v55
    v_smfmac_f32_32x32x32_bf16 v[16:31], v[112:115], v[32:39], v143
    v_exp_f32 v56, v56
    v_exp_f32 v57, v57
    v_exp_f32 v58, v58
    v_exp_f32 v59, v59
    v_smfmac_f32_32x32x32_bf16 v[16:31], v[116:119], v[40:47], v143
    v_exp_f32 v60, v60
    v_exp_f32 v61, v61
    v_exp_f32 v62, v62
    v_exp_f32 v63, v63
    s_waitcnt lgkmcnt(6)
    v_mfma_f32_32x32x16_bf16 v[32:47], v[80:83], v[128:131], 0
    v_exp_f32 v64, v64
    v_exp_f32 v65, v65
    v_exp_f32 v66, v66
    v_exp_f32 v67, v67
    s_waitcnt lgkmcnt(5)
    v_mfma_f32_32x32x8_bf16 v[32:47], v[88:89], v[132:133], v[32:47]
    v_exp_f32 v68, v68
    v_exp_f32 v69, v69
    v_exp_f32 v70, v70
    v_exp_f32 v71, v71
    v_smfmac_f32_32x32x32_bf16 v[0:15], v[120:123], v[48:55], v143
    v_exp_f32 v72, v72
    v_exp_f32 v73, v73
    v_exp_f32 v74, v74
    v_exp_f32 v75, v75
    v_smfmac_f32_32x32x32_bf16 v[0:15], v[124:127], v[56:63], v143
    v_exp_f32 v76, v76
    v_exp_f32 v77, v77
    v_exp_f32 v78, v78
    v_exp_f32 v79, v79
    v_mfma_f32_32x32x16_bf16 v[48:63], v[80:83], v[134:137], 0
    ds_read_b128 v[80:83], v140 offset:61440
    v_exp_f32 v32, v32
    v_exp_f32 v33, v33
    v_exp_f32 v34, v34
    v_exp_f32 v35, v35
    v_mfma_f32_32x32x8_bf16 v[48:63], v[88:89], v[138:139], v[48:63]
    ds_read2st64_b64 v[92:95], v141 offset0:250 offset1:255
    v_exp_f32 v36, v36
    v_exp_f32 v37, v37
    v_exp_f32 v38, v38
    v_exp_f32 v39, v39
    v_smfmac_f32_32x32x32_bf16 v[16:31], v[120:123], v[64:71], v143
    v_exp_f32 v40, v40
    v_exp_f32 v41, v41
    v_exp_f32 v42, v42
    v_exp_f32 v43, v43
    v_smfmac_f32_32x32x32_bf16 v[16:31], v[124:127], v[72:79], v143
    s_mov_b64 exec, s[76:77]
    ds_read_b128 v[112:115], v142 offset:61440
    ds_read_b128 v[116:119], v142 offset:62720
    ds_read_b128 v[120:123], v142 offset:64000
    ds_read_b128 v[124:127], v142 offset:65280
    s_mov_b64 exec, -1
    v_exp_f32 v44, v44
    v_exp_f32 v45, v45
    v_exp_f32 v46, v46
    v_exp_f32 v47, v47
    s_waitcnt lgkmcnt(6)
    v_mfma_f32_32x32x16_bf16 v[64:79], v[84:87], v[128:131], 0
    v_exp_f32 v48, v48
    v_exp_f32 v49, v49
    v_exp_f32 v50, v50
    v_exp_f32 v51, v51
    v_mfma_f32_32x32x8_bf16 v[64:79], v[90:91], v[132:133], v[64:79]
    v_exp_f32 v52, v52
    v_exp_f32 v53, v53
    v_exp_f32 v54, v54
    v_exp_f32 v55, v55
    v_smfmac_f32_32x32x32_bf16 v[0:15], v[96:99], v[32:39], v143
    v_exp_f32 v56, v56
    v_exp_f32 v57, v57
    v_exp_f32 v58, v58
    v_exp_f32 v59, v59
    v_smfmac_f32_32x32x32_bf16 v[0:15], v[100:103], v[40:47], v143
    v_exp_f32 v60, v60
    v_exp_f32 v61, v61
    v_exp_f32 v62, v62
    v_exp_f32 v63, v63
    v_mfma_f32_32x32x16_bf16 v[32:47], v[84:87], v[134:137], 0
    ds_read_b128 v[84:87], v140 offset:64000
    v_exp_f32 v64, v64
    v_exp_f32 v65, v65
    v_exp_f32 v66, v66
    v_exp_f32 v67, v67
    v_mfma_f32_32x32x8_bf16 v[32:47], v[90:91], v[138:139], v[32:47]
    v_exp_f32 v68, v68
    v_exp_f32 v69, v69
    v_exp_f32 v70, v70
    v_exp_f32 v71, v71
    v_smfmac_f32_32x32x32_bf16 v[16:31], v[96:99], v[48:55], v143
    v_exp_f32 v72, v72
    v_exp_f32 v73, v73
    v_exp_f32 v74, v74
    v_exp_f32 v75, v75
    v_smfmac_f32_32x32x32_bf16 v[16:31], v[100:103], v[56:63], v143
    v_exp_f32 v76, v76
    v_exp_f32 v77, v77
    v_exp_f32 v78, v78
    v_exp_f32 v79, v79
    s_waitcnt lgkmcnt(6)
    v_mfma_f32_32x32x16_bf16 v[48:63], v[80:83], v[128:131], 0
    v_exp_f32 v32, v32
    v_exp_f32 v33, v33
    v_exp_f32 v34, v34
    v_exp_f32 v35, v35
    s_waitcnt lgkmcnt(5)
    v_mfma_f32_32x32x8_bf16 v[48:63], v[92:93], v[132:133], v[48:63]
    v_exp_f32 v36, v36
    v_exp_f32 v37, v37
    v_exp_f32 v38, v38
    v_exp_f32 v39, v39
    v_smfmac_f32_32x32x32_bf16 v[0:15], v[104:107], v[64:71], v143
    v_exp_f32 v40, v40
    v_exp_f32 v41, v41
    v_exp_f32 v42, v42
    v_exp_f32 v43, v43
    v_smfmac_f32_32x32x32_bf16 v[0:15], v[108:111], v[72:79], v143
    v_exp_f32 v44, v44
    v_exp_f32 v45, v45
    v_exp_f32 v46, v46
    v_exp_f32 v47, v47
    v_mfma_f32_32x32x16_bf16 v[64:79], v[80:83], v[134:137], 0
    v_add_u32 v140, 66560, v140
    ds_read_b128 v[80:83], v140 offset:0
    v_exp_f32 v48, v48
    v_exp_f32 v49, v49
    v_exp_f32 v50, v50
    v_exp_f32 v51, v51
    v_mfma_f32_32x32x8_bf16 v[64:79], v[92:93], v[138:139], v[64:79]
    v_add_u32 v141, 133120, v141
    ds_read2st64_b64 v[88:91], v141 offset0:0 offset1:5
    v_exp_f32 v52, v52
    v_exp_f32 v53, v53
    v_exp_f32 v54, v54
    v_exp_f32 v55, v55
    v_smfmac_f32_32x32x32_bf16 v[16:31], v[104:107], v[32:39], v143
    v_exp_f32 v56, v56
    v_exp_f32 v57, v57
    v_exp_f32 v58, v58
    v_exp_f32 v59, v59
    v_smfmac_f32_32x32x32_bf16 v[16:31], v[108:111], v[40:47], v143
    v_add_u32 v142, 66560, v142
    s_mov_b64 exec, s[76:77]
    ds_read_b128 v[96:99], v142 offset:0
    ds_read_b128 v[100:103], v142 offset:1280
    ds_read_b128 v[104:107], v142 offset:2560
    ds_read_b128 v[108:111], v142 offset:3840
    s_mov_b64 exec, -1
    v_exp_f32 v60, v60
    v_exp_f32 v61, v61
    v_exp_f32 v62, v62
    v_exp_f32 v63, v63
    s_waitcnt lgkmcnt(6)
    v_mfma_f32_32x32x16_bf16 v[32:47], v[84:87], v[128:131], 0
    v_exp_f32 v64, v64
    v_exp_f32 v65, v65
    v_exp_f32 v66, v66
    v_exp_f32 v67, v67
    v_mfma_f32_32x32x8_bf16 v[32:47], v[94:95], v[132:133], v[32:47]
    v_exp_f32 v68, v68
    v_exp_f32 v69, v69
    v_exp_f32 v70, v70
    v_exp_f32 v71, v71
    v_smfmac_f32_32x32x32_bf16 v[0:15], v[112:115], v[48:55], v143
    v_exp_f32 v72, v72
    v_exp_f32 v73, v73
    v_exp_f32 v74, v74
    v_exp_f32 v75, v75
    v_smfmac_f32_32x32x32_bf16 v[0:15], v[116:119], v[56:63], v143
    v_exp_f32 v76, v76
    v_exp_f32 v77, v77
    v_exp_f32 v78, v78
    v_exp_f32 v79, v79
    v_mfma_f32_32x32x16_bf16 v[48:63], v[84:87], v[134:137], 0
    ds_read_b128 v[84:87], v140 offset:2560
    v_exp_f32 v32, v32
    v_exp_f32 v33, v33
    v_exp_f32 v34, v34
    v_exp_f32 v35, v35
    v_mfma_f32_32x32x8_bf16 v[48:63], v[94:95], v[138:139], v[48:63]
    v_exp_f32 v36, v36
    v_exp_f32 v37, v37
    v_exp_f32 v38, v38
    v_exp_f32 v39, v39
    v_smfmac_f32_32x32x32_bf16 v[16:31], v[112:115], v[64:71], v143
    v_exp_f32 v40, v40
    v_exp_f32 v41, v41
    v_exp_f32 v42, v42
    v_exp_f32 v43, v43
    v_smfmac_f32_32x32x32_bf16 v[16:31], v[116:119], v[72:79], v143
    v_exp_f32 v44, v44
    v_exp_f32 v45, v45
    v_exp_f32 v46, v46
    v_exp_f32 v47, v47
    s_waitcnt lgkmcnt(6)
    v_mfma_f32_32x32x16_bf16 v[64:79], v[80:83], v[128:131], 0
    v_exp_f32 v48, v48
    v_exp_f32 v49, v49
    v_exp_f32 v50, v50
    v_exp_f32 v51, v51
    s_waitcnt lgkmcnt(5)
    v_mfma_f32_32x32x8_bf16 v[64:79], v[88:89], v[132:133], v[64:79]
    v_exp_f32 v52, v52
    v_exp_f32 v53, v53
    v_exp_f32 v54, v54
    v_exp_f32 v55, v55
    v_smfmac_f32_32x32x32_bf16 v[0:15], v[120:123], v[32:39], v143
    v_exp_f32 v56, v56
    v_exp_f32 v57, v57
    v_exp_f32 v58, v58
    v_exp_f32 v59, v59
    v_smfmac_f32_32x32x32_bf16 v[0:15], v[124:127], v[40:47], v143
    v_exp_f32 v60, v60
    v_exp_f32 v61, v61
    v_exp_f32 v62, v62
    v_exp_f32 v63, v63
    v_mfma_f32_32x32x16_bf16 v[32:47], v[80:83], v[134:137], 0
    ds_read_b128 v[80:83], v140 offset:5120
    v_exp_f32 v64, v64
    v_exp_f32 v65, v65
    v_exp_f32 v66, v66
    v_exp_f32 v67, v67
    v_mfma_f32_32x32x8_bf16 v[32:47], v[88:89], v[138:139], v[32:47]
    ds_read2st64_b64 v[92:95], v141 offset0:10 offset1:15
    v_exp_f32 v68, v68
    v_exp_f32 v69, v69
    v_exp_f32 v70, v70
    v_exp_f32 v71, v71
    v_smfmac_f32_32x32x32_bf16 v[16:31], v[120:123], v[48:55], v143
    v_exp_f32 v72, v72
    v_exp_f32 v73, v73
    v_exp_f32 v74, v74
    v_exp_f32 v75, v75
    v_smfmac_f32_32x32x32_bf16 v[16:31], v[124:127], v[56:63], v143
    s_mov_b64 exec, s[76:77]
    ds_read_b128 v[112:115], v142 offset:5120
    ds_read_b128 v[116:119], v142 offset:6400
    ds_read_b128 v[120:123], v142 offset:7680
    ds_read_b128 v[124:127], v142 offset:8960
    s_mov_b64 exec, -1
    v_exp_f32 v76, v76
    v_exp_f32 v77, v77
    v_exp_f32 v78, v78
    v_exp_f32 v79, v79
    s_waitcnt lgkmcnt(6)
    v_mfma_f32_32x32x16_bf16 v[48:63], v[84:87], v[128:131], 0
    v_exp_f32 v32, v32
    v_exp_f32 v33, v33
    v_exp_f32 v34, v34
    v_exp_f32 v35, v35
    v_mfma_f32_32x32x8_bf16 v[48:63], v[90:91], v[132:133], v[48:63]
    v_exp_f32 v36, v36
    v_exp_f32 v37, v37
    v_exp_f32 v38, v38
    v_exp_f32 v39, v39
    v_smfmac_f32_32x32x32_bf16 v[0:15], v[96:99], v[64:71], v143
    v_exp_f32 v40, v40
    v_exp_f32 v41, v41
    v_exp_f32 v42, v42
    v_exp_f32 v43, v43
    v_smfmac_f32_32x32x32_bf16 v[0:15], v[100:103], v[72:79], v143
    v_exp_f32 v44, v44
    v_exp_f32 v45, v45
    v_exp_f32 v46, v46
    v_exp_f32 v47, v47
    v_mfma_f32_32x32x16_bf16 v[64:79], v[84:87], v[134:137], 0
    ds_read_b128 v[84:87], v140 offset:7680
    v_exp_f32 v48, v48
    v_exp_f32 v49, v49
    v_exp_f32 v50, v50
    v_exp_f32 v51, v51
    v_mfma_f32_32x32x8_bf16 v[64:79], v[90:91], v[138:139], v[64:79]
    v_exp_f32 v52, v52
    v_exp_f32 v53, v53
    v_exp_f32 v54, v54
    v_exp_f32 v55, v55
    v_smfmac_f32_32x32x32_bf16 v[16:31], v[96:99], v[32:39], v143
    v_exp_f32 v56, v56
    v_exp_f32 v57, v57
    v_exp_f32 v58, v58
    v_exp_f32 v59, v59
    v_smfmac_f32_32x32x32_bf16 v[16:31], v[100:103], v[40:47], v143
    v_exp_f32 v60, v60
    v_exp_f32 v61, v61
    v_exp_f32 v62, v62
    v_exp_f32 v63, v63
    s_waitcnt lgkmcnt(6)
    v_mfma_f32_32x32x16_bf16 v[32:47], v[80:83], v[128:131], 0
    v_exp_f32 v64, v64
    v_exp_f32 v65, v65
    v_exp_f32 v66, v66
    v_exp_f32 v67, v67
    s_waitcnt lgkmcnt(5)
    v_mfma_f32_32x32x8_bf16 v[32:47], v[92:93], v[132:133], v[32:47]
    v_exp_f32 v68, v68
    v_exp_f32 v69, v69
    v_exp_f32 v70, v70
    v_exp_f32 v71, v71
    v_smfmac_f32_32x32x32_bf16 v[0:15], v[104:107], v[48:55], v143
    v_exp_f32 v72, v72
    v_exp_f32 v73, v73
    v_exp_f32 v74, v74
    v_exp_f32 v75, v75
    v_smfmac_f32_32x32x32_bf16 v[0:15], v[108:111], v[56:63], v143
    v_exp_f32 v76, v76
    v_exp_f32 v77, v77
    v_exp_f32 v78, v78
    v_exp_f32 v79, v79
    v_mfma_f32_32x32x16_bf16 v[48:63], v[80:83], v[134:137], 0
    ds_read_b128 v[80:83], v140 offset:10240
    v_exp_f32 v32, v32
    v_exp_f32 v33, v33
    v_exp_f32 v34, v34
    v_exp_f32 v35, v35
    v_mfma_f32_32x32x8_bf16 v[48:63], v[92:93], v[138:139], v[48:63]
    ds_read2st64_b64 v[88:91], v141 offset0:20 offset1:25
    v_exp_f32 v36, v36
    v_exp_f32 v37, v37
    v_exp_f32 v38, v38
    v_exp_f32 v39, v39
    v_smfmac_f32_32x32x32_bf16 v[16:31], v[104:107], v[64:71], v143
    v_exp_f32 v40, v40
    v_exp_f32 v41, v41
    v_exp_f32 v42, v42
    v_exp_f32 v43, v43
    v_smfmac_f32_32x32x32_bf16 v[16:31], v[108:111], v[72:79], v143
    s_mov_b64 exec, s[76:77]
    ds_read_b128 v[96:99], v142 offset:10240
    ds_read_b128 v[100:103], v142 offset:11520
    ds_read_b128 v[104:107], v142 offset:12800
    ds_read_b128 v[108:111], v142 offset:14080
    s_mov_b64 exec, -1
    v_exp_f32 v44, v44
    v_exp_f32 v45, v45
    v_exp_f32 v46, v46
    v_exp_f32 v47, v47
    s_waitcnt lgkmcnt(6)
    v_mfma_f32_32x32x16_bf16 v[64:79], v[84:87], v[128:131], 0
    v_exp_f32 v48, v48
    v_exp_f32 v49, v49
    v_exp_f32 v50, v50
    v_exp_f32 v51, v51
    v_mfma_f32_32x32x8_bf16 v[64:79], v[94:95], v[132:133], v[64:79]
    v_exp_f32 v52, v52
    v_exp_f32 v53, v53
    v_exp_f32 v54, v54
    v_exp_f32 v55, v55
    v_smfmac_f32_32x32x32_bf16 v[0:15], v[112:115], v[32:39], v143
    v_exp_f32 v56, v56
    v_exp_f32 v57, v57
    v_exp_f32 v58, v58
    v_exp_f32 v59, v59
    v_smfmac_f32_32x32x32_bf16 v[0:15], v[116:119], v[40:47], v143
    v_exp_f32 v60, v60
    v_exp_f32 v61, v61
    v_exp_f32 v62, v62
    v_exp_f32 v63, v63
    v_mfma_f32_32x32x16_bf16 v[32:47], v[84:87], v[134:137], 0
    ds_read_b128 v[84:87], v140 offset:12800
    v_exp_f32 v64, v64
    v_exp_f32 v65, v65
    v_exp_f32 v66, v66
    v_exp_f32 v67, v67
    v_mfma_f32_32x32x8_bf16 v[32:47], v[94:95], v[138:139], v[32:47]
    v_exp_f32 v68, v68
    v_exp_f32 v69, v69
    v_exp_f32 v70, v70
    v_exp_f32 v71, v71
    v_smfmac_f32_32x32x32_bf16 v[16:31], v[112:115], v[48:55], v143
    v_exp_f32 v72, v72
    v_exp_f32 v73, v73
    v_exp_f32 v74, v74
    v_exp_f32 v75, v75
    v_smfmac_f32_32x32x32_bf16 v[16:31], v[116:119], v[56:63], v143
    v_exp_f32 v76, v76
    v_exp_f32 v77, v77
    v_exp_f32 v78, v78
    v_exp_f32 v79, v79
    s_waitcnt lgkmcnt(6)
    v_mfma_f32_32x32x16_bf16 v[48:63], v[80:83], v[128:131], 0
    v_exp_f32 v32, v32
    v_exp_f32 v33, v33
    v_exp_f32 v34, v34
    v_exp_f32 v35, v35
    s_waitcnt lgkmcnt(5)
    v_mfma_f32_32x32x8_bf16 v[48:63], v[88:89], v[132:133], v[48:63]
    v_exp_f32 v36, v36
    v_exp_f32 v37, v37
    v_exp_f32 v38, v38
    v_exp_f32 v39, v39
    v_smfmac_f32_32x32x32_bf16 v[0:15], v[120:123], v[64:71], v143
    v_exp_f32 v40, v40
    v_exp_f32 v41, v41
    v_exp_f32 v42, v42
    v_exp_f32 v43, v43
    v_smfmac_f32_32x32x32_bf16 v[0:15], v[124:127], v[72:79], v143
    v_exp_f32 v44, v44
    v_exp_f32 v45, v45
    v_exp_f32 v46, v46
    v_exp_f32 v47, v47
    v_mfma_f32_32x32x16_bf16 v[64:79], v[80:83], v[134:137], 0
    ds_read_b128 v[80:83], v140 offset:15360
    v_exp_f32 v48, v48
    v_exp_f32 v49, v49
    v_exp_f32 v50, v50
    v_exp_f32 v51, v51
    v_mfma_f32_32x32x8_bf16 v[64:79], v[88:89], v[138:139], v[64:79]
    ds_read2st64_b64 v[92:95], v141 offset0:30 offset1:35
    v_exp_f32 v52, v52
    v_exp_f32 v53, v53
    v_exp_f32 v54, v54
    v_exp_f32 v55, v55
    v_smfmac_f32_32x32x32_bf16 v[16:31], v[120:123], v[32:39], v143
    v_exp_f32 v56, v56
    v_exp_f32 v57, v57
    v_exp_f32 v58, v58
    v_exp_f32 v59, v59
    v_smfmac_f32_32x32x32_bf16 v[16:31], v[124:127], v[40:47], v143
    s_mov_b64 exec, s[76:77]
    ds_read_b128 v[112:115], v142 offset:15360
    ds_read_b128 v[116:119], v142 offset:16640
    ds_read_b128 v[120:123], v142 offset:17920
    ds_read_b128 v[124:127], v142 offset:19200
    s_mov_b64 exec, -1
    v_exp_f32 v60, v60
    v_exp_f32 v61, v61
    v_exp_f32 v62, v62
    v_exp_f32 v63, v63
    s_waitcnt lgkmcnt(6)
    v_mfma_f32_32x32x16_bf16 v[32:47], v[84:87], v[128:131], 0
    v_exp_f32 v64, v64
    v_exp_f32 v65, v65
    v_exp_f32 v66, v66
    v_exp_f32 v67, v67
    v_mfma_f32_32x32x8_bf16 v[32:47], v[90:91], v[132:133], v[32:47]
    v_exp_f32 v68, v68
    v_exp_f32 v69, v69
    v_exp_f32 v70, v70
    v_exp_f32 v71, v71
    v_smfmac_f32_32x32x32_bf16 v[0:15], v[96:99], v[48:55], v143
    v_exp_f32 v72, v72
    v_exp_f32 v73, v73
    v_exp_f32 v74, v74
    v_exp_f32 v75, v75
    v_smfmac_f32_32x32x32_bf16 v[0:15], v[100:103], v[56:63], v143
    v_exp_f32 v76, v76
    v_exp_f32 v77, v77
    v_exp_f32 v78, v78
    v_exp_f32 v79, v79
    v_mfma_f32_32x32x16_bf16 v[48:63], v[84:87], v[134:137], 0
    ds_read_b128 v[84:87], v140 offset:17920
    v_exp_f32 v32, v32
    v_exp_f32 v33, v33
    v_exp_f32 v34, v34
    v_exp_f32 v35, v35
    v_mfma_f32_32x32x8_bf16 v[48:63], v[90:91], v[138:139], v[48:63]
    v_exp_f32 v36, v36
    v_exp_f32 v37, v37
    v_exp_f32 v38, v38
    v_exp_f32 v39, v39
    v_smfmac_f32_32x32x32_bf16 v[16:31], v[96:99], v[64:71], v143
    v_exp_f32 v40, v40
    v_exp_f32 v41, v41
    v_exp_f32 v42, v42
    v_exp_f32 v43, v43
    v_smfmac_f32_32x32x32_bf16 v[16:31], v[100:103], v[72:79], v143
    v_exp_f32 v44, v44
    v_exp_f32 v45, v45
    v_exp_f32 v46, v46
    v_exp_f32 v47, v47
    s_waitcnt lgkmcnt(6)
    v_mfma_f32_32x32x16_bf16 v[64:79], v[80:83], v[128:131], 0
    v_exp_f32 v48, v48
    v_exp_f32 v49, v49
    v_exp_f32 v50, v50
    v_exp_f32 v51, v51
    s_waitcnt lgkmcnt(5)
    v_mfma_f32_32x32x8_bf16 v[64:79], v[92:93], v[132:133], v[64:79]
    v_exp_f32 v52, v52
    v_exp_f32 v53, v53
    v_exp_f32 v54, v54
    v_exp_f32 v55, v55
    v_smfmac_f32_32x32x32_bf16 v[0:15], v[104:107], v[32:39], v143
    v_exp_f32 v56, v56
    v_exp_f32 v57, v57
    v_exp_f32 v58, v58
    v_exp_f32 v59, v59
    v_smfmac_f32_32x32x32_bf16 v[0:15], v[108:111], v[40:47], v143
    v_exp_f32 v60, v60
    v_exp_f32 v61, v61
    v_exp_f32 v62, v62
    v_exp_f32 v63, v63
    v_mfma_f32_32x32x16_bf16 v[32:47], v[80:83], v[134:137], 0
    ds_read_b128 v[80:83], v140 offset:20480
    v_exp_f32 v64, v64
    v_exp_f32 v65, v65
    v_exp_f32 v66, v66
    v_exp_f32 v67, v67
    v_mfma_f32_32x32x8_bf16 v[32:47], v[92:93], v[138:139], v[32:47]
    ds_read2st64_b64 v[88:91], v141 offset0:40 offset1:45
    v_exp_f32 v68, v68
    v_exp_f32 v69, v69
    v_exp_f32 v70, v70
    v_exp_f32 v71, v71
    v_smfmac_f32_32x32x32_bf16 v[16:31], v[104:107], v[48:55], v143
    v_exp_f32 v72, v72
    v_exp_f32 v73, v73
    v_exp_f32 v74, v74
    v_exp_f32 v75, v75
    v_smfmac_f32_32x32x32_bf16 v[16:31], v[108:111], v[56:63], v143
    s_mov_b64 exec, s[76:77]
    ds_read_b128 v[96:99], v142 offset:20480
    ds_read_b128 v[100:103], v142 offset:21760
    ds_read_b128 v[104:107], v142 offset:23040
    ds_read_b128 v[108:111], v142 offset:24320
    s_mov_b64 exec, -1
    v_exp_f32 v76, v76
    v_exp_f32 v77, v77
    v_exp_f32 v78, v78
    v_exp_f32 v79, v79
    s_waitcnt lgkmcnt(6)
    v_mfma_f32_32x32x16_bf16 v[48:63], v[84:87], v[128:131], 0
    v_exp_f32 v32, v32
    v_exp_f32 v33, v33
    v_exp_f32 v34, v34
    v_exp_f32 v35, v35
    v_mfma_f32_32x32x8_bf16 v[48:63], v[94:95], v[132:133], v[48:63]
    v_exp_f32 v36, v36
    v_exp_f32 v37, v37
    v_exp_f32 v38, v38
    v_exp_f32 v39, v39
    v_smfmac_f32_32x32x32_bf16 v[0:15], v[112:115], v[64:71], v143
    v_exp_f32 v40, v40
    v_exp_f32 v41, v41
    v_exp_f32 v42, v42
    v_exp_f32 v43, v43
    v_smfmac_f32_32x32x32_bf16 v[0:15], v[116:119], v[72:79], v143
    v_exp_f32 v44, v44
    v_exp_f32 v45, v45
    v_exp_f32 v46, v46
    v_exp_f32 v47, v47
    v_mfma_f32_32x32x16_bf16 v[64:79], v[84:87], v[134:137], 0
    ds_read_b128 v[84:87], v140 offset:23040
    v_exp_f32 v48, v48
    v_exp_f32 v49, v49
    v_exp_f32 v50, v50
    v_exp_f32 v51, v51
    v_mfma_f32_32x32x8_bf16 v[64:79], v[94:95], v[138:139], v[64:79]
    v_exp_f32 v52, v52
    v_exp_f32 v53, v53
    v_exp_f32 v54, v54
    v_exp_f32 v55, v55
    v_smfmac_f32_32x32x32_bf16 v[16:31], v[112:115], v[32:39], v143
    v_exp_f32 v56, v56
    v_exp_f32 v57, v57
    v_exp_f32 v58, v58
    v_exp_f32 v59, v59
    v_smfmac_f32_32x32x32_bf16 v[16:31], v[116:119], v[40:47], v143
    v_exp_f32 v60, v60
    v_exp_f32 v61, v61
    v_exp_f32 v62, v62
    v_exp_f32 v63, v63
    s_waitcnt lgkmcnt(6)
    v_mfma_f32_32x32x16_bf16 v[32:47], v[80:83], v[128:131], 0
    v_exp_f32 v64, v64
    v_exp_f32 v65, v65
    v_exp_f32 v66, v66
    v_exp_f32 v67, v67
    s_waitcnt lgkmcnt(5)
    v_mfma_f32_32x32x8_bf16 v[32:47], v[88:89], v[132:133], v[32:47]
    v_exp_f32 v68, v68
    v_exp_f32 v69, v69
    v_exp_f32 v70, v70
    v_exp_f32 v71, v71
    v_smfmac_f32_32x32x32_bf16 v[0:15], v[120:123], v[48:55], v143
    v_exp_f32 v72, v72
    v_exp_f32 v73, v73
    v_exp_f32 v74, v74
    v_exp_f32 v75, v75
    v_smfmac_f32_32x32x32_bf16 v[0:15], v[124:127], v[56:63], v143
    v_exp_f32 v76, v76
    v_exp_f32 v77, v77
    v_exp_f32 v78, v78
    v_exp_f32 v79, v79
    v_mfma_f32_32x32x16_bf16 v[48:63], v[80:83], v[134:137], 0
    ds_read_b128 v[80:83], v140 offset:25600
    v_exp_f32 v32, v32
    v_exp_f32 v33, v33
    v_exp_f32 v34, v34
    v_exp_f32 v35, v35
    v_mfma_f32_32x32x8_bf16 v[48:63], v[88:89], v[138:139], v[48:63]
    ds_read2st64_b64 v[92:95], v141 offset0:50 offset1:55
    v_exp_f32 v36, v36
    v_exp_f32 v37, v37
    v_exp_f32 v38, v38
    v_exp_f32 v39, v39
    v_smfmac_f32_32x32x32_bf16 v[16:31], v[120:123], v[64:71], v143
    v_exp_f32 v40, v40
    v_exp_f32 v41, v41
    v_exp_f32 v42, v42
    v_exp_f32 v43, v43
    v_smfmac_f32_32x32x32_bf16 v[16:31], v[124:127], v[72:79], v143
    s_mov_b64 exec, s[76:77]
    ds_read_b128 v[112:115], v142 offset:25600
    ds_read_b128 v[116:119], v142 offset:26880
    ds_read_b128 v[120:123], v142 offset:28160
    ds_read_b128 v[124:127], v142 offset:29440
    s_mov_b64 exec, -1
    v_exp_f32 v44, v44
    v_exp_f32 v45, v45
    v_exp_f32 v46, v46
    v_exp_f32 v47, v47
    s_waitcnt lgkmcnt(6)
    v_mfma_f32_32x32x16_bf16 v[64:79], v[84:87], v[128:131], 0
    v_exp_f32 v48, v48
    v_exp_f32 v49, v49
    v_exp_f32 v50, v50
    v_exp_f32 v51, v51
    v_mfma_f32_32x32x8_bf16 v[64:79], v[90:91], v[132:133], v[64:79]
    v_exp_f32 v52, v52
    v_exp_f32 v53, v53
    v_exp_f32 v54, v54
    v_exp_f32 v55, v55
    v_smfmac_f32_32x32x32_bf16 v[0:15], v[96:99], v[32:39], v143
    v_exp_f32 v56, v56
    v_exp_f32 v57, v57
    v_exp_f32 v58, v58
    v_exp_f32 v59, v59
    v_smfmac_f32_32x32x32_bf16 v[0:15], v[100:103], v[40:47], v143
    v_exp_f32 v60, v60
    v_exp_f32 v61, v61
    v_exp_f32 v62, v62
    v_exp_f32 v63, v63
    v_mfma_f32_32x32x16_bf16 v[32:47], v[84:87], v[134:137], 0
    ds_read_b128 v[84:87], v140 offset:28160
    v_exp_f32 v64, v64
    v_exp_f32 v65, v65
    v_exp_f32 v66, v66
    v_exp_f32 v67, v67
    v_mfma_f32_32x32x8_bf16 v[32:47], v[90:91], v[138:139], v[32:47]
    v_exp_f32 v68, v68
    v_exp_f32 v69, v69
    v_exp_f32 v70, v70
    v_exp_f32 v71, v71
    v_smfmac_f32_32x32x32_bf16 v[16:31], v[96:99], v[48:55], v143
    v_exp_f32 v72, v72
    v_exp_f32 v73, v73
    v_exp_f32 v74, v74
    v_exp_f32 v75, v75
    v_smfmac_f32_32x32x32_bf16 v[16:31], v[100:103], v[56:63], v143
    v_exp_f32 v76, v76
    v_exp_f32 v77, v77
    v_exp_f32 v78, v78
    v_exp_f32 v79, v79
    s_waitcnt lgkmcnt(6)
    v_mfma_f32_32x32x16_bf16 v[48:63], v[80:83], v[128:131], 0
    v_exp_f32 v32, v32
    v_exp_f32 v33, v33
    v_exp_f32 v34, v34
    v_exp_f32 v35, v35
    s_waitcnt lgkmcnt(5)
    v_mfma_f32_32x32x8_bf16 v[48:63], v[92:93], v[132:133], v[48:63]
    v_exp_f32 v36, v36
    v_exp_f32 v37, v37
    v_exp_f32 v38, v38
    v_exp_f32 v39, v39
    v_smfmac_f32_32x32x32_bf16 v[0:15], v[104:107], v[64:71], v143
    v_exp_f32 v40, v40
    v_exp_f32 v41, v41
    v_exp_f32 v42, v42
    v_exp_f32 v43, v43
    v_smfmac_f32_32x32x32_bf16 v[0:15], v[108:111], v[72:79], v143
    v_exp_f32 v44, v44
    v_exp_f32 v45, v45
    v_exp_f32 v46, v46
    v_exp_f32 v47, v47
    v_mfma_f32_32x32x16_bf16 v[64:79], v[80:83], v[134:137], 0
    v_exp_f32 v48, v48
    v_exp_f32 v49, v49
    v_exp_f32 v50, v50
    v_exp_f32 v51, v51
    v_mfma_f32_32x32x8_bf16 v[64:79], v[92:93], v[138:139], v[64:79]
    v_exp_f32 v52, v52
    v_exp_f32 v53, v53
    v_exp_f32 v54, v54
    v_exp_f32 v55, v55
    v_smfmac_f32_32x32x32_bf16 v[16:31], v[104:107], v[32:39], v143
    v_exp_f32 v56, v56
    v_exp_f32 v57, v57
    v_exp_f32 v58, v58
    v_exp_f32 v59, v59
    v_smfmac_f32_32x32x32_bf16 v[16:31], v[108:111], v[40:47], v143
    v_exp_f32 v60, v60
    v_exp_f32 v61, v61
    v_exp_f32 v62, v62
    v_exp_f32 v63, v63
    s_waitcnt lgkmcnt(0)
    v_mfma_f32_32x32x16_bf16 v[32:47], v[84:87], v[128:131], 0
    v_exp_f32 v64, v64
    v_exp_f32 v65, v65
    v_exp_f32 v66, v66
    v_exp_f32 v67, v67
    v_mfma_f32_32x32x8_bf16 v[32:47], v[94:95], v[132:133], v[32:47]
    v_exp_f32 v68, v68
    v_exp_f32 v69, v69
    v_exp_f32 v70, v70
    v_exp_f32 v71, v71
    v_smfmac_f32_32x32x32_bf16 v[0:15], v[112:115], v[48:55], v143
    v_exp_f32 v72, v72
    v_exp_f32 v73, v73
    v_exp_f32 v74, v74
    v_exp_f32 v75, v75
    v_smfmac_f32_32x32x32_bf16 v[0:15], v[116:119], v[56:63], v143
    v_exp_f32 v76, v76
    v_exp_f32 v77, v77
    v_exp_f32 v78, v78
    v_exp_f32 v79, v79
    v_mfma_f32_32x32x16_bf16 v[48:63], v[84:87], v[134:137], 0
    v_exp_f32 v32, v32
    v_exp_f32 v33, v33
    v_exp_f32 v34, v34
    v_exp_f32 v35, v35
    v_mfma_f32_32x32x8_bf16 v[48:63], v[94:95], v[138:139], v[48:63]
    v_exp_f32 v36, v36
    v_exp_f32 v37, v37
    v_exp_f32 v38, v38
    v_exp_f32 v39, v39
    v_smfmac_f32_32x32x32_bf16 v[16:31], v[112:115], v[64:71], v143
    v_exp_f32 v40, v40
    v_exp_f32 v41, v41
    v_exp_f32 v42, v42
    v_exp_f32 v43, v43
    v_smfmac_f32_32x32x32_bf16 v[16:31], v[116:119], v[72:79], v143
    v_exp_f32 v44, v44
    v_exp_f32 v45, v45
    v_exp_f32 v46, v46
    v_exp_f32 v47, v47
    v_exp_f32 v48, v48
    v_exp_f32 v49, v49
    v_exp_f32 v50, v50
    v_exp_f32 v51, v51
    v_exp_f32 v52, v52
    v_exp_f32 v53, v53
    v_exp_f32 v54, v54
    v_exp_f32 v55, v55
    v_smfmac_f32_32x32x32_bf16 v[0:15], v[120:123], v[32:39], v143
    v_exp_f32 v56, v56
    v_exp_f32 v57, v57
    v_exp_f32 v58, v58
    v_exp_f32 v59, v59
    v_smfmac_f32_32x32x32_bf16 v[0:15], v[124:127], v[40:47], v143
    v_exp_f32 v60, v60
    v_exp_f32 v61, v61
    v_exp_f32 v62, v62
    v_exp_f32 v63, v63
    v_smfmac_f32_32x32x32_bf16 v[16:31], v[120:123], v[48:55], v143
    s_nop 0
    v_smfmac_f32_32x32x32_bf16 v[16:31], v[124:127], v[56:63], v143
    s_barrier
L_fbret:
    s_nop 3
    v_cndmask_b32 v144, v12, v8, s[48:49]
    s_nop 5
    v_cndmask_b32 v146, v28, v24, s[48:49]
    v_rcp_f32 v148, v144
    v_rcp_f32 v150, v146
    v_mov_b32 v149, v148
    v_mov_b32 v151, v150
    v_pk_mul_f32 v[0:1], v[0:1], v[148:149]
    v_pk_mul_f32 v[2:3], v[2:3], v[148:149]
    v_pk_mul_f32 v[4:5], v[4:5], v[148:149]
    v_pk_mul_f32 v[6:7], v[6:7], v[148:149]
    v_pk_mul_f32 v[8:9], v[8:9], v[148:149]
    v_pk_mul_f32 v[10:11], v[10:11], v[148:149]
    v_cvt_pk_bf16_f32 v32, v0, v1
    v_cvt_pk_bf16_f32 v33, v2, v3
    v_cvt_pk_bf16_f32 v34, v4, v5
    v_cvt_pk_bf16_f32 v35, v6, v7
    v_cvt_pk_bf16_f32 v36, v8, v9
    v_cvt_pk_bf16_f32 v37, v10, v11
    v_pk_mul_f32 v[16:17], v[16:17], v[150:151]
    v_pk_mul_f32 v[18:19], v[18:19], v[150:151]
    v_pk_mul_f32 v[20:21], v[20:21], v[150:151]
    v_pk_mul_f32 v[22:23], v[22:23], v[150:151]
    v_pk_mul_f32 v[24:25], v[24:25], v[150:151]
    v_pk_mul_f32 v[26:27], v[26:27], v[150:151]
    v_cvt_pk_bf16_f32 v38, v16, v17
    v_cvt_pk_bf16_f32 v39, v18, v19
    v_cvt_pk_bf16_f32 v40, v20, v21
    v_cvt_pk_bf16_f32 v41, v22, v23
    v_cvt_pk_bf16_f32 v42, v24, v25
    v_cvt_pk_bf16_f32 v43, v26, v27
    s_cmp_eq_u32 s42, 0
    s_cbranch_scc1 L_slow7
    buffer_store_dwordx4 v[32:35], v227, s[36:39], s59 offen
    buffer_store_dwordx4 v[38:41], v227, s[36:39], s61 offen
    s_mov_b32 exec_hi, 0
    buffer_store_dwordx2 v[36:37], v226, s[36:39], s58 offen
    buffer_store_dwordx2 v[42:43], v226, s[36:39], s60 offen
    s_branch L_stend8
L_slow7:
    buffer_store_dwordx4 v[32:35], v227, s[36:39], s59 offen sc1
    buffer_store_dwordx4 v[38:41], v227, s[36:39], s61 offen sc1
    s_mov_b32 exec_hi, 0
    buffer_store_dwordx2 v[36:37], v226, s[36:39], s58 offen sc1
    buffer_store_dwordx2 v[42:43], v226, s[36:39], s60 offen sc1
L_stend8:
    s_mov_b32 exec_hi, -1
    v_pk_add_f32 v[0:1], v[0:1], v[16:17]
    v_pk_add_f32 v[2:3], v[2:3], v[18:19]
    v_pk_add_f32 v[4:5], v[4:5], v[20:21]
    v_pk_add_f32 v[6:7], v[6:7], v[22:23]
    v_pk_add_f32 v[8:9], v[8:9], v[24:25]
    v_pk_add_f32 v[10:11], v[10:11], v[26:27]
    v_min_f32 v148, v144, v146
    v_max_f32 v149, v144, v146
    v_pk_add_f32 v[0:1], v[0:1], v[2:3]
    v_pk_add_f32 v[4:5], v[4:5], v[6:7]
    v_pk_add_f32 v[8:9], v[8:9], v[10:11]
    v_cmp_nle_f32 s[50:51], s66, v148
    v_pk_add_f32 v[0:1], v[0:1], v[4:5]
    v_cmp_nge_f32 s[52:53], s67, v149
    v_pk_add_f32 v[0:1], v[0:1], v[8:9]
    v_add_f32 v144, v144, v146
    v_add_f32 v0, v0, v1
    v_add_f32 v0, |v0|, v144
    s_or_b64 s[50:51], s[50:51], s[52:53]
    v_cmp_nge_f32 vcc, 0x7e800000, v0
    s_nop 0
    s_or_b64 s[50:51], s[50:51], vcc
    s_cmp_lg_u64 s[50:51], 0
    s_cselect_b32 s65, 1, 0
    s_cmp_gt_u32 s65, s64
    s_cbranch_scc1 L_fallback
    ds_read_b64_tr_b16 v[200:201], v225 offset:46080
    ds_read_b64_tr_b16 v[202:203], v225 offset:48640
    ds_read_b64_tr_b16 v[204:205], v225 offset:46112
    ds_read_b64_tr_b16 v[206:207], v225 offset:48672
    ds_read_b64_tr_b16 v[208:209], v225 offset:46144
    ds_read_b64_tr_b16 v[210:211], v225 offset:48704
    ds_read_b64_tr_b16 v[212:213], v225 offset:46176
    ds_read_b64_tr_b16 v[214:215], v225 offset:48736
    ds_read_b64_tr_b16 v[216:217], v225 offset:46208
    ds_read_b64_tr_b16 v[218:219], v225 offset:48768
    ds_read_b64_tr_b16 v[140:141], v225 offset:40960
    ds_read_b64_tr_b16 v[142:143], v225 offset:43520
    ds_read_b64_tr_b16 v[144:145], v225 offset:40992
    ds_read_b64_tr_b16 v[146:147], v225 offset:43552
    ds_read_b64_tr_b16 v[148:149], v225 offset:41024
    ds_read_b64_tr_b16 v[150:151], v225 offset:43584
    ds_read_b64_tr_b16 v[152:153], v225 offset:41056
    ds_read_b64_tr_b16 v[154:155], v225 offset:43616
    ds_read_b64_tr_b16 v[156:157], v225 offset:41088
    ds_read_b64_tr_b16 v[158:159], v225 offset:43648
    v_mov_b32 v247, s40
    s_mov_b64 exec, 1
    s_waitcnt vmcnt(0)
    s_cmp_eq_u32 s42, 0
    s_cbranch_scc1 L_slow9
    buffer_store_dword v247, off, s[36:39], s56
    s_branch L_stend10
L_slow9:
    buffer_store_dword v247, off, s[36:39], s56 sc1
L_stend10:
    s_mov_b64 exec, -1
    buffer_load_dwordx4 v[160:163], v240, s[28:31], s55 offen
    buffer_load_dwordx4 v[164:167], v241, s[28:31], s55 offen
    buffer_load_dwordx4 v[168:171], v242, s[28:31], s55 offen
    buffer_load_dwordx4 v[172:175], v243, s[28:31], s55 offen
    buffer_load_dwordx4 v[176:179], v244, s[28:31], s55 offen
    s_add_u32 s55, s55, 40960
    buffer_load_dwordx4 v[180:183], v240, s[28:31], s55 offen
    buffer_load_dwordx4 v[184:187], v241, s[28:31], s55 offen
    buffer_load_dwordx4 v[188:191], v242, s[28:31], s55 offen
    buffer_load_dwordx4 v[192:195], v243, s[28:31], s55 offen
    buffer_load_dwordx4 v[196:199], v244, s[28:31], s55 offen
    s_add_u32 s55, s55, 40960
    ds_read_b64_tr_b16 v[120:121], v225 offset:35840
    ds_read_b64_tr_b16 v[122:123], v225 offset:38400
    ds_read_b64_tr_b16 v[124:125], v225 offset:35872
    ds_read_b64_tr_b16 v[126:127], v225 offset:38432
    ds_read_b64_tr_b16 v[128:129], v225 offset:35904
    ds_read_b64_tr_b16 v[130:131], v225 offset:38464
    ds_read_b64_tr_b16 v[132:133], v225 offset:35936
    ds_read_b64_tr_b16 v[134:135], v225 offset:38496
    ds_read_b64_tr_b16 v[136:137], v225 offset:35968
    ds_read_b64_tr_b16 v[138:139], v225 offset:38528
    ds_read_b64_tr_b16 v[100:101], v225 offset:30720
    ds_read_b64_tr_b16 v[102:103], v225 offset:33280
    ds_read_b64_tr_b16 v[104:105], v225 offset:30752
    ds_read_b64_tr_b16 v[106:107], v225 offset:33312
    ds_read_b64_tr_b16 v[108:109], v225 offset:30784
    ds_read_b64_tr_b16 v[110:111], v225 offset:33344
    ds_read_b64_tr_b16 v[112:113], v225 offset:30816
    ds_read_b64_tr_b16 v[114:115], v225 offset:33376
    ds_read_b64_tr_b16 v[116:117], v225 offset:30848
    ds_read_b64_tr_b16 v[118:119], v225 offset:33408
    v_permlane16_swap_b32 v230, v232
    v_permlane16_swap_b32 v231, v233
    v_permlane16_swap_b32 v236, v238
    v_permlane16_swap_b32 v237, v239
    s_mov_b32 s79, 0xffff0000
    v_and_b32 v221, 15, v245
    v_lshrrev_b32 v222, 5, v245
    v_bfe_u32 v223, v245, 4, 1
    v_lshlrev_b32 v228, 4, v221
    v_lshl_add_u32 v227, v222, 9, v228
    v_lshl_add_u32 v226, v223, 10, v227
    v_lshl_add_u32 v227, v223, 3, v227
    s_lshl_b32 s56, s6, 1
    s_add_u32 s56, s56, s43
    s_lshl_b32 s61, s44, 8
    s_mul_i32 s60, s56, 40960
    s_add_u32 s60, s60, s61
    s_mul_i32 s58, s7, 5120
    s_add_u32 s60, s60, s58
    s_add_u32 s60, s60, 0
    s_lshl_b32 s58, s56, 11
    s_add_u32 s58, s58, s61
    s_lshr_b32 s59, s7, 1
    s_lshl_b32 s59, s59, 9
    s_add_u32 s58, s58, s59
    s_and_b32 s59, s7, 1
    s_lshl_b32 s59, s59, 3
    s_add_u32 s58, s58, s59
    s_add_u32 s58, s58, 262144
    s_lshl_b32 s56, s56, 7
    s_lshl_b32 s59, s7, 3
    s_add_u32 s56, s56, s59
    s_lshl_b32 s59, s44, 2
    s_add_u32 s56, s56, s59
    s_add_u32 s56, s56, 45056
    v_lshlrev_b32 v80, 16, v230
    v_and_b32 v81, s79, v230
    v_lshlrev_b32 v82, 16, v231
    v_and_b32 v83, s79, v231
    v_lshlrev_b32 v84, 16, v232
    v_and_b32 v85, s79, v232
    v_lshlrev_b32 v86, 16, v233
    v_and_b32 v87, s79, v233
    v_lshlrev_b32 v88, 16, v234
    v_and_b32 v89, s79, v234
    v_lshlrev_b32 v90, 16, v235
    v_and_b32 v91, s79, v235
    v_lshlrev_b32 v92, 16, v236
    v_and_b32 v93, s79, v236
    v_lshlrev_b32 v94, 16, v237
    v_and_b32 v95, s79, v237
    v_lshlrev_b32 v96, 16, v238
    v_and_b32 v97, s79, v238
    v_lshlrev_b32 v98, 16, v239
    v_and_b32 v99, s79, v239
    s_mov_b32 s78, 0
L_poll11:
    buffer_load_dword v223, v229, s[36:39], s62 offen sc1
    s_add_u32 s78, s78, 1
    s_cmp_gt_u32 s78, 0x8000
    s_cbranch_scc1 L_pdone12
    s_waitcnt vmcnt(0)
    v_cmp_ne_u32 vcc, s40, v223
    s_nop 4
    s_cbranch_vccnz L_poll11
L_pdone12:
    s_waitcnt vmcnt(0)
    buffer_load_dwordx4 v[76:79], v246, s[36:39], s57 offen offset:3072 sc1
    buffer_load_dwordx4 v[72:75], v246, s[36:39], s57 offen offset:2048 sc1
    buffer_load_dwordx4 v[68:71], v246, s[36:39], s57 offen offset:1024 sc1
    buffer_load_dwordx4 v[64:67], v246, s[36:39], s57 offen offset:0 sc1
    s_sub_u32 s57, s57, 4096
    buffer_load_dwordx4 v[60:63], v246, s[36:39], s57 offen offset:3072 sc1
    buffer_load_dwordx4 v[56:59], v246, s[36:39], s57 offen offset:2048 sc1
    buffer_load_dwordx4 v[52:55], v246, s[36:39], s57 offen offset:1024 sc1
    buffer_load_dwordx4 v[48:51], v246, s[36:39], s57 offen offset:0 sc1
    s_sub_u32 s57, s57, 4096
    s_waitcnt lgkmcnt(0)
    s_waitcnt vmcnt(7)
    v_mfma_f32_16x16x32_bf16 v[80:83], v[200:203], v[76:79], v[80:83]
    buffer_load_dwordx4 v[44:47], v246, s[36:39], s57 offen offset:3072 sc1
    ds_read_b64_tr_b16 v[200:201], v225 offset:25600
    ds_read_b64_tr_b16 v[202:203], v225 offset:28160
    v_mfma_f32_16x16x32_bf16 v[84:87], v[204:207], v[76:79], v[84:87]
    ds_read_b64_tr_b16 v[204:205], v225 offset:25632
    ds_read_b64_tr_b16 v[206:207], v225 offset:28192
    v_mfma_f32_16x16x32_bf16 v[88:91], v[208:211], v[76:79], v[88:91]
    buffer_load_dwordx4 v[40:43], v246, s[36:39], s57 offen offset:2048 sc1
    ds_read_b64_tr_b16 v[208:209], v225 offset:25664
    ds_read_b64_tr_b16 v[210:211], v225 offset:28224
    v_mfma_f32_16x16x32_bf16 v[92:95], v[212:215], v[76:79], v[92:95]
    ds_read_b64_tr_b16 v[212:213], v225 offset:25696
    ds_read_b64_tr_b16 v[214:215], v225 offset:28256
    v_mfma_f32_16x16x32_bf16 v[96:99], v[216:219], v[76:79], v[96:99]
    ds_read_b64_tr_b16 v[216:217], v225 offset:25728
    ds_read_b64_tr_b16 v[218:219], v225 offset:28288
    s_waitcnt vmcnt(8)
    v_mfma_f32_16x16x32_bf16 v[80:83], v[140:143], v[72:75], v[80:83]
    buffer_load_dwordx4 v[36:39], v246, s[36:39], s57 offen offset:1024 sc1
    ds_read_b64_tr_b16 v[140:141], v225 offset:20480
    ds_read_b64_tr_b16 v[142:143], v225 offset:23040
    v_mfma_f32_16x16x32_bf16 v[84:87], v[144:147], v[72:75], v[84:87]
    ds_read_b64_tr_b16 v[144:145], v225 offset:20512
    ds_read_b64_tr_b16 v[146:147], v225 offset:23072
    v_mfma_f32_16x16x32_bf16 v[88:91], v[148:151], v[72:75], v[88:91]
    buffer_load_dwordx4 v[32:35], v246, s[36:39], s57 offen offset:0 sc1
    s_sub_u32 s57, s57, 4096
    ds_read_b64_tr_b16 v[148:149], v225 offset:20544
    ds_read_b64_tr_b16 v[150:151], v225 offset:23104
    v_mfma_f32_16x16x32_bf16 v[92:95], v[152:155], v[72:75], v[92:95]
    ds_read_b64_tr_b16 v[152:153], v225 offset:20576
    ds_read_b64_tr_b16 v[154:155], v225 offset:23136
    v_mfma_f32_16x16x32_bf16 v[96:99], v[156:159], v[72:75], v[96:99]
    ds_read_b64_tr_b16 v[156:157], v225 offset:20608
    ds_read_b64_tr_b16 v[158:159], v225 offset:23168
    s_waitcnt vmcnt(9)
    v_mfma_f32_16x16x32_bf16 v[80:83], v[120:123], v[68:71], v[80:83]
    buffer_load_dwordx4 v[28:31], v246, s[36:39], s57 offen offset:3072 sc1
    ds_read_b64_tr_b16 v[120:121], v225 offset:15360
    ds_read_b64_tr_b16 v[122:123], v225 offset:17920
    v_mfma_f32_16x16x32_bf16 v[84:87], v[124:127], v[68:71], v[84:87]
    ds_read_b64_tr_b16 v[124:125], v225 offset:15392
    ds_read_b64_tr_b16 v[126:127], v225 offset:17952
    v_mfma_f32_16x16x32_bf16 v[88:91], v[128:131], v[68:71], v[88:91]
    buffer_load_dwordx4 v[24:27], v246, s[36:39], s57 offen offset:2048 sc1
    ds_read_b64_tr_b16 v[128:129], v225 offset:15424
    ds_read_b64_tr_b16 v[130:131], v225 offset:17984
    v_mfma_f32_16x16x32_bf16 v[92:95], v[132:135], v[68:71], v[92:95]
    ds_read_b64_tr_b16 v[132:133], v225 offset:15456
    ds_read_b64_tr_b16 v[134:135], v225 offset:18016
    v_mfma_f32_16x16x32_bf16 v[96:99], v[136:139], v[68:71], v[96:99]
    ds_read_b64_tr_b16 v[136:137], v225 offset:15488
    ds_read_b64_tr_b16 v[138:139], v225 offset:18048
    s_waitcnt vmcnt(10)
    v_mfma_f32_16x16x32_bf16 v[80:83], v[100:103], v[64:67], v[80:83]
    buffer_load_dwordx4 v[20:23], v246, s[36:39], s57 offen offset:1024 sc1
    ds_read_b64_tr_b16 v[100:101], v225 offset:10240
    ds_read_b64_tr_b16 v[102:103], v225 offset:12800
    v_mfma_f32_16x16x32_bf16 v[84:87], v[104:107], v[64:67], v[84:87]
    ds_read_b64_tr_b16 v[104:105], v225 offset:10272
    ds_read_b64_tr_b16 v[106:107], v225 offset:12832
    v_mfma_f32_16x16x32_bf16 v[88:91], v[108:111], v[64:67], v[88:91]
    buffer_load_dwordx4 v[16:19], v246, s[36:39], s57 offen offset:0 sc1
    s_sub_u32 s57, s57, 4096
    ds_read_b64_tr_b16 v[108:109], v225 offset:10304
    ds_read_b64_tr_b16 v[110:111], v225 offset:12864
    v_mfma_f32_16x16x32_bf16 v[92:95], v[112:115], v[64:67], v[92:95]
    ds_read_b64_tr_b16 v[112:113], v225 offset:10336
    ds_read_b64_tr_b16 v[114:115], v225 offset:12896
    v_mfma_f32_16x16x32_bf16 v[96:99], v[116:119], v[64:67], v[96:99]
    ds_read_b64_tr_b16 v[116:117], v225 offset:10368
    ds_read_b64_tr_b16 v[118:119], v225 offset:12928
    s_waitcnt vmcnt(11)
    s_waitcnt lgkmcnt(15)
    v_mfma_f32_16x16x32_bf16 v[80:83], v[200:203], v[60:63], v[80:83]
    buffer_load_dwordx4 v[12:15], v246, s[36:39], s57 offen offset:3072 sc1
    ds_read_b64_tr_b16 v[200:201], v225 offset:5120
    ds_read_b64_tr_b16 v[202:203], v225 offset:7680
    v_mfma_f32_16x16x32_bf16 v[84:87], v[204:207], v[60:63], v[84:87]
    ds_read_b64_tr_b16 v[204:205], v225 offset:5152
    ds_read_b64_tr_b16 v[206:207], v225 offset:7712
    v_mfma_f32_16x16x32_bf16 v[88:91], v[208:211], v[60:63], v[88:91]
    ds_read_b64_tr_b16 v[208:209], v225 offset:5184
    ds_read_b64_tr_b16 v[210:211], v225 offset:7744
    v_mfma_f32_16x16x32_bf16 v[92:95], v[212:215], v[60:63], v[92:95]
    ds_read_b64_tr_b16 v[212:213], v225 offset:5216
    ds_read_b64_tr_b16 v[214:215], v225 offset:7776
    v_mfma_f32_16x16x32_bf16 v[96:99], v[216:219], v[60:63], v[96:99]
    ds_read_b64_tr_b16 v[216:217], v225 offset:5248
    ds_read_b64_tr_b16 v[218:219], v225 offset:7808
    s_waitcnt vmcnt(11)
    v_mfma_f32_16x16x32_bf16 v[80:83], v[140:143], v[56:59], v[80:83]
    buffer_load_dwordx4 v[8:11], v246, s[36:39], s57 offen offset:2048 sc1
    ds_read_b64_tr_b16 v[140:141], v225 offset:0
    ds_read_b64_tr_b16 v[142:143], v225 offset:2560
    v_mfma_f32_16x16x32_bf16 v[84:87], v[144:147], v[56:59], v[84:87]
    ds_read_b64_tr_b16 v[144:145], v225 offset:32
    ds_read_b64_tr_b16 v[146:147], v225 offset:2592
    v_mfma_f32_16x16x32_bf16 v[88:91], v[148:151], v[56:59], v[88:91]
    ds_read_b64_tr_b16 v[148:149], v225 offset:64
    ds_read_b64_tr_b16 v[150:151], v225 offset:2624
    v_mfma_f32_16x16x32_bf16 v[92:95], v[152:155], v[56:59], v[92:95]
    ds_read_b64_tr_b16 v[152:153], v225 offset:96
    ds_read_b64_tr_b16 v[154:155], v225 offset:2656
    v_mfma_f32_16x16x32_bf16 v[96:99], v[156:159], v[56:59], v[96:99]
    ds_read_b64_tr_b16 v[156:157], v225 offset:128
    ds_read_b64_tr_b16 v[158:159], v225 offset:2688
    s_waitcnt vmcnt(11)
    v_mfma_f32_16x16x32_bf16 v[80:83], v[120:123], v[52:55], v[80:83]
    buffer_load_dwordx4 v[4:7], v246, s[36:39], s57 offen offset:1024 sc1
    ds_read_b64_tr_b16 v[120:121], v220 offset:46080
    ds_read_b64_tr_b16 v[122:123], v220 offset:48640
    v_mfma_f32_16x16x32_bf16 v[84:87], v[124:127], v[52:55], v[84:87]
    ds_read_b64_tr_b16 v[124:125], v220 offset:46112
    ds_read_b64_tr_b16 v[126:127], v220 offset:48672
    s_waitcnt lgkmcnt(15)
    v_mfma_f32_16x16x32_bf16 v[88:91], v[128:131], v[52:55], v[88:91]
    ds_read_b64_tr_b16 v[128:129], v220 offset:46144
    ds_read_b64_tr_b16 v[130:131], v220 offset:48704
    v_mfma_f32_16x16x32_bf16 v[92:95], v[132:135], v[52:55], v[92:95]
    ds_read_b64_tr_b16 v[132:133], v220 offset:46176
    ds_read_b64_tr_b16 v[134:135], v220 offset:48736
    v_mfma_f32_16x16x32_bf16 v[96:99], v[136:139], v[52:55], v[96:99]
    ds_read_b64_tr_b16 v[136:137], v220 offset:46208
    ds_read_b64_tr_b16 v[138:139], v220 offset:48768
    s_waitcnt vmcnt(11)
    v_mfma_f32_16x16x32_bf16 v[80:83], v[100:103], v[48:51], v[80:83]
    buffer_load_dwordx4 v[0:3], v246, s[36:39], s57 offen offset:0 sc1
    ds_read_b64_tr_b16 v[100:101], v220 offset:40960
    ds_read_b64_tr_b16 v[102:103], v220 offset:43520
    v_mfma_f32_16x16x32_bf16 v[84:87], v[104:107], v[48:51], v[84:87]
    ds_read_b64_tr_b16 v[104:105], v220 offset:40992
    ds_read_b64_tr_b16 v[106:107], v220 offset:43552
    v_mfma_f32_16x16x32_bf16 v[88:91], v[108:111], v[48:51], v[88:91]
    ds_read_b64_tr_b16 v[108:109], v220 offset:41024
    ds_read_b64_tr_b16 v[110:111], v220 offset:43584
    v_mfma_f32_16x16x32_bf16 v[92:95], v[112:115], v[48:51], v[92:95]
    ds_read_b64_tr_b16 v[112:113], v220 offset:41056
    ds_read_b64_tr_b16 v[114:115], v220 offset:43616
    v_mfma_f32_16x16x32_bf16 v[96:99], v[116:119], v[48:51], v[96:99]
    ds_read_b64_tr_b16 v[116:117], v220 offset:41088
    ds_read_b64_tr_b16 v[118:119], v220 offset:43648
    s_waitcnt vmcnt(11)
    v_mfma_f32_16x16x32_bf16 v[80:83], v[200:203], v[44:47], v[80:83]
    ds_read_b64_tr_b16 v[200:201], v220 offset:35840
    ds_read_b64_tr_b16 v[202:203], v220 offset:38400
    v_mfma_f32_16x16x32_bf16 v[84:87], v[204:207], v[44:47], v[84:87]
    ds_read_b64_tr_b16 v[204:205], v220 offset:35872
    ds_read_b64_tr_b16 v[206:207], v220 offset:38432
    v_mfma_f32_16x16x32_bf16 v[88:91], v[208:211], v[44:47], v[88:91]
    ds_read_b64_tr_b16 v[208:209], v220 offset:35904
    ds_read_b64_tr_b16 v[210:211], v220 offset:38464
    v_mfma_f32_16x16x32_bf16 v[92:95], v[212:215], v[44:47], v[92:95]
    ds_read_b64_tr_b16 v[212:213], v220 offset:35936
    ds_read_b64_tr_b16 v[214:215], v220 offset:38496
    s_waitcnt lgkmcnt(15)
    v_mfma_f32_16x16x32_bf16 v[96:99], v[216:219], v[44:47], v[96:99]
    ds_read_b64_tr_b16 v[216:217], v220 offset:35968
    ds_read_b64_tr_b16 v[218:219], v220 offset:38528
    s_waitcnt vmcnt(10)
    v_mfma_f32_16x16x32_bf16 v[80:83], v[140:143], v[40:43], v[80:83]
    ds_read_b64_tr_b16 v[140:141], v220 offset:30720
    ds_read_b64_tr_b16 v[142:143], v220 offset:33280
    v_mfma_f32_16x16x32_bf16 v[84:87], v[144:147], v[40:43], v[84:87]
    ds_read_b64_tr_b16 v[144:145], v220 offset:30752
    ds_read_b64_tr_b16 v[146:147], v220 offset:33312
    v_mfma_f32_16x16x32_bf16 v[88:91], v[148:151], v[40:43], v[88:91]
    ds_read_b64_tr_b16 v[148:149], v220 offset:30784
    ds_read_b64_tr_b16 v[150:151], v220 offset:33344
    v_mfma_f32_16x16x32_bf16 v[92:95], v[152:155], v[40:43], v[92:95]
    ds_read_b64_tr_b16 v[152:153], v220 offset:30816
    ds_read_b64_tr_b16 v[154:155], v220 offset:33376
    v_mfma_f32_16x16x32_bf16 v[96:99], v[156:159], v[40:43], v[96:99]
    ds_read_b64_tr_b16 v[156:157], v220 offset:30848
    ds_read_b64_tr_b16 v[158:159], v220 offset:33408
    s_waitcnt vmcnt(9)
    v_mfma_f32_16x16x32_bf16 v[80:83], v[120:123], v[36:39], v[80:83]
    ds_read_b64_tr_b16 v[120:121], v220 offset:25600
    ds_read_b64_tr_b16 v[122:123], v220 offset:28160
    v_mfma_f32_16x16x32_bf16 v[84:87], v[124:127], v[36:39], v[84:87]
    ds_read_b64_tr_b16 v[124:125], v220 offset:25632
    ds_read_b64_tr_b16 v[126:127], v220 offset:28192
    v_mfma_f32_16x16x32_bf16 v[88:91], v[128:131], v[36:39], v[88:91]
    ds_read_b64_tr_b16 v[128:129], v220 offset:25664
    ds_read_b64_tr_b16 v[130:131], v220 offset:28224
    v_mfma_f32_16x16x32_bf16 v[92:95], v[132:135], v[36:39], v[92:95]
    ds_read_b64_tr_b16 v[132:133], v220 offset:25696
    ds_read_b64_tr_b16 v[134:135], v220 offset:28256
    v_mfma_f32_16x16x32_bf16 v[96:99], v[136:139], v[36:39], v[96:99]
    ds_read_b64_tr_b16 v[136:137], v220 offset:25728
    ds_read_b64_tr_b16 v[138:139], v220 offset:28288
    s_waitcnt vmcnt(8)
    v_mfma_f32_16x16x32_bf16 v[80:83], v[100:103], v[32:35], v[80:83]
    ds_read_b64_tr_b16 v[100:101], v220 offset:20480
    ds_read_b64_tr_b16 v[102:103], v220 offset:23040
    s_waitcnt lgkmcnt(15)
    v_mfma_f32_16x16x32_bf16 v[84:87], v[104:107], v[32:35], v[84:87]
    ds_read_b64_tr_b16 v[104:105], v220 offset:20512
    ds_read_b64_tr_b16 v[106:107], v220 offset:23072
    v_mfma_f32_16x16x32_bf16 v[88:91], v[108:111], v[32:35], v[88:91]
    ds_read_b64_tr_b16 v[108:109], v220 offset:20544
    ds_read_b64_tr_b16 v[110:111], v220 offset:23104
    v_mfma_f32_16x16x32_bf16 v[92:95], v[112:115], v[32:35], v[92:95]
    ds_read_b64_tr_b16 v[112:113], v220 offset:20576
    ds_read_b64_tr_b16 v[114:115], v220 offset:23136
    s_barrier
    v_mfma_f32_16x16x32_bf16 v[96:99], v[116:119], v[32:35], v[96:99]
    ds_read_b64_tr_b16 v[116:117], v220 offset:20608
    ds_read_b64_tr_b16 v[118:119], v220 offset:23168
    s_waitcnt vmcnt(7)
    v_mfma_f32_16x16x32_bf16 v[80:83], v[200:203], v[28:31], v[80:83]
    ds_read_b64_tr_b16 v[200:201], v220 offset:15360
    ds_read_b64_tr_b16 v[202:203], v220 offset:17920
    v_mfma_f32_16x16x32_bf16 v[84:87], v[204:207], v[28:31], v[84:87]
    ds_read_b64_tr_b16 v[204:205], v220 offset:15392
    ds_read_b64_tr_b16 v[206:207], v220 offset:17952
    v_mfma_f32_16x16x32_bf16 v[88:91], v[208:211], v[28:31], v[88:91]
    ds_read_b64_tr_b16 v[208:209], v220 offset:15424
    ds_read_b64_tr_b16 v[210:211], v220 offset:17984
    v_mfma_f32_16x16x32_bf16 v[92:95], v[212:215], v[28:31], v[92:95]
    ds_read_b64_tr_b16 v[212:213], v220 offset:15456
    ds_read_b64_tr_b16 v[214:215], v220 offset:18016
    v_mfma_f32_16x16x32_bf16 v[96:99], v[216:219], v[28:31], v[96:99]
    ds_read_b64_tr_b16 v[216:217], v220 offset:15488
    ds_read_b64_tr_b16 v[218:219], v220 offset:18048
    s_waitcnt vmcnt(6)
    v_mfma_f32_16x16x32_bf16 v[80:83], v[140:143], v[24:27], v[80:83]
    ds_read_b64_tr_b16 v[140:141], v220 offset:10240
    ds_read_b64_tr_b16 v[142:143], v220 offset:12800
    v_mfma_f32_16x16x32_bf16 v[84:87], v[144:147], v[24:27], v[84:87]
    ds_read_b64_tr_b16 v[144:145], v220 offset:10272
    ds_read_b64_tr_b16 v[146:147], v220 offset:12832
    v_mfma_f32_16x16x32_bf16 v[88:91], v[148:151], v[24:27], v[88:91]
    ds_read_b64_tr_b16 v[148:149], v220 offset:10304
    ds_read_b64_tr_b16 v[150:151], v220 offset:12864
    s_waitcnt lgkmcnt(15)
    v_mfma_f32_16x16x32_bf16 v[92:95], v[152:155], v[24:27], v[92:95]
    ds_read_b64_tr_b16 v[152:153], v220 offset:10336
    ds_read_b64_tr_b16 v[154:155], v220 offset:12896
    v_mfma_f32_16x16x32_bf16 v[96:99], v[156:159], v[24:27], v[96:99]
    ds_read_b64_tr_b16 v[156:157], v220 offset:10368
    ds_read_b64_tr_b16 v[158:159], v220 offset:12928
    s_waitcnt vmcnt(5)
    v_mfma_f32_16x16x32_bf16 v[80:83], v[120:123], v[20:23], v[80:83]
    ds_read_b64_tr_b16 v[120:121], v220 offset:5120
    ds_read_b64_tr_b16 v[122:123], v220 offset:7680
    v_mfma_f32_16x16x32_bf16 v[84:87], v[124:127], v[20:23], v[84:87]
    ds_read_b64_tr_b16 v[124:125], v220 offset:5152
    ds_read_b64_tr_b16 v[126:127], v220 offset:7712
    v_mfma_f32_16x16x32_bf16 v[88:91], v[128:131], v[20:23], v[88:91]
    ds_read_b64_tr_b16 v[128:129], v220 offset:5184
    ds_read_b64_tr_b16 v[130:131], v220 offset:7744
    v_mfma_f32_16x16x32_bf16 v[92:95], v[132:135], v[20:23], v[92:95]
    ds_read_b64_tr_b16 v[132:133], v220 offset:5216
    ds_read_b64_tr_b16 v[134:135], v220 offset:7776
    v_mfma_f32_16x16x32_bf16 v[96:99], v[136:139], v[20:23], v[96:99]
    ds_read_b64_tr_b16 v[136:137], v220 offset:5248
    ds_read_b64_tr_b16 v[138:139], v220 offset:7808
    s_waitcnt vmcnt(4)
    v_mfma_f32_16x16x32_bf16 v[80:83], v[100:103], v[16:19], v[80:83]
    ds_read_b64_tr_b16 v[100:101], v220 offset:0
    ds_read_b64_tr_b16 v[102:103], v220 offset:2560
    v_mfma_f32_16x16x32_bf16 v[84:87], v[104:107], v[16:19], v[84:87]
    ds_read_b64_tr_b16 v[104:105], v220 offset:32
    ds_read_b64_tr_b16 v[106:107], v220 offset:2592
    v_mfma_f32_16x16x32_bf16 v[88:91], v[108:111], v[16:19], v[88:91]
    ds_read_b64_tr_b16 v[108:109], v220 offset:64
    ds_read_b64_tr_b16 v[110:111], v220 offset:2624
    v_mfma_f32_16x16x32_bf16 v[92:95], v[112:115], v[16:19], v[92:95]
    ds_read_b64_tr_b16 v[112:113], v220 offset:96
    ds_read_b64_tr_b16 v[114:115], v220 offset:2656
    v_mfma_f32_16x16x32_bf16 v[96:99], v[116:119], v[16:19], v[96:99]
    ds_read_b64_tr_b16 v[116:117], v220 offset:128
    ds_read_b64_tr_b16 v[118:119], v220 offset:2688
    s_waitcnt vmcnt(3)
    s_waitcnt lgkmcnt(15)
    v_mfma_f32_16x16x32_bf16 v[80:83], v[200:203], v[12:15], v[80:83]
    v_mfma_f32_16x16x32_bf16 v[84:87], v[204:207], v[12:15], v[84:87]
    v_mfma_f32_16x16x32_bf16 v[88:91], v[208:211], v[12:15], v[88:91]
    v_mfma_f32_16x16x32_bf16 v[92:95], v[212:215], v[12:15], v[92:95]
    v_mfma_f32_16x16x32_bf16 v[96:99], v[216:219], v[12:15], v[96:99]
    s_waitcnt vmcnt(2)
    v_mfma_f32_16x16x32_bf16 v[80:83], v[140:143], v[8:11], v[80:83]
    v_mfma_f32_16x16x32_bf16 v[84:87], v[144:147], v[8:11], v[84:87]
    v_mfma_f32_16x16x32_bf16 v[88:91], v[148:151], v[8:11], v[88:91]
    v_mfma_f32_16x16x32_bf16 v[92:95], v[152:155], v[8:11], v[92:95]
    v_mfma_f32_16x16x32_bf16 v[96:99], v[156:159], v[8:11], v[96:99]
    s_waitcnt vmcnt(1)
    v_mfma_f32_16x16x32_bf16 v[80:83], v[120:123], v[4:7], v[80:83]
    v_mfma_f32_16x16x32_bf16 v[84:87], v[124:127], v[4:7], v[84:87]
    s_waitcnt lgkmcnt(14)
    v_mfma_f32_16x16x32_bf16 v[88:91], v[128:131], v[4:7], v[88:91]
    s_waitcnt lgkmcnt(12)
    v_mfma_f32_16x16x32_bf16 v[92:95], v[132:135], v[4:7], v[92:95]
    s_waitcnt lgkmcnt(10)
    v_mfma_f32_16x16x32_bf16 v[96:99], v[136:139], v[4:7], v[96:99]
    s_waitcnt vmcnt(0)
    s_waitcnt lgkmcnt(8)
    v_mfma_f32_16x16x32_bf16 v[80:83], v[100:103], v[0:3], v[80:83]
    s_waitcnt lgkmcnt(6)
    v_mfma_f32_16x16x32_bf16 v[84:87], v[104:107], v[0:3], v[84:87]
    s_waitcnt lgkmcnt(4)
    v_mfma_f32_16x16x32_bf16 v[88:91], v[108:111], v[0:3], v[88:91]
    s_waitcnt lgkmcnt(2)
    v_mfma_f32_16x16x32_bf16 v[92:95], v[112:115], v[0:3], v[92:95]
    s_waitcnt lgkmcnt(0)
    v_mfma_f32_16x16x32_bf16 v[96:99], v[116:119], v[0:3], v[96:99]
    v_cvt_pk_bf16_f32 v16, v80, v81
    v_cvt_pk_bf16_f32 v17, v82, v83
    v_cvt_pk_bf16_f32 v18, v84, v85
    v_cvt_pk_bf16_f32 v19, v86, v87
    v_cvt_pk_bf16_f32 v20, v88, v89
    v_cvt_pk_bf16_f32 v21, v90, v91
    v_cvt_pk_bf16_f32 v22, v92, v93
    v_cvt_pk_bf16_f32 v23, v94, v95
    v_cvt_pk_bf16_f32 v24, v96, v97
    v_cvt_pk_bf16_f32 v25, v98, v99
    v_permlane16_swap_b32 v16, v18
    v_permlane16_swap_b32 v17, v19
    v_permlane16_swap_b32 v22, v24
    v_permlane16_swap_b32 v23, v25
    s_cmp_eq_u32 s42, 0
    s_cbranch_scc1 L_slow13
    buffer_store_dwordx4 v[16:19], v226, s[32:35], s60 offen
    buffer_store_dwordx2 v[20:21], v227, s[32:35], s60 offen offset:2048
    buffer_store_dwordx4 v[22:25], v226, s[32:35], s60 offen offset:3072
    s_branch L_stend14
L_slow13:
    buffer_store_dwordx4 v[16:19], v226, s[32:35], s60 offen sc1
    buffer_store_dwordx2 v[20:21], v227, s[32:35], s60 offen offset:2048 sc1
    buffer_store_dwordx4 v[22:25], v226, s[32:35], s60 offen offset:3072 sc1
L_stend14:
    v_pk_add_f32 v[12:13], v[80:81], v[82:83]
    v_pk_mul_f32 v[14:15], v[80:81], v[80:81]
    v_pk_fma_f32 v[14:15], v[82:83], v[82:83], v[14:15]
    v_pk_add_f32 v[12:13], v[12:13], v[84:85]
    v_pk_fma_f32 v[14:15], v[84:85], v[84:85], v[14:15]
    v_pk_add_f32 v[12:13], v[12:13], v[86:87]
    v_pk_fma_f32 v[14:15], v[86:87], v[86:87], v[14:15]
    v_pk_add_f32 v[12:13], v[12:13], v[88:89]
    v_pk_fma_f32 v[14:15], v[88:89], v[88:89], v[14:15]
    v_pk_add_f32 v[12:13], v[12:13], v[90:91]
    v_pk_fma_f32 v[14:15], v[90:91], v[90:91], v[14:15]
    v_pk_add_f32 v[12:13], v[12:13], v[92:93]
    v_pk_fma_f32 v[14:15], v[92:93], v[92:93], v[14:15]
    v_pk_add_f32 v[12:13], v[12:13], v[94:95]
    v_pk_fma_f32 v[14:15], v[94:95], v[94:95], v[14:15]
    v_pk_add_f32 v[12:13], v[12:13], v[96:97]
    v_pk_fma_f32 v[14:15], v[96:97], v[96:97], v[14:15]
    v_pk_add_f32 v[12:13], v[12:13], v[98:99]
    v_pk_fma_f32 v[14:15], v[98:99], v[98:99], v[14:15]
    v_add_f32 v12, v12, v13
    v_add_f32 v13, v14, v15
    v_mov_b32 v14, v12
    v_mov_b32 v15, v13
    s_nop 0
    v_permlane16_swap_b32 v12, v14
    v_permlane16_swap_b32 v13, v15
    v_pk_add_f32 v[12:13], v[12:13], v[14:15]
    v_mov_b32 v14, v12
    v_mov_b32 v15, v13
    s_nop 0
    v_permlane32_swap_b32 v12, v14
    v_permlane32_swap_b32 v13, v15
    v_pk_add_f32 v[12:13], v[12:13], v[14:15]
    s_mov_b64 exec, 0xffff
    s_cmp_eq_u32 s42, 0
    s_cbranch_scc1 L_slow15
    buffer_store_dwordx2 v[12:13], v228, s[36:39], s58 offen
    s_branch L_stend16
L_slow15:
    buffer_store_dwordx2 v[12:13], v228, s[36:39], s58 offen sc1
L_stend16:
    s_mov_b64 exec, -1
    v_cvt_pk_bf16_f32 v230, v80, v81
    v_cvt_pk_bf16_f32 v231, v82, v83
    v_cvt_pk_bf16_f32 v232, v84, v85
    v_cvt_pk_bf16_f32 v233, v86, v87
    v_cvt_pk_bf16_f32 v234, v88, v89
    v_cvt_pk_bf16_f32 v235, v90, v91
    v_cvt_pk_bf16_f32 v236, v92, v93
    v_cvt_pk_bf16_f32 v237, v94, v95
    v_cvt_pk_bf16_f32 v238, v96, v97
    v_cvt_pk_bf16_f32 v239, v98, v99
    v_and_b32 v109, 1, v245
    v_bfe_u32 v110, v245, 1, 1
    v_lshl_add_u32 v108, v109, 1, v110
    v_bfe_u32 v109, v245, 2, 3
    v_lshrrev_b32 v110, 5, v245
    v_lshl_add_u32 v111, v110, 4, v109
    v_mul_u32_u24 v111, 96, v111
    v_lshl_add_u32 v111, v108, 3, v111
    v_add_u32 v116, 40960, v111
    v_and_b32 v115, 15, v245
    v_lshlrev_b32 v115, 2, v115
    v_and_b32 v108, 31, v245
    v_lshlrev_b32 v118, 2, v108
    v_lshlrev_b32 v108, 4, v108
    v_lshl_add_u32 v119, v110, 10, v108
    s_lshl_b32 s68, s4, 2
    s_add_u32 s68, s68, s46
    s_lshl_b32 s68, s68, 1
    s_add_u32 s68, s68, 1
    s_sub_u32 s68, s68, s45
    s_lshl_b32 s57, s68, 7
    s_add_u32 s57, s57, 45056
    s_lshl_b32 s58, s68, 11
    s_add_u32 s58, s58, 262144
    s_mul_i32 s59, s68, 40960
    s_add_u32 s59, s59, 0
    s_mul_i32 s60, s3, 5120
    s_mul_i32 s61, s3, 40960
    s_add_u32 s61, s61, 1638400
    s_lshl_b32 s62, s6, 8
    s_add_u32 s62, s62, 53248
    s_mul_i32 s63, s6, 196608
    s_add_u32 s63, s63, 5767168
    s_lshl_b32 s64, s3, 10
    s_add_u32 s64, s64, s63
    s_add_u32 s64, s64, 40960
    v_mov_b32 v247, s40
    s_mov_b64 exec, 1
    s_waitcnt vmcnt(0)
    s_cmp_eq_u32 s42, 0
    s_cbranch_scc1 L_slow17
    buffer_store_dword v247, off, s[36:39], s56
    s_branch L_stend18
L_slow17:
    buffer_store_dword v247, off, s[36:39], s56 sc1
L_stend18:
    s_mov_b64 exec, -1
    s_barrier
    s_add_u32 m0, s60, 0
    s_nop 0
    buffer_load_dwordx4 v240, s[28:31], s55 offen lds
    s_add_u32 m0, s60, 1024
    s_nop 0
    buffer_load_dwordx4 v241, s[28:31], s55 offen lds
    s_add_u32 m0, s60, 2048
    s_nop 0
    buffer_load_dwordx4 v242, s[28:31], s55 offen lds
    s_add_u32 m0, s60, 3072
    s_nop 0
    buffer_load_dwordx4 v243, s[28:31], s55 offen lds
    s_add_u32 m0, s60, 4096
    s_nop 0
    buffer_load_dwordx4 v244, s[28:31], s55 offen lds
    s_add_u32 s55, s55, 40960
    v_add_u32 v222, s60, v246
    v_add_u32 v223, s60, v220
    s_branch L_p4
L_loader:
    s_setprio 2
    s_cmp_eq_u32 s54, 1
    s_cbranch_scc1 L_l0
    s_mov_b32 s78, 0
L_poll19:
    buffer_load_dwordx2 v[234:235], v248, s[36:39], 0 offen sc1
    s_add_u32 s78, s78, 1
    s_cmp_gt_u32 s78, 0x8000
    s_cbranch_scc1 L_pdone20
    s_waitcnt vmcnt(0)
    v_cmp_ne_u32 vcc, s40, v234
    s_nop 4
    s_cbranch_vccnz L_poll19
L_pdone20:
    s_waitcnt vmcnt(0)
    s_add_u32 m0, s64, 0
    s_nop 0
    buffer_load_dwordx4 v246, s[36:39], s63 offen offset:0 sc1 lds
    buffer_load_dwordx4 v246, s[36:39], s63 offen offset:1024 sc1 lds
    buffer_load_dwordx4 v246, s[36:39], s63 offen offset:2048 sc1 lds
    buffer_load_dwordx4 v246, s[36:39], s63 offen offset:3072 sc1 lds
    s_add_u32 s63, s63, 4096
    s_add_u32 m0, s64, 4096
    s_nop 0
    buffer_load_dwordx4 v246, s[36:39], s63 offen offset:0 sc1 lds
    buffer_load_dword v236, v232, s[36:39], 0 offen sc1
    s_add_u32 s78, s65, 0
    s_mov_b64 exec, s[72:73]
    buffer_load_dword v254, v253, s[24:27], s78 offen
    s_mov_b64 exec, -1
L_l0:
    s_waitcnt vmcnt(2)
    s_barrier
    s_waitcnt vmcnt(1)
    v_cmp_ne_u32 vcc, s40, v236
    s_nop 4
    s_cbranch_vccz L_l1
    s_mov_b32 s78, 0
L_poll21:
    buffer_load_dword v236, v232, s[36:39], 0 offen sc1
    s_add_u32 s78, s78, 1
    s_cmp_gt_u32 s78, 0x8000
    s_cbranch_scc1 L_pdone22
    s_waitcnt vmcnt(0)
    v_cmp_ne_u32 vcc, s40, v236
    s_nop 4
    s_cbranch_vccnz L_poll21
L_pdone22:
    s_waitcnt vmcnt(0)
L_l1:
    s_add_u32 m0, s64, 20480
    s_nop 0
    buffer_load_dwordx4 v246, s[36:39], s60 offen offset:0 sc1 lds
    buffer_load_dwordx4 v246, s[36:39], s60 offen offset:1024 sc1 lds
    buffer_load_dwordx4 v246, s[36:39], s60 offen offset:2048 sc1 lds
    buffer_load_dwordx4 v246, s[36:39], s60 offen offset:3072 sc1 lds
    s_add_u32 s60, s60, 4096
    s_add_u32 m0, s64, 24576
    s_nop 0
    buffer_load_dwordx4 v246, s[36:39], s60 offen offset:0 sc1 lds
    s_mov_b64 exec, 0x1f
    buffer_load_dword v254, v253, s[36:39], s62 offen sc1
    s_mov_b64 exec, -1
L_l2:
    v_cmp_ne_u32 vcc, s41, v235
    s_nop 1
    s_cmp_eq_u64 vcc, 0
    s_cselect_b32 s42, 1, 0
    buffer_load_dword v237, v233, s[36:39], 0 offen sc1
    s_add_u32 m0, s56, 0
    s_nop 0
    buffer_load_dwordx4 v246, s[36:39], s61 offen offset:0 sc1 lds
    buffer_load_dwordx4 v246, s[36:39], s61 offen offset:1024 sc1 lds
    buffer_load_dwordx4 v246, s[36:39], s61 offen offset:2048 sc1 lds
    buffer_load_dwordx4 v246, s[36:39], s61 offen offset:3072 sc1 lds
    s_add_u32 s61, s61, 4096
    s_add_u32 m0, s56, 4096
    s_nop 0
    buffer_load_dwordx4 v246, s[36:39], s61 offen offset:0 sc1 lds
    buffer_load_dwordx4 v246, s[36:39], s61 offen offset:1024 sc1 lds
    s_waitcnt vmcnt(6)
    v_cmp_ne_u32 vcc, s40, v237
    s_mov_b64 exec, 7
    s_nop 3
    s_cbranch_vccnz L_l4
    buffer_load_dword v254, v253, s[36:39], s58 offen sc1
L_l4:
    s_mov_b64 exec, -1
    s_add_u32 m0, s56, 4096
    s_nop 0
    buffer_load_dwordx4 v246, s[36:39], s61 offen offset:2048 sc1 lds
    buffer_load_dwordx4 v246, s[36:39], s61 offen offset:3072 sc1 lds
    s_add_u32 s61, s61, 4096
    s_add_u32 m0, s56, 8192
    s_nop 0
    buffer_load_dwordx4 v246, s[36:39], s61 offen offset:0 sc1 lds
    buffer_load_dwordx4 v246, s[36:39], s61 offen offset:1024 sc1 lds
    buffer_load_dwordx4 v246, s[36:39], s61 offen offset:2048 sc1 lds
    buffer_load_dwordx4 v246, s[36:39], s61 offen offset:3072 sc1 lds
    s_add_u32 s61, s61, 4096
    s_add_u32 m0, s56, 12288
    s_nop 0
    buffer_load_dwordx4 v246, s[36:39], s61 offen offset:0 sc1 lds
    buffer_load_dwordx4 v246, s[36:39], s61 offen offset:1024 sc1 lds
    buffer_load_dwordx4 v246, s[36:39], s61 offen offset:2048 sc1 lds
    buffer_load_dwordx4 v246, s[36:39], s61 offen offset:3072 sc1 lds
    s_add_u32 s61, s61, 4096
    s_barrier
    s_add_u32 m0, s56, 16384
    s_nop 0
    buffer_load_dwordx4 v246, s[36:39], s61 offen offset:0 sc1 lds
    buffer_load_dwordx4 v246, s[36:39], s61 offen offset:1024 sc1 lds
    buffer_load_dwordx4 v246, s[36:39], s61 offen offset:2048 sc1 lds
    buffer_load_dwordx4 v246, s[36:39], s61 offen offset:3072 sc1 lds
    s_add_u32 s61, s61, 4096
    v_cmp_ne_u32 vcc, s40, v237
    s_nop 4
    s_cbranch_vccz L_l3
    s_mov_b32 s78, 0
L_poll23:
    buffer_load_dword v237, v233, s[36:39], 0 offen sc1
    s_add_u32 s78, s78, 1
    s_cmp_gt_u32 s78, 0x8000
    s_cbranch_scc1 L_pdone24
    s_waitcnt vmcnt(0)
    v_cmp_ne_u32 vcc, s40, v237
    s_nop 4
    s_cbranch_vccnz L_poll23
L_pdone24:
    s_waitcnt vmcnt(0)
L_l3:
    s_add_u32 m0, s57, 0
    s_nop 0
    buffer_load_dwordx4 v246, s[36:39], s59 offen offset:0 sc1 lds
    buffer_load_dwordx4 v246, s[36:39], s59 offen offset:1024 sc1 lds
    buffer_load_dwordx4 v246, s[36:39], s59 offen offset:2048 sc1 lds
    buffer_load_dwordx4 v246, s[36:39], s59 offen offset:3072 sc1 lds
    s_add_u32 s59, s59, 4096
    s_add_u32 m0, s57, 4096
    s_nop 0
    buffer_load_dwordx4 v246, s[36:39], s59 offen offset:0 sc1 lds
    buffer_load_dwordx4 v246, s[36:39], s59 offen offset:1024 sc1 lds
    buffer_load_dwordx4 v246, s[36:39], s59 offen offset:2048 sc1 lds
    buffer_load_dwordx4 v246, s[36:39], s59 offen offset:3072 sc1 lds
    s_add_u32 s59, s59, 4096
    s_add_u32 m0, s57, 8192
    s_nop 0
    buffer_load_dwordx4 v246, s[36:39], s59 offen offset:0 sc1 lds
    buffer_load_dwordx4 v246, s[36:39], s59 offen offset:1024 sc1 lds
    s_mov_b32 s78, 0
    buffer_load_dwordx4 v[0:3], v250, s[24:27], s78 offen
    buffer_load_dwordx4 v[4:7], v251, s[24:27], s78 offen
    buffer_load_dwordx4 v[8:11], v252, s[24:27], s78 offen
    s_mov_b32 s78, 196608
    buffer_load_dwordx4 v[12:15], v250, s[24:27], s78 offen
    buffer_load_dwordx4 v[16:19], v251, s[24:27], s78 offen
    buffer_load_dwordx4 v[20:23], v252, s[24:27], s78 offen
    s_add_u32 s78, s74, 0
    s_mov_b64 exec, 0x3ff
    buffer_load_dword v254, v253, s[28:31], s78 offen
    s_mov_b64 exec, -1
    s_add_u32 s78, s65, 393216
    s_mov_b64 exec, s[72:73]
    buffer_load_dword v254, v253, s[24:27], s78 offen
    s_mov_b64 exec, -1
    s_add_u32 s78, s74, 40960
    s_mov_b64 exec, 0x3ff
    buffer_load_dword v254, v253, s[28:31], s78 offen
    s_mov_b64 exec, -1
    s_waitcnt vmcnt(9)
    s_barrier
    s_add_u32 m0, s64, 0
    s_nop 0
    buffer_load_dwordx4 v240, s[28:31], s55 offen lds
    s_add_u32 m0, s64, 1024
    s_nop 0
    buffer_load_dwordx4 v241, s[28:31], s55 offen lds
    s_add_u32 m0, s64, 2048
    s_nop 0
    buffer_load_dwordx4 v242, s[28:31], s55 offen lds
    s_add_u32 m0, s64, 3072
    s_nop 0
    buffer_load_dwordx4 v243, s[28:31], s55 offen lds
    s_add_u32 m0, s64, 4096
    s_nop 0
    buffer_load_dwordx4 v244, s[28:31], s55 offen lds
    s_add_u32 s55, s55, 40960
    s_add_u32 s78, s65, 786432
    s_mov_b64 exec, s[72:73]
    buffer_load_dword v254, v253, s[24:27], s78 offen
    s_mov_b64 exec, -1
    s_add_u32 s78, s74, 81920
    s_mov_b64 exec, 0x3ff
    buffer_load_dword v254, v253, s[28:31], s78 offen
    s_mov_b64 exec, -1
    s_mov_b32 s78, 393216
    buffer_load_dwordx4 v[24:27], v250, s[24:27], s78 offen
    buffer_load_dwordx4 v[28:31], v251, s[24:27], s78 offen
    buffer_load_dwordx4 v[32:35], v252, s[24:27], s78 offen
    s_mov_b32 s78, 589824
    buffer_load_dwordx4 v[36:39], v250, s[24:27], s78 offen
    buffer_load_dwordx4 v[40:43], v251, s[24:27], s78 offen
    buffer_load_dwordx4 v[44:47], v252, s[24:27], s78 offen
    s_waitcnt vmcnt(8)
    ds_read_b64_tr_b16 v[120:121], v249 offset:0
    ds_read_b64_tr_b16 v[122:123], v249 offset:2560
    ds_read_b64_tr_b16 v[124:125], v249 offset:32
    ds_read_b64_tr_b16 v[126:127], v249 offset:2592
    ds_read_b64_tr_b16 v[128:129], v249 offset:64
    ds_read_b64_tr_b16 v[130:131], v249 offset:2624
    ds_read_b64_tr_b16 v[132:133], v249 offset:96
    ds_read_b64_tr_b16 v[134:135], v249 offset:2656
    ds_read_b64_tr_b16 v[136:137], v249 offset:128
    ds_read_b64_tr_b16 v[138:139], v249 offset:2688
    s_waitcnt lgkmcnt(0)
    s_add_u32 m0, s64, 0
    s_nop 0
    buffer_load_dwordx4 v240, s[28:31], s55 offen lds
    s_add_u32 m0, s64, 1024
    s_nop 0
    buffer_load_dwordx4 v241, s[28:31], s55 offen lds
    s_add_u32 m0, s64, 2048
    s_nop 0
    buffer_load_dwordx4 v242, s[28:31], s55 offen lds
    s_add_u32 m0, s64, 3072
    s_nop 0
    buffer_load_dwordx4 v243, s[28:31], s55 offen lds
    s_add_u32 m0, s64, 4096
    s_nop 0
    buffer_load_dwordx4 v244, s[28:31], s55 offen lds
    s_add_u32 s55, s55, 40960
    s_add_u32 s78, s65, 1179648
    s_mov_b64 exec, s[72:73]
    buffer_load_dword v254, v253, s[24:27], s78 offen
    s_mov_b64 exec, -1
    s_add_u32 s78, s74, 122880
    s_mov_b64 exec, 0x3ff
    buffer_load_dword v254, v253, s[28:31], s78 offen
    s_mov_b64 exec, -1
    s_mov_b64 exec, 15
    global_load_dword v254, v255, s[80:81]
    s_mov_b64 exec, -1
    s_mov_b32 s78, 786432
    buffer_load_dwordx4 v[48:51], v250, s[24:27], s78 offen
    buffer_load_dwordx4 v[52:55], v251, s[24:27], s78 offen
    buffer_load_dwordx4 v[56:59], v252, s[24:27], s78 offen
    s_mov_b32 s78, 983040
    buffer_load_dwordx4 v[60:63], v250, s[24:27], s78 offen
    buffer_load_dwordx4 v[64:67], v251, s[24:27], s78 offen
    buffer_load_dwordx4 v[68:71], v252, s[24:27], s78 offen
    s_waitcnt vmcnt(9)
    ds_read_b64_tr_b16 v[140:141], v249 offset:0
    ds_read_b64_tr_b16 v[142:143], v249 offset:2560
    ds_read_b64_tr_b16 v[144:145], v249 offset:32
    ds_read_b64_tr_b16 v[146:147], v249 offset:2592
    ds_read_b64_tr_b16 v[148:149], v249 offset:64
    ds_read_b64_tr_b16 v[150:151], v249 offset:2624
    ds_read_b64_tr_b16 v[152:153], v249 offset:96
    ds_read_b64_tr_b16 v[154:155], v249 offset:2656
    ds_read_b64_tr_b16 v[156:157], v249 offset:128
    ds_read_b64_tr_b16 v[158:159], v249 offset:2688
    s_waitcnt lgkmcnt(0)
    s_add_u32 m0, s64, 0
    s_nop 0
    buffer_load_dwordx4 v240, s[28:31], s55 offen lds
    s_add_u32 m0, s64, 1024
    s_nop 0
    buffer_load_dwordx4 v241, s[28:31], s55 offen lds
    s_add_u32 m0, s64, 2048
    s_nop 0
    buffer_load_dwordx4 v242, s[28:31], s55 offen lds
    s_add_u32 m0, s64, 3072
    s_nop 0
    buffer_load_dwordx4 v243, s[28:31], s55 offen lds
    s_add_u32 m0, s64, 4096
    s_nop 0
    buffer_load_dwordx4 v244, s[28:31], s55 offen lds
    s_add_u32 s55, s55, 40960
    s_add_u32 s78, s65, 1572864
    s_mov_b64 exec, s[72:73]
    buffer_load_dword v254, v253, s[24:27], s78 offen
    s_mov_b64 exec, -1
    s_add_u32 s78, s74, 163840
    s_mov_b64 exec, 0x3ff
    buffer_load_dword v254, v253, s[28:31], s78 offen
    s_mov_b64 exec, -1
    s_mov_b32 s78, 1179648
    buffer_load_dwordx4 v[72:75], v250, s[24:27], s78 offen
    buffer_load_dwordx4 v[76:79], v251, s[24:27], s78 offen
    buffer_load_dwordx4 v[80:83], v252, s[24:27], s78 offen
    s_mov_b32 s78, 1376256
    buffer_load_dwordx4 v[84:87], v250, s[24:27], s78 offen
    buffer_load_dwordx4 v[88:91], v251, s[24:27], s78 offen
    buffer_load_dwordx4 v[92:95], v252, s[24:27], s78 offen
    s_waitcnt vmcnt(8)
    ds_read_b64_tr_b16 v[160:161], v249 offset:0
    ds_read_b64_tr_b16 v[162:163], v249 offset:2560
    ds_read_b64_tr_b16 v[164:165], v249 offset:32
    ds_read_b64_tr_b16 v[166:167], v249 offset:2592
    ds_read_b64_tr_b16 v[168:169], v249 offset:64
    ds_read_b64_tr_b16 v[170:171], v249 offset:2624
    ds_read_b64_tr_b16 v[172:173], v249 offset:96
    ds_read_b64_tr_b16 v[174:175], v249 offset:2656
    ds_read_b64_tr_b16 v[176:177], v249 offset:128
    ds_read_b64_tr_b16 v[178:179], v249 offset:2688
    s_waitcnt lgkmcnt(0)
    s_add_u32 m0, s64, 0
    s_nop 0
    buffer_load_dwordx4 v240, s[28:31], s55 offen lds
    s_add_u32 m0, s64, 1024
    s_nop 0
    buffer_load_dwordx4 v241, s[28:31], s55 offen lds
    s_add_u32 m0, s64, 2048
    s_nop 0
    buffer_load_dwordx4 v242, s[28:31], s55 offen lds
    s_add_u32 m0, s64, 3072
    s_nop 0
    buffer_load_dwordx4 v243, s[28:31], s55 offen lds
    s_add_u32 m0, s64, 4096
    s_nop 0
    buffer_load_dwordx4 v244, s[28:31], s55 offen lds
    s_add_u32 s55, s55, 40960
    s_add_u32 s78, s67, 0
    s_mov_b32 exec_hi, 262143
    buffer_load_dword v254, v253, s[20:23], s78 offen
    s_mov_b32 exec_hi, -1
    s_add_u32 s78, s74, 204800
    s_mov_b64 exec, 0x3ff
    buffer_load_dword v254, v253, s[28:31], s78 offen
    s_mov_b64 exec, -1
    s_mov_b64 exec, 15
    global_load_dword v254, v255, s[80:81]
    s_mov_b64 exec, -1
    s_mov_b32 s78, 1572864
    buffer_load_dwordx4 v[96:99], v250, s[24:27], s78 offen
    buffer_load_dwordx4 v[100:103], v251, s[24:27], s78 offen
    buffer_load_dwordx4 v[104:107], v252, s[24:27], s78 offen
    s_mov_b32 s78, 1769472
    buffer_load_dwordx4 v[108:111], v250, s[24:27], s78 offen
    buffer_load_dwordx4 v[112:115], v251, s[24:27], s78 offen
    buffer_load_dwordx4 v[116:119], v252, s[24:27], s78 offen
    s_waitcnt vmcnt(9)
    ds_read_b64_tr_b16 v[180:181], v249 offset:0
    ds_read_b64_tr_b16 v[182:183], v249 offset:2560
    ds_read_b64_tr_b16 v[184:185], v249 offset:32
    ds_read_b64_tr_b16 v[186:187], v249 offset:2592
    ds_read_b64_tr_b16 v[188:189], v249 offset:64
    ds_read_b64_tr_b16 v[190:191], v249 offset:2624
    ds_read_b64_tr_b16 v[192:193], v249 offset:96
    ds_read_b64_tr_b16 v[194:195], v249 offset:2656
    ds_read_b64_tr_b16 v[196:197], v249 offset:128
    ds_read_b64_tr_b16 v[198:199], v249 offset:2688
    s_waitcnt lgkmcnt(0)
    s_add_u32 m0, s64, 0
    s_nop 0
    buffer_load_dwordx4 v240, s[28:31], s55 offen lds
    s_add_u32 m0, s64, 1024
    s_nop 0
    buffer_load_dwordx4 v241, s[28:31], s55 offen lds
    s_add_u32 m0, s64, 2048
    s_nop 0
    buffer_load_dwordx4 v242, s[28:31], s55 offen lds
    s_add_u32 m0, s64, 3072
    s_nop 0
    buffer_load_dwordx4 v243, s[28:31], s55 offen lds
    s_add_u32 m0, s64, 4096
    s_nop 0
    buffer_load_dwordx4 v244, s[28:31], s55 offen lds
    s_add_u32 s55, s55, 40960
    s_waitcnt vmcnt(0)
    ds_read_b64_tr_b16 v[200:201], v249 offset:0
    ds_read_b64_tr_b16 v[202:203], v249 offset:2560
    ds_read_b64_tr_b16 v[204:205], v249 offset:32
    ds_read_b64_tr_b16 v[206:207], v249 offset:2592
    ds_read_b64_tr_b16 v[208:209], v249 offset:64
    ds_read_b64_tr_b16 v[210:211], v249 offset:2624
    ds_read_b64_tr_b16 v[212:213], v249 offset:96
    ds_read_b64_tr_b16 v[214:215], v249 offset:2656
    ds_read_b64_tr_b16 v[216:217], v249 offset:128
    ds_read_b64_tr_b16 v[218:219], v249 offset:2688
    s_waitcnt lgkmcnt(0)
    s_cmp_eq_u32 s42, 0
    s_cbranch_scc1 L_npt
    s_lshl_b32 s78, s4, 5
    s_add_u32 s78, s78, s5
    s_lshl_b32 s78, s78, 2
    s_add_u32 s78, s78, s46
    s_lshr_b32 s79, s78, 3
    s_mul_i32 s79, s79, 49152
    s_add_u32 s79, s79, 5767168
    s_and_b32 s76, s78, 7
    s_mul_i32 s77, s76, 3584
    s_mul_i32 s76, s76, 2560
    s_add_u32 s76, s76, s79
    s_add_u32 s79, s79, s77
    s_add_u32 s79, s79, 20480
    v_add_u32 v248, s79, v253
    s_lshl_b32 s79, s78, 7
    s_add_u32 s79, s79, 262144
    v_writelane_b32 v248, s79, 28
    s_mul_i32 s78, s78, 2560
    s_add_u32 s77, s78, 0
    s_add_u32 s78, s78, 524288
    s_mov_b64 exec, 0xfffff
    buffer_load_dword v254, v253, s[36:39], s76 offen sc1
    s_mov_b64 exec, 0xfffff
    buffer_load_dword v247, v253, s[32:35], s77 offen sc1
    s_mov_b64 exec, -1
L_npt:
    s_mul_i32 s57, s46, 40960
    s_barrier
    s_add_u32 s78, s57, 655360
    s_add_u32 m0, s64, 81920
    s_nop 0
    buffer_load_dwordx4 v240, s[20:23], s78 offen lds
    s_add_u32 m0, s64, 82944
    s_nop 0
    buffer_load_dwordx4 v241, s[20:23], s78 offen lds
    s_add_u32 m0, s64, 83968
    s_nop 0
    buffer_load_dwordx4 v242, s[20:23], s78 offen lds
    s_add_u32 m0, s64, 84992
    s_nop 0
    buffer_load_dwordx4 v243, s[20:23], s78 offen lds
    s_add_u32 m0, s64, 86016
    s_nop 0
    buffer_load_dwordx4 v244, s[20:23], s78 offen lds
    s_add_u32 s78, s57, 491520
    s_add_u32 m0, s64, 61440
    s_nop 0
    buffer_load_dwordx4 v240, s[20:23], s78 offen lds
    s_add_u32 m0, s64, 62464
    s_nop 0
    buffer_load_dwordx4 v241, s[20:23], s78 offen lds
    s_add_u32 m0, s64, 63488
    s_nop 0
    buffer_load_dwordx4 v242, s[20:23], s78 offen lds
    s_add_u32 m0, s64, 64512
    s_nop 0
    buffer_load_dwordx4 v243, s[20:23], s78 offen lds
    s_add_u32 m0, s64, 65536
    s_nop 0
    buffer_load_dwordx4 v244, s[20:23], s78 offen lds
    s_add_u32 m0, s64, 0
    s_nop 0
    buffer_load_dwordx4 v240, s[28:31], s55 offen lds
    s_add_u32 m0, s64, 1024
    s_nop 0
    buffer_load_dwordx4 v241, s[28:31], s55 offen lds
    s_add_u32 m0, s64, 2048
    s_nop 0
    buffer_load_dwordx4 v242, s[28:31], s55 offen lds
    s_add_u32 m0, s64, 3072
    s_nop 0
    buffer_load_dwordx4 v243, s[28:31], s55 offen lds
    s_add_u32 m0, s64, 4096
    s_nop 0
    buffer_load_dwordx4 v244, s[28:31], s55 offen lds
    s_add_u32 s55, s55, 40960
    s_add_u32 s78, s57, 327680
    s_add_u32 m0, s64, 40960
    s_nop 0
    buffer_load_dwordx4 v240, s[20:23], s78 offen lds
    s_add_u32 m0, s64, 41984
    s_nop 0
    buffer_load_dwordx4 v241, s[20:23], s78 offen lds
    s_add_u32 m0, s64, 43008
    s_nop 0
    buffer_load_dwordx4 v242, s[20:23], s78 offen lds
    s_add_u32 m0, s64, 44032
    s_nop 0
    buffer_load_dwordx4 v243, s[20:23], s78 offen lds
    s_add_u32 m0, s64, 45056
    s_nop 0
    buffer_load_dwordx4 v244, s[20:23], s78 offen lds
    s_waitcnt vmcnt(5)
    ds_read_b64_tr_b16 v[220:221], v249 offset:0
    ds_read_b64_tr_b16 v[222:223], v249 offset:2560
    ds_read_b64_tr_b16 v[224:225], v249 offset:32
    ds_read_b64_tr_b16 v[226:227], v249 offset:2592
    ds_read_b64_tr_b16 v[228:229], v249 offset:64
    ds_read_b64_tr_b16 v[230:231], v249 offset:2624
    ds_read_b64_tr_b16 v[232:233], v249 offset:96
    ds_read_b64_tr_b16 v[234:235], v249 offset:2656
    ds_read_b64_tr_b16 v[236:237], v249 offset:128
    ds_read_b64_tr_b16 v[238:239], v249 offset:2688
    s_waitcnt lgkmcnt(0)
    s_add_u32 s78, s57, 163840
    s_add_u32 m0, s64, 20480
    s_nop 0
    buffer_load_dwordx4 v240, s[20:23], s78 offen lds
    s_add_u32 m0, s64, 21504
    s_nop 0
    buffer_load_dwordx4 v241, s[20:23], s78 offen lds
    s_add_u32 m0, s64, 22528
    s_nop 0
    buffer_load_dwordx4 v242, s[20:23], s78 offen lds
    s_add_u32 m0, s64, 23552
    s_nop 0
    buffer_load_dwordx4 v243, s[20:23], s78 offen lds
    s_add_u32 m0, s64, 24576
    s_nop 0
    buffer_load_dwordx4 v244, s[20:23], s78 offen lds
    s_add_u32 s78, s57, 0
    s_add_u32 m0, s64, 0
    s_nop 0
    buffer_load_dwordx4 v240, s[20:23], s78 offen lds
    s_add_u32 m0, s64, 1024
    s_nop 0
    buffer_load_dwordx4 v241, s[20:23], s78 offen lds
    s_add_u32 m0, s64, 2048
    s_nop 0
    buffer_load_dwordx4 v242, s[20:23], s78 offen lds
    s_add_u32 m0, s64, 3072
    s_nop 0
    buffer_load_dwordx4 v243, s[20:23], s78 offen lds
    s_add_u32 m0, s64, 4096
    s_nop 0
    buffer_load_dwordx4 v244, s[20:23], s78 offen lds
    s_mov_b64 exec, 15
    global_load_dword v247, v255, s[80:81]
    s_mov_b64 exec, -1
    s_add_u32 s78, s66, 983040
    s_mov_b32 exec_hi, 268435455
    buffer_load_dword v247, v253, s[28:31], s78 offen
    s_mov_b32 exec_hi, -1
    s_cmp_eq_u32 s42, 0
    s_cbranch_scc1 L_npu
    s_mov_b64 exec, 0x1fffffff
    buffer_load_dword v247, v248, s[36:39], 0 offen sc1
    s_mov_b64 exec, -1
    s_waitcnt vmcnt(3)
    s_branch L_npv
L_npu:
    s_waitcnt vmcnt(2)
L_npv:
    s_setprio 0
    s_barrier
    s_mul_i32 s78, s44, 6144
    s_lshr_b32 s79, s46, 1
    s_mul_i32 s79, s79, 384
    s_add_u32 s78, s78, s79
    s_add_u32 s78, s78, 102400
    v_and_b32 v248, 31, v245
    v_add_u32 v248, 0, v248
    v_mul_u32_u24 v252, 10923, v248
    v_lshrrev_b32 v252, 18, v252
    v_mul_u32_u24 v252, 384, v252
    v_lshl_add_u32 v252, v248, 4, v252
    v_lshrrev_b32 v248, 5, v245
    v_mul_u32_u24 v248, 3072, v248
    v_add3_u32 v249, v248, v252, s78
    v_and_b32 v248, 31, v245
    v_add_u32 v248, 32, v248
    v_mul_u32_u24 v252, 10923, v248
    v_lshrrev_b32 v252, 18, v252
    v_mul_u32_u24 v252, 384, v252
    v_lshl_add_u32 v252, v248, 4, v252
    v_lshrrev_b32 v248, 5, v245
    v_mul_u32_u24 v248, 3072, v248
    v_add3_u32 v250, v248, v252, s78
    v_and_b32 v248, 31, v245
    v_add_u32 v248, 64, v248
    v_mul_u32_u24 v252, 10923, v248
    v_lshrrev_b32 v252, 18, v252
    v_mul_u32_u24 v252, 384, v252
    v_lshl_add_u32 v252, v248, 4, v252
    v_lshrrev_b32 v248, 5, v245
    v_mul_u32_u24 v248, 3072, v248
    v_add3_u32 v251, v248, v252, s78
    ds_write_b128 v249, v[108:111] offset:49152
    ds_write_b128 v250, v[112:115] offset:49152
    ds_write_b128 v251, v[116:119] offset:49152
    ds_write_b128 v249, v[96:99] offset:36864
    ds_write_b128 v250, v[100:103] offset:36864
    ds_write_b128 v251, v[104:107] offset:36864
    ds_write_b128 v249, v[84:87] offset:24576
    ds_write_b128 v250, v[88:91] offset:24576
    ds_write_b128 v251, v[92:95] offset:24576
    ds_write_b128 v249, v[72:75] offset:12288
    ds_write_b128 v250, v[76:79] offset:12288
    ds_write_b128 v251, v[80:83] offset:12288
    v_bfe_u32 v248, v245, 3, 1
    v_bfe_u32 v255, v245, 4, 1
    v_cmp_eq_u32 vcc, v248, v255
    v_and_b32 v248, 1, v245
    v_lshlrev_b32 v248, 4, v248
    v_mov_b32 v252, 0x3f80
    v_lshlrev_b32 v248, v248, v252
    v_bfe_u32 v255, v245, 1, 2
    v_cndmask_b32 v248, 0, v248, vcc
    v_cmp_eq_u32 vcc, 0, v255
    s_nop 1
    v_cndmask_b32 v252, 0, v248, vcc
    v_cmp_eq_u32 vcc, 1, v255
    s_nop 1
    v_cndmask_b32 v253, 0, v248, vcc
    v_cmp_eq_u32 vcc, 2, v255
    s_nop 1
    v_cndmask_b32 v254, 0, v248, vcc
    v_cmp_eq_u32 vcc, 3, v255
    s_nop 1
    v_cndmask_b32 v255, 0, v248, vcc
    s_waitcnt lgkmcnt(0)
    s_nop 0
    v_mfma_f32_16x16x32_bf16 v[108:111], v[252:255], v[108:111], 0
    v_mfma_f32_16x16x32_bf16 v[112:115], v[252:255], v[112:115], 0
    v_mfma_f32_16x16x32_bf16 v[116:119], v[252:255], v[116:119], 0
    v_mfma_f32_16x16x32_bf16 v[108:111], v[252:255], v[96:99], v[108:111]
    v_mfma_f32_16x16x32_bf16 v[112:115], v[252:255], v[100:103], v[112:115]
    v_mfma_f32_16x16x32_bf16 v[116:119], v[252:255], v[104:107], v[116:119]
    v_mfma_f32_16x16x32_bf16 v[108:111], v[252:255], v[84:87], v[108:111]
    v_mfma_f32_16x16x32_bf16 v[112:115], v[252:255], v[88:91], v[112:115]
    v_mfma_f32_16x16x32_bf16 v[116:119], v[252:255], v[92:95], v[116:119]
    v_mfma_f32_16x16x32_bf16 v[108:111], v[252:255], v[72:75], v[108:111]
    v_mfma_f32_16x16x32_bf16 v[112:115], v[252:255], v[76:79], v[112:115]
    v_mfma_f32_16x16x32_bf16 v[116:119], v[252:255], v[80:83], v[116:119]
    v_mfma_f32_16x16x32_bf16 v[108:111], v[252:255], v[60:63], v[108:111]
    v_mfma_f32_16x16x32_bf16 v[112:115], v[252:255], v[64:67], v[112:115]
    v_mfma_f32_16x16x32_bf16 v[116:119], v[252:255], v[68:71], v[116:119]
    v_mfma_f32_16x16x32_bf16 v[108:111], v[252:255], v[48:51], v[108:111]
    v_mfma_f32_16x16x32_bf16 v[112:115], v[252:255], v[52:55], v[112:115]
    v_mfma_f32_16x16x32_bf16 v[116:119], v[252:255], v[56:59], v[116:119]
    v_mfma_f32_16x16x32_bf16 v[108:111], v[252:255], v[36:39], v[108:111]
    v_mfma_f32_16x16x32_bf16 v[112:115], v[252:255], v[40:43], v[112:115]
    v_mfma_f32_16x16x32_bf16 v[116:119], v[252:255], v[44:47], v[116:119]
    v_mfma_f32_16x16x32_bf16 v[108:111], v[252:255], v[24:27], v[108:111]
    v_mfma_f32_16x16x32_bf16 v[112:115], v[252:255], v[28:31], v[112:115]
    v_mfma_f32_16x16x32_bf16 v[116:119], v[252:255], v[32:35], v[116:119]
    v_mfma_f32_16x16x32_bf16 v[108:111], v[252:255], v[12:15], v[108:111]
    v_mfma_f32_16x16x32_bf16 v[112:115], v[252:255], v[16:19], v[112:115]
    v_mfma_f32_16x16x32_bf16 v[116:119], v[252:255], v[20:23], v[116:119]
    v_mfma_f32_16x16x32_bf16 v[108:111], v[252:255], v[0:3], v[108:111]
    v_mfma_f32_16x16x32_bf16 v[112:115], v[252:255], v[4:7], v[112:115]
    v_mfma_f32_16x16x32_bf16 v[116:119], v[252:255], v[8:11], v[116:119]
    s_mul_i32 s78, s46, 3072
    s_add_u32 s78, s78, 102400
    v_lshlrev_b32 v100, 2, v245
    v_add_u32 v101, s78, v100
    v_and_b32 v248, 15, v245
    v_lshrrev_b32 v102, 5, v245
    v_lshl_add_u32 v248, v102, 4, v248
    v_and_b32 v102, 16, v245
    v_lshl_add_u32 v248, v248, 5, v102
    v_add_u32 v248, s78, v248
    s_lshl_b32 s79, s2, 2
    s_add_u32 s79, s79, s46
    s_lshl_b32 s79, s79, 8
    s_add_u32 s79, s79, 12058624
    ds_write_b128 v248, v[108:111] offset:0
    ds_write_b128 v248, v[112:115] offset:1024
    ds_write_b128 v248, v[116:119] offset:2048
    ds_read_b32 v84, v101 offset:0
    ds_read_b32 v85, v101 offset:192
    ds_read_b32 v86, v101 offset:384
    ds_read_b32 v87, v101 offset:576
    ds_read_b32 v88, v101 offset:768
    ds_read_b32 v89, v101 offset:960
    ds_read_b32 v90, v101 offset:1152
    ds_read_b32 v91, v101 offset:1344
    ds_read_b32 v92, v101 offset:1536
    ds_read_b32 v93, v101 offset:1728
    ds_read_b32 v94, v101 offset:1920
    ds_read_b32 v95, v101 offset:2112
    ds_read_b32 v96, v101 offset:2304
    ds_read_b32 v97, v101 offset:2496
    ds_read_b32 v98, v101 offset:2688
    ds_read_b32 v99, v101 offset:2880
    v_subrev_u32 v249, 61440, v249
    v_subrev_u32 v250, 61440, v250
    v_subrev_u32 v251, 61440, v251
    s_waitcnt lgkmcnt(0)
    v_add_f32 v84, v84, v92
    v_add_f32 v85, v85, v93
    v_add_f32 v86, v86, v94
    v_add_f32 v87, v87, v95
    v_add_f32 v88, v88, v96
    v_add_f32 v89, v89, v97
    v_add_f32 v90, v90, v98
    v_add_f32 v91, v91, v99
    v_add_f32 v84, v84, v88
    v_add_f32 v85, v85, v89
    v_add_f32 v86, v86, v90
    v_add_f32 v87, v87, v91
    v_add_f32 v84, v84, v86
    v_add_f32 v85, v85, v87
    v_add_f32 v84, v84, v85
    buffer_store_dword v84, v100, s[36:39], s79 offen
    s_waitcnt vmcnt(0)
    buffer_load_dword v254, v100, s[36:39], s79 offen sc1
    v_and_b32 v109, 1, v245
    v_bfe_u32 v110, v245, 1, 1
    v_lshl_add_u32 v108, v109, 1, v110
    v_bfe_u32 v109, v245, 2, 3
    v_lshrrev_b32 v110, 5, v245
    v_lshl_add_u32 v111, v110, 4, v109
    v_mul_u32_u24 v111, 96, v111
    v_lshl_add_u32 v111, v108, 3, v111
    v_add_u32 v116, 40960, v111
    v_and_b32 v115, 15, v245
    v_lshlrev_b32 v115, 2, v115
    v_and_b32 v108, 31, v245
    v_lshlrev_b32 v118, 2, v108
    v_lshlrev_b32 v108, 4, v108
    v_lshl_add_u32 v119, v110, 10, v108
    s_lshl_b32 s68, s4, 2
    s_add_u32 s68, s68, s46
    s_lshl_b32 s68, s68, 1
    s_add_u32 s68, s68, 1
    s_sub_u32 s68, s68, s45
    s_lshl_b32 s57, s68, 7
    s_add_u32 s57, s57, 45056
    s_lshl_b32 s58, s68, 11
    s_add_u32 s58, s58, 262144
    s_mul_i32 s59, s68, 40960
    s_add_u32 s59, s59, 0
    s_mul_i32 s60, s3, 5120
    s_mul_i32 s61, s3, 40960
    s_add_u32 s61, s61, 1638400
    s_lshl_b32 s62, s6, 8
    s_add_u32 s62, s62, 53248
    s_mul_i32 s63, s6, 196608
    s_add_u32 s63, s63, 5767168
    s_lshl_b32 s64, s3, 10
    s_add_u32 s64, s64, s63
    s_add_u32 s64, s64, 40960
    s_barrier
    ds_write_b128 v249, v[0:3] offset:0
    ds_write_b128 v250, v[4:7] offset:0
    ds_write_b128 v251, v[8:11] offset:0
    ds_write_b128 v249, v[12:15] offset:12288
    ds_write_b128 v250, v[16:19] offset:12288
    ds_write_b128 v251, v[20:23] offset:12288
    ds_write_b128 v249, v[24:27] offset:24576
    ds_write_b128 v250, v[28:31] offset:24576
    ds_write_b128 v251, v[32:35] offset:24576
    ds_write_b128 v249, v[36:39] offset:36864
    ds_write_b128 v250, v[40:43] offset:36864
    ds_write_b128 v251, v[44:47] offset:36864
    ds_write_b128 v249, v[48:51] offset:49152
    ds_write_b128 v250, v[52:55] offset:49152
    ds_write_b128 v251, v[56:59] offset:49152
    ds_write_b128 v249, v[60:63] offset:61440
    ds_write_b128 v250, v[64:67] offset:61440
    ds_write_b128 v251, v[68:71] offset:61440
    s_waitcnt lgkmcnt(0)
    s_setprio 2
    s_barrier
L_p4:
    v_add_u32 v117, 0, v116
    ds_read_b64_tr_b16 v[48:49], v117 offset:0
    ds_read_b64_tr_b16 v[50:51], v117 offset:768
    ds_read_b64_tr_b16 v[52:53], v117 offset:32
    ds_read_b64_tr_b16 v[54:55], v117 offset:800
    ds_read_b64_tr_b16 v[56:57], v117 offset:64
    ds_read_b64_tr_b16 v[58:59], v117 offset:832
    ds_read_b64_tr_b16 v[60:61], v117 offset:3072
    ds_read_b64_tr_b16 v[62:63], v117 offset:3840
    ds_read_b64_tr_b16 v[64:65], v117 offset:3104
    ds_read_b64_tr_b16 v[66:67], v117 offset:3872
    ds_read_b64_tr_b16 v[68:69], v117 offset:3136
    ds_read_b64_tr_b16 v[70:71], v117 offset:3904
    s_mov_b32 s78, 0
L_poll25:
    buffer_load_dword v114, v115, s[36:39], s57 offen sc1
    s_add_u32 s78, s78, 1
    s_cmp_gt_u32 s78, 0x8000
    s_cbranch_scc1 L_pdone26
    s_waitcnt vmcnt(0)
    v_cmp_ne_u32 vcc, s40, v114
    s_nop 4
    s_cbranch_vccnz L_poll25
L_pdone26:
    s_waitcnt vmcnt(0)
    buffer_load_dwordx4 v[84:87], v246, s[32:35], s59 offen offset:0 sc1
    buffer_load_dwordx4 v[88:91], v246, s[32:35], s59 offen offset:1024 sc1
    buffer_load_dwordx4 v[92:95], v246, s[32:35], s59 offen offset:2048 sc1
    s_waitcnt vmcnt(2)
    ds_read_b64_tr_b16 v[72:73], v117 offset:6144
    ds_read_b64_tr_b16 v[74:75], v117 offset:6912
    s_waitcnt lgkmcnt(12)
    v_mfma_f32_32x32x16_bf16 v[0:15], v[48:51], v[84:87], 0
    buffer_load_dwordx4 v[96:99], v246, s[32:35], s59 offen offset:3072 sc1
    s_add_u32 s59, s59, 4096
    ds_read_b64_tr_b16 v[76:77], v117 offset:6176
    ds_read_b64_tr_b16 v[78:79], v117 offset:6944
    s_waitcnt lgkmcnt(12)
    v_mfma_f32_32x32x16_bf16 v[16:31], v[52:55], v[84:87], 0
    buffer_load_dwordx4 v[100:103], v246, s[32:35], s59 offen offset:0 sc1
    ds_read_b64_tr_b16 v[80:81], v117 offset:6208
    ds_read_b64_tr_b16 v[82:83], v117 offset:6976
    s_waitcnt lgkmcnt(12)
    v_mfma_f32_32x32x16_bf16 v[32:47], v[56:59], v[84:87], 0
    s_waitcnt vmcnt(3)
    ds_read_b64_tr_b16 v[48:49], v117 offset:9216
    ds_read_b64_tr_b16 v[50:51], v117 offset:9984
    s_waitcnt lgkmcnt(12)
    v_mfma_f32_32x32x16_bf16 v[0:15], v[60:63], v[88:91], v[0:15]
    buffer_load_dwordx4 v[104:107], v246, s[32:35], s59 offen offset:1024 sc1
    ds_read_b64_tr_b16 v[52:53], v117 offset:9248
    ds_read_b64_tr_b16 v[54:55], v117 offset:10016
    s_waitcnt lgkmcnt(12)
    v_mfma_f32_32x32x16_bf16 v[16:31], v[64:67], v[88:91], v[16:31]
    buffer_load_dwordx4 v[108:111], v246, s[32:35], s59 offen offset:2048 sc1
    ds_read_b64_tr_b16 v[56:57], v117 offset:9280
    ds_read_b64_tr_b16 v[58:59], v117 offset:10048
    s_waitcnt lgkmcnt(12)
    v_mfma_f32_32x32x16_bf16 v[32:47], v[68:71], v[88:91], v[32:47]
    s_waitcnt vmcnt(4)
    ds_read_b64_tr_b16 v[60:61], v117 offset:12288
    ds_read_b64_tr_b16 v[62:63], v117 offset:13056
    s_waitcnt lgkmcnt(12)
    v_mfma_f32_32x32x16_bf16 v[0:15], v[72:75], v[92:95], v[0:15]
    buffer_load_dwordx4 v[84:87], v246, s[32:35], s59 offen offset:3072 sc1
    s_add_u32 s59, s59, 4096
    ds_read_b64_tr_b16 v[64:65], v117 offset:12320
    ds_read_b64_tr_b16 v[66:67], v117 offset:13088
    s_waitcnt lgkmcnt(12)
    v_mfma_f32_32x32x16_bf16 v[16:31], v[76:79], v[92:95], v[16:31]
    buffer_load_dwordx4 v[88:91], v246, s[32:35], s59 offen offset:0 sc1
    ds_read_b64_tr_b16 v[68:69], v117 offset:12352
    ds_read_b64_tr_b16 v[70:71], v117 offset:13120
    s_waitcnt lgkmcnt(12)
    v_mfma_f32_32x32x16_bf16 v[32:47], v[80:83], v[92:95], v[32:47]
    s_mul_i32 s65, s44, 49152
    v_add_u32 v251, s65, v246
    s_sub_u32 s65, 49152, s65
    v_add_u32 v252, s65, v246
    s_waitcnt vmcnt(5)
    ds_read_b64_tr_b16 v[72:73], v117 offset:15360
    ds_read_b64_tr_b16 v[74:75], v117 offset:16128
    s_waitcnt lgkmcnt(12)
    v_mfma_f32_32x32x16_bf16 v[0:15], v[48:51], v[96:99], v[0:15]
    buffer_load_dwordx4 v[92:95], v246, s[32:35], s59 offen offset:1024 sc1
    ds_read_b64_tr_b16 v[76:77], v117 offset:15392
    ds_read_b64_tr_b16 v[78:79], v117 offset:16160
    s_waitcnt lgkmcnt(12)
    v_mfma_f32_32x32x16_bf16 v[16:31], v[52:55], v[96:99], v[16:31]
    ds_read_b64_tr_b16 v[80:81], v117 offset:15424
    ds_read_b64_tr_b16 v[82:83], v117 offset:16192
    s_waitcnt lgkmcnt(12)
    v_mfma_f32_32x32x16_bf16 v[32:47], v[56:59], v[96:99], v[32:47]
    v_bfe_u32 v247, v245, 4, 1
    v_lshrrev_b32 v250, 5, v245
    v_lshl_add_u32 v250, v247, 1, v250
    v_lshlrev_b32 v250, 8, v250
    v_bfe_u32 v247, v245, 2, 1
    v_lshl_add_u32 v250, v247, 5, v250
    v_bfe_u32 v247, v245, 3, 1
    v_lshl_add_u32 v250, v247, 4, v250
    v_and_b32 v247, 3, v245
    v_lshl_add_u32 v250, v247, 2, v250
    s_waitcnt vmcnt(5)
    ds_read_b64_tr_b16 v[48:49], v117 offset:18432
    ds_read_b64_tr_b16 v[50:51], v117 offset:19200
    s_waitcnt lgkmcnt(12)
    v_mfma_f32_32x32x16_bf16 v[0:15], v[60:63], v[100:103], v[0:15]
    buffer_load_dwordx4 v[96:99], v246, s[32:35], s59 offen offset:2048 sc1
    ds_read_b64_tr_b16 v[52:53], v117 offset:18464
    ds_read_b64_tr_b16 v[54:55], v117 offset:19232
    s_waitcnt lgkmcnt(12)
    v_mfma_f32_32x32x16_bf16 v[16:31], v[64:67], v[100:103], v[16:31]
    ds_read_b64_tr_b16 v[56:57], v117 offset:18496
    ds_read_b64_tr_b16 v[58:59], v117 offset:19264
    s_waitcnt lgkmcnt(12)
    v_mfma_f32_32x32x16_bf16 v[32:47], v[68:71], v[100:103], v[32:47]
    s_lshl_b32 s78, s2, 10
    s_add_u32 s78, s78, 12058624
    buffer_load_dword v253, v250, s[36:39], s78 offen offset:0 sc1
    buffer_load_dword v254, v250, s[36:39], s78 offen offset:64 sc1
    buffer_load_dword v255, v250, s[36:39], s78 offen offset:128 sc1
    s_waitcnt vmcnt(8)
    ds_read_b64_tr_b16 v[60:61], v117 offset:21504
    ds_read_b64_tr_b16 v[62:63], v117 offset:22272
    s_waitcnt lgkmcnt(12)
    v_mfma_f32_32x32x16_bf16 v[0:15], v[72:75], v[104:107], v[0:15]
    buffer_load_dwordx4 v[100:103], v246, s[32:35], s59 offen offset:3072 sc1
    s_add_u32 s59, s59, 4096
    ds_read_b64_tr_b16 v[64:65], v117 offset:21536
    ds_read_b64_tr_b16 v[66:67], v117 offset:22304
    s_waitcnt lgkmcnt(12)
    v_mfma_f32_32x32x16_bf16 v[16:31], v[76:79], v[104:107], v[16:31]
    ds_read_b64_tr_b16 v[68:69], v117 offset:21568
    ds_read_b64_tr_b16 v[70:71], v117 offset:22336
    s_waitcnt lgkmcnt(12)
    v_mfma_f32_32x32x16_bf16 v[32:47], v[80:83], v[104:107], v[32:47]
    s_cmp_ge_u32 s3, 4
    s_cbranch_scc1 L_ls5
    ds_read_b64_tr_b16 v[120:121], v223 offset:0
    ds_read_b64_tr_b16 v[122:123], v223 offset:2560
    ds_read_b64_tr_b16 v[124:125], v223 offset:32
    ds_read_b64_tr_b16 v[126:127], v223 offset:2592
    ds_read_b64_tr_b16 v[128:129], v223 offset:64
    ds_read_b64_tr_b16 v[130:131], v223 offset:2624
    ds_read_b64_tr_b16 v[132:133], v223 offset:96
    ds_read_b64_tr_b16 v[134:135], v223 offset:2656
    ds_read_b64_tr_b16 v[136:137], v223 offset:128
    ds_read_b64_tr_b16 v[138:139], v223 offset:2688
L_ls5:
    s_waitcnt vmcnt(8)
    ds_read_b64_tr_b16 v[72:73], v117 offset:24576
    ds_read_b64_tr_b16 v[74:75], v117 offset:25344
    s_waitcnt lgkmcnt(12)
    v_mfma_f32_32x32x16_bf16 v[0:15], v[48:51], v[108:111], v[0:15]
    buffer_load_dwordx4 v[104:107], v246, s[32:35], s59 offen offset:0 sc1
    ds_read_b64_tr_b16 v[76:77], v117 offset:24608
    ds_read_b64_tr_b16 v[78:79], v117 offset:25376
    s_waitcnt lgkmcnt(12)
    v_mfma_f32_32x32x16_bf16 v[16:31], v[52:55], v[108:111], v[16:31]
    ds_read_b64_tr_b16 v[80:81], v117 offset:24640
    ds_read_b64_tr_b16 v[82:83], v117 offset:25408
    s_waitcnt lgkmcnt(12)
    v_mfma_f32_32x32x16_bf16 v[32:47], v[56:59], v[108:111], v[32:47]
    s_waitcnt vmcnt(8)
    ds_read_b64_tr_b16 v[48:49], v117 offset:27648
    ds_read_b64_tr_b16 v[50:51], v117 offset:28416
    s_waitcnt lgkmcnt(12)
    v_mfma_f32_32x32x16_bf16 v[0:15], v[60:63], v[84:87], v[0:15]
    buffer_load_dwordx4 v[108:111], v246, s[32:35], s59 offen offset:1024 sc1
    ds_read_b64_tr_b16 v[52:53], v117 offset:27680
    ds_read_b64_tr_b16 v[54:55], v117 offset:28448
    s_waitcnt lgkmcnt(12)
    v_mfma_f32_32x32x16_bf16 v[16:31], v[64:67], v[84:87], v[16:31]
    ds_read_b64_tr_b16 v[56:57], v117 offset:27712
    ds_read_b64_tr_b16 v[58:59], v117 offset:28480
    s_waitcnt lgkmcnt(12)
    v_mfma_f32_32x32x16_bf16 v[32:47], v[68:71], v[84:87], v[32:47]
    s_waitcnt vmcnt(8)
    ds_read_b64_tr_b16 v[60:61], v117 offset:30720
    ds_read_b64_tr_b16 v[62:63], v117 offset:31488
    s_waitcnt lgkmcnt(12)
    v_mfma_f32_32x32x16_bf16 v[0:15], v[72:75], v[88:91], v[0:15]
    buffer_load_dwordx4 v[84:87], v246, s[32:35], s59 offen offset:2048 sc1
    ds_read_b64_tr_b16 v[64:65], v117 offset:30752
    ds_read_b64_tr_b16 v[66:67], v117 offset:31520
    s_waitcnt lgkmcnt(12)
    v_mfma_f32_32x32x16_bf16 v[16:31], v[76:79], v[88:91], v[16:31]
    ds_read_b64_tr_b16 v[68:69], v117 offset:30784
    ds_read_b64_tr_b16 v[70:71], v117 offset:31552
    s_waitcnt lgkmcnt(12)
    v_mfma_f32_32x32x16_bf16 v[32:47], v[80:83], v[88:91], v[32:47]
    buffer_load_dwordx4 v[112:115], v119, s[36:39], s58 offen offset:0 sc1
    s_waitcnt vmcnt(9)
    ds_read_b64_tr_b16 v[72:73], v117 offset:33792
    ds_read_b64_tr_b16 v[74:75], v117 offset:34560
    s_waitcnt lgkmcnt(12)
    v_mfma_f32_32x32x16_bf16 v[0:15], v[48:51], v[92:95], v[0:15]
    buffer_load_dwordx4 v[88:91], v246, s[32:35], s59 offen offset:3072 sc1
    s_add_u32 s59, s59, 4096
    ds_read_b64_tr_b16 v[76:77], v117 offset:33824
    ds_read_b64_tr_b16 v[78:79], v117 offset:34592
    s_waitcnt lgkmcnt(12)
    v_mfma_f32_32x32x16_bf16 v[16:31], v[52:55], v[92:95], v[16:31]
    ds_read_b64_tr_b16 v[80:81], v117 offset:33856
    ds_read_b64_tr_b16 v[82:83], v117 offset:34624
    s_waitcnt lgkmcnt(12)
    v_mfma_f32_32x32x16_bf16 v[32:47], v[56:59], v[92:95], v[32:47]
    s_cmp_ge_u32 s3, 4
    s_cbranch_scc1 L_ls9
    s_add_u32 m0, s60, 0
    s_nop 0
    buffer_load_dwordx4 v240, s[28:31], s55 offen lds
    s_add_u32 m0, s60, 1024
    s_nop 0
    buffer_load_dwordx4 v241, s[28:31], s55 offen lds
    s_add_u32 m0, s60, 2048
    s_nop 0
    buffer_load_dwordx4 v242, s[28:31], s55 offen lds
    s_add_u32 m0, s60, 3072
    s_nop 0
    buffer_load_dwordx4 v243, s[28:31], s55 offen lds
    s_add_u32 m0, s60, 4096
    s_nop 0
    buffer_load_dwordx4 v244, s[28:31], s55 offen lds
    s_add_u32 s55, s55, 40960
L_ls9:
    s_waitcnt vmcnt(9)
    ds_read_b64_tr_b16 v[48:49], v117 offset:36864
    ds_read_b64_tr_b16 v[50:51], v117 offset:37632
    s_waitcnt lgkmcnt(12)
    v_mfma_f32_32x32x16_bf16 v[0:15], v[60:63], v[96:99], v[0:15]
    buffer_load_dwordx4 v[92:95], v246, s[32:35], s59 offen offset:0 sc1
    ds_read_b64_tr_b16 v[52:53], v117 offset:36896
    ds_read_b64_tr_b16 v[54:55], v117 offset:37664
    s_waitcnt lgkmcnt(12)
    v_mfma_f32_32x32x16_bf16 v[16:31], v[64:67], v[96:99], v[16:31]
    ds_read_b64_tr_b16 v[56:57], v117 offset:36928
    ds_read_b64_tr_b16 v[58:59], v117 offset:37696
    s_waitcnt lgkmcnt(12)
    v_mfma_f32_32x32x16_bf16 v[32:47], v[68:71], v[96:99], v[32:47]
    s_waitcnt vmcnt(6)
    ds_read_b64_tr_b16 v[60:61], v117 offset:39936
    ds_read_b64_tr_b16 v[62:63], v117 offset:40704
    s_waitcnt lgkmcnt(12)
    v_mfma_f32_32x32x16_bf16 v[0:15], v[72:75], v[100:103], v[0:15]
    buffer_load_dwordx4 v[96:99], v246, s[32:35], s59 offen offset:1024 sc1
    ds_read_b64_tr_b16 v[64:65], v117 offset:39968
    ds_read_b64_tr_b16 v[66:67], v117 offset:40736
    s_waitcnt lgkmcnt(12)
    v_mfma_f32_32x32x16_bf16 v[16:31], v[76:79], v[100:103], v[16:31]
    ds_read_b64_tr_b16 v[68:69], v117 offset:40000
    ds_read_b64_tr_b16 v[70:71], v117 offset:40768
    s_waitcnt lgkmcnt(12)
    v_mfma_f32_32x32x16_bf16 v[32:47], v[80:83], v[100:103], v[32:47]
    s_waitcnt vmcnt(6)
    ds_read_b64_tr_b16 v[72:73], v117 offset:43008
    ds_read_b64_tr_b16 v[74:75], v117 offset:43776
    s_waitcnt lgkmcnt(12)
    v_mfma_f32_32x32x16_bf16 v[0:15], v[48:51], v[104:107], v[0:15]
    buffer_load_dwordx4 v[100:103], v246, s[32:35], s59 offen offset:2048 sc1
    ds_read_b64_tr_b16 v[76:77], v117 offset:43040
    ds_read_b64_tr_b16 v[78:79], v117 offset:43808
    s_waitcnt lgkmcnt(12)
    v_mfma_f32_32x32x16_bf16 v[16:31], v[52:55], v[104:107], v[16:31]
    ds_read_b64_tr_b16 v[80:81], v117 offset:43072
    ds_read_b64_tr_b16 v[82:83], v117 offset:43840
    s_waitcnt lgkmcnt(12)
    v_mfma_f32_32x32x16_bf16 v[32:47], v[56:59], v[104:107], v[32:47]
    s_waitcnt vmcnt(6)
    ds_read_b64_tr_b16 v[48:49], v117 offset:46080
    ds_read_b64_tr_b16 v[50:51], v117 offset:46848
    s_waitcnt lgkmcnt(12)
    v_mfma_f32_32x32x16_bf16 v[0:15], v[60:63], v[108:111], v[0:15]
    buffer_load_dwordx4 v[104:107], v246, s[32:35], s59 offen offset:3072 sc1
    s_add_u32 s59, s59, 4096
    ds_read_b64_tr_b16 v[52:53], v117 offset:46112
    ds_read_b64_tr_b16 v[54:55], v117 offset:46880
    s_waitcnt lgkmcnt(12)
    v_mfma_f32_32x32x16_bf16 v[16:31], v[64:67], v[108:111], v[16:31]
    ds_read_b64_tr_b16 v[56:57], v117 offset:46144
    ds_read_b64_tr_b16 v[58:59], v117 offset:46912
    s_waitcnt lgkmcnt(12)
    v_mfma_f32_32x32x16_bf16 v[32:47], v[68:71], v[108:111], v[32:47]
    s_waitcnt vmcnt(6)
    ds_read_b64_tr_b16 v[60:61], v117 offset:49152
    ds_read_b64_tr_b16 v[62:63], v117 offset:49920
    s_waitcnt lgkmcnt(12)
    v_mfma_f32_32x32x16_bf16 v[0:15], v[72:75], v[84:87], v[0:15]
    buffer_load_dwordx4 v[108:111], v246, s[32:35], s59 offen offset:0 sc1
    ds_read_b64_tr_b16 v[64:65], v117 offset:49184
    ds_read_b64_tr_b16 v[66:67], v117 offset:49952
    s_waitcnt lgkmcnt(12)
    v_mfma_f32_32x32x16_bf16 v[16:31], v[76:79], v[84:87], v[16:31]
    ds_read_b64_tr_b16 v[68:69], v117 offset:49216
    ds_read_b64_tr_b16 v[70:71], v117 offset:49984
    s_waitcnt lgkmcnt(12)
    v_mfma_f32_32x32x16_bf16 v[32:47], v[80:83], v[84:87], v[32:47]
    s_waitcnt vmcnt(5)
    ds_read_b64_tr_b16 v[72:73], v117 offset:52224
    ds_read_b64_tr_b16 v[74:75], v117 offset:52992
    s_waitcnt lgkmcnt(12)
    v_mfma_f32_32x32x16_bf16 v[0:15], v[48:51], v[88:91], v[0:15]
    buffer_load_dwordx4 v[84:87], v246, s[32:35], s59 offen offset:1024 sc1
    ds_read_b64_tr_b16 v[76:77], v117 offset:52256
    ds_read_b64_tr_b16 v[78:79], v117 offset:53024
    s_waitcnt lgkmcnt(12)
    v_mfma_f32_32x32x16_bf16 v[16:31], v[52:55], v[88:91], v[16:31]
    ds_read_b64_tr_b16 v[80:81], v117 offset:52288
    ds_read_b64_tr_b16 v[82:83], v117 offset:53056
    s_waitcnt lgkmcnt(12)
    v_mfma_f32_32x32x16_bf16 v[32:47], v[56:59], v[88:91], v[32:47]
    s_waitcnt vmcnt(5)
    ds_read_b64_tr_b16 v[48:49], v117 offset:55296
    ds_read_b64_tr_b16 v[50:51], v117 offset:56064
    s_waitcnt lgkmcnt(12)
    v_mfma_f32_32x32x16_bf16 v[0:15], v[60:63], v[92:95], v[0:15]
    buffer_load_dwordx4 v[88:91], v246, s[32:35], s59 offen offset:2048 sc1
    ds_read_b64_tr_b16 v[52:53], v117 offset:55328
    ds_read_b64_tr_b16 v[54:55], v117 offset:56096
    s_waitcnt lgkmcnt(12)
    v_mfma_f32_32x32x16_bf16 v[16:31], v[64:67], v[92:95], v[16:31]
    ds_read_b64_tr_b16 v[56:57], v117 offset:55360
    ds_read_b64_tr_b16 v[58:59], v117 offset:56128
    s_waitcnt lgkmcnt(12)
    v_mfma_f32_32x32x16_bf16 v[32:47], v[68:71], v[92:95], v[32:47]
    v_add_f32 v248, v112, v114
    v_add_f32 v249, v113, v115
    buffer_load_dwordx4 v[112:115], v119, s[36:39], s58 offen offset:512 sc1
    s_waitcnt vmcnt(6)
    ds_read_b64_tr_b16 v[60:61], v117 offset:58368
    ds_read_b64_tr_b16 v[62:63], v117 offset:59136
    s_waitcnt lgkmcnt(12)
    v_mfma_f32_32x32x16_bf16 v[0:15], v[72:75], v[96:99], v[0:15]
    buffer_load_dwordx4 v[92:95], v246, s[32:35], s59 offen offset:3072 sc1
    s_add_u32 s59, s59, 4096
    ds_read_b64_tr_b16 v[64:65], v117 offset:58400
    ds_read_b64_tr_b16 v[66:67], v117 offset:59168
    s_waitcnt lgkmcnt(12)
    v_mfma_f32_32x32x16_bf16 v[16:31], v[76:79], v[96:99], v[16:31]
    ds_read_b64_tr_b16 v[68:69], v117 offset:58432
    ds_read_b64_tr_b16 v[70:71], v117 offset:59200
    s_waitcnt lgkmcnt(12)
    v_mfma_f32_32x32x16_bf16 v[32:47], v[80:83], v[96:99], v[32:47]
    s_cmp_ge_u32 s3, 4
    s_cbranch_scc1 L_ls17
    ds_read_b64_tr_b16 v[140:141], v223 offset:0
    ds_read_b64_tr_b16 v[142:143], v223 offset:2560
    ds_read_b64_tr_b16 v[144:145], v223 offset:32
    ds_read_b64_tr_b16 v[146:147], v223 offset:2592
    ds_read_b64_tr_b16 v[148:149], v223 offset:64
    ds_read_b64_tr_b16 v[150:151], v223 offset:2624
    ds_read_b64_tr_b16 v[152:153], v223 offset:96
    ds_read_b64_tr_b16 v[154:155], v223 offset:2656
    ds_read_b64_tr_b16 v[156:157], v223 offset:128
    ds_read_b64_tr_b16 v[158:159], v223 offset:2688
L_ls17:
    s_waitcnt vmcnt(6)
    v_add_u32 v117, 61440, v116
    ds_read_b64_tr_b16 v[72:73], v117 offset:0
    ds_read_b64_tr_b16 v[74:75], v117 offset:768
    s_waitcnt lgkmcnt(12)
    v_mfma_f32_32x32x16_bf16 v[0:15], v[48:51], v[100:103], v[0:15]
    buffer_load_dwordx4 v[96:99], v246, s[32:35], s59 offen offset:0 sc1
    ds_read_b64_tr_b16 v[76:77], v117 offset:32
    ds_read_b64_tr_b16 v[78:79], v117 offset:800
    s_waitcnt lgkmcnt(12)
    v_mfma_f32_32x32x16_bf16 v[16:31], v[52:55], v[100:103], v[16:31]
    ds_read_b64_tr_b16 v[80:81], v117 offset:64
    ds_read_b64_tr_b16 v[82:83], v117 offset:832
    s_waitcnt lgkmcnt(12)
    v_mfma_f32_32x32x16_bf16 v[32:47], v[56:59], v[100:103], v[32:47]
    s_waitcnt vmcnt(6)
    ds_read_b64_tr_b16 v[48:49], v117 offset:3072
    ds_read_b64_tr_b16 v[50:51], v117 offset:3840
    s_waitcnt lgkmcnt(12)
    v_mfma_f32_32x32x16_bf16 v[0:15], v[60:63], v[104:107], v[0:15]
    buffer_load_dwordx4 v[100:103], v246, s[32:35], s59 offen offset:1024 sc1
    ds_read_b64_tr_b16 v[52:53], v117 offset:3104
    ds_read_b64_tr_b16 v[54:55], v117 offset:3872
    s_waitcnt lgkmcnt(12)
    v_mfma_f32_32x32x16_bf16 v[16:31], v[64:67], v[104:107], v[16:31]
    ds_read_b64_tr_b16 v[56:57], v117 offset:3136
    ds_read_b64_tr_b16 v[58:59], v117 offset:3904
    s_waitcnt lgkmcnt(12)
    v_mfma_f32_32x32x16_bf16 v[32:47], v[68:71], v[104:107], v[32:47]
    s_waitcnt vmcnt(6)
    ds_read_b64_tr_b16 v[60:61], v117 offset:6144
    ds_read_b64_tr_b16 v[62:63], v117 offset:6912
    s_waitcnt lgkmcnt(12)
    v_mfma_f32_32x32x16_bf16 v[0:15], v[72:75], v[108:111], v[0:15]
    buffer_load_dwordx4 v[104:107], v246, s[32:35], s59 offen offset:2048 sc1
    ds_read_b64_tr_b16 v[64:65], v117 offset:6176
    ds_read_b64_tr_b16 v[66:67], v117 offset:6944
    s_waitcnt lgkmcnt(12)
    v_mfma_f32_32x32x16_bf16 v[16:31], v[76:79], v[108:111], v[16:31]
    ds_read_b64_tr_b16 v[68:69], v117 offset:6208
    ds_read_b64_tr_b16 v[70:71], v117 offset:6976
    s_waitcnt lgkmcnt(12)
    v_mfma_f32_32x32x16_bf16 v[32:47], v[80:83], v[108:111], v[32:47]
    s_waitcnt vmcnt(6)
    ds_read_b64_tr_b16 v[72:73], v117 offset:9216
    ds_read_b64_tr_b16 v[74:75], v117 offset:9984
    s_waitcnt lgkmcnt(12)
    v_mfma_f32_32x32x16_bf16 v[0:15], v[48:51], v[84:87], v[0:15]
    buffer_load_dwordx4 v[108:111], v246, s[32:35], s59 offen offset:3072 sc1
    s_add_u32 s59, s59, 4096
    ds_read_b64_tr_b16 v[76:77], v117 offset:9248
    ds_read_b64_tr_b16 v[78:79], v117 offset:10016
    s_waitcnt lgkmcnt(12)
    v_mfma_f32_32x32x16_bf16 v[16:31], v[52:55], v[84:87], v[16:31]
    ds_read_b64_tr_b16 v[80:81], v117 offset:9280
    ds_read_b64_tr_b16 v[82:83], v117 offset:10048
    s_waitcnt lgkmcnt(12)
    v_mfma_f32_32x32x16_bf16 v[32:47], v[56:59], v[84:87], v[32:47]
    s_cmp_ge_u32 s3, 4
    s_cbranch_scc1 L_ls21
    ds_write_b128 v222, v[160:163] offset:0
    ds_write_b128 v222, v[164:167] offset:1024
    ds_write_b128 v222, v[168:171] offset:2048
    ds_write_b128 v222, v[172:175] offset:3072
    ds_write_b128 v222, v[176:179] offset:4096
    ds_read_b64_tr_b16 v[160:161], v223 offset:0
    ds_read_b64_tr_b16 v[162:163], v223 offset:2560
    ds_read_b64_tr_b16 v[164:165], v223 offset:32
    ds_read_b64_tr_b16 v[166:167], v223 offset:2592
    ds_read_b64_tr_b16 v[168:169], v223 offset:64
    ds_read_b64_tr_b16 v[170:171], v223 offset:2624
    ds_read_b64_tr_b16 v[172:173], v223 offset:96
    ds_read_b64_tr_b16 v[174:175], v223 offset:2656
    ds_read_b64_tr_b16 v[176:177], v223 offset:128
    ds_read_b64_tr_b16 v[178:179], v223 offset:2688
L_ls21:
    s_waitcnt vmcnt(6)
    ds_read_b64_tr_b16 v[48:49], v117 offset:12288
    ds_read_b64_tr_b16 v[50:51], v117 offset:13056
    s_waitcnt lgkmcnt(12)
    v_mfma_f32_32x32x16_bf16 v[0:15], v[60:63], v[88:91], v[0:15]
    buffer_load_dwordx4 v[84:87], v246, s[32:35], s59 offen offset:0 sc1
    ds_read_b64_tr_b16 v[52:53], v117 offset:12320
    ds_read_b64_tr_b16 v[54:55], v117 offset:13088
    s_waitcnt lgkmcnt(12)
    v_mfma_f32_32x32x16_bf16 v[16:31], v[64:67], v[88:91], v[16:31]
    ds_read_b64_tr_b16 v[56:57], v117 offset:12352
    ds_read_b64_tr_b16 v[58:59], v117 offset:13120
    s_waitcnt lgkmcnt(12)
    v_mfma_f32_32x32x16_bf16 v[32:47], v[68:71], v[88:91], v[32:47]
    s_waitcnt vmcnt(5)
    ds_read_b64_tr_b16 v[60:61], v117 offset:15360
    ds_read_b64_tr_b16 v[62:63], v117 offset:16128
    s_waitcnt lgkmcnt(12)
    v_mfma_f32_32x32x16_bf16 v[0:15], v[72:75], v[92:95], v[0:15]
    buffer_load_dwordx4 v[88:91], v246, s[32:35], s59 offen offset:1024 sc1
    ds_read_b64_tr_b16 v[64:65], v117 offset:15392
    ds_read_b64_tr_b16 v[66:67], v117 offset:16160
    s_waitcnt lgkmcnt(12)
    v_mfma_f32_32x32x16_bf16 v[16:31], v[76:79], v[92:95], v[16:31]
    ds_read_b64_tr_b16 v[68:69], v117 offset:15424
    ds_read_b64_tr_b16 v[70:71], v117 offset:16192
    s_waitcnt lgkmcnt(12)
    v_mfma_f32_32x32x16_bf16 v[32:47], v[80:83], v[92:95], v[32:47]
    s_waitcnt vmcnt(5)
    ds_read_b64_tr_b16 v[72:73], v117 offset:18432
    ds_read_b64_tr_b16 v[74:75], v117 offset:19200
    s_waitcnt lgkmcnt(12)
    v_mfma_f32_32x32x16_bf16 v[0:15], v[48:51], v[96:99], v[0:15]
    buffer_load_dwordx4 v[92:95], v246, s[32:35], s59 offen offset:2048 sc1
    ds_read_b64_tr_b16 v[76:77], v117 offset:18464
    ds_read_b64_tr_b16 v[78:79], v117 offset:19232
    s_waitcnt lgkmcnt(12)
    v_mfma_f32_32x32x16_bf16 v[16:31], v[52:55], v[96:99], v[16:31]
    ds_read_b64_tr_b16 v[80:81], v117 offset:18496
    ds_read_b64_tr_b16 v[82:83], v117 offset:19264
    s_waitcnt lgkmcnt(12)
    v_mfma_f32_32x32x16_bf16 v[32:47], v[56:59], v[96:99], v[32:47]
    v_add_f32 v112, v112, v114
    v_add_f32 v113, v113, v115
    v_add_f32 v248, v248, v112
    v_add_f32 v249, v249, v113
    s_waitcnt vmcnt(5)
    ds_read_b64_tr_b16 v[48:49], v117 offset:21504
    ds_read_b64_tr_b16 v[50:51], v117 offset:22272
    s_waitcnt lgkmcnt(12)
    v_mfma_f32_32x32x16_bf16 v[0:15], v[60:63], v[100:103], v[0:15]
    buffer_load_dwordx4 v[96:99], v246, s[32:35], s59 offen offset:3072 sc1
    s_add_u32 s59, s59, 4096
    ds_read_b64_tr_b16 v[52:53], v117 offset:21536
    ds_read_b64_tr_b16 v[54:55], v117 offset:22304
    s_waitcnt lgkmcnt(12)
    v_mfma_f32_32x32x16_bf16 v[16:31], v[64:67], v[100:103], v[16:31]
    ds_read_b64_tr_b16 v[56:57], v117 offset:21568
    ds_read_b64_tr_b16 v[58:59], v117 offset:22336
    s_waitcnt lgkmcnt(12)
    v_mfma_f32_32x32x16_bf16 v[32:47], v[68:71], v[100:103], v[32:47]
    s_cmp_ge_u32 s3, 4
    s_cbranch_scc1 L_ls25
    ds_write_b128 v222, v[180:183] offset:0
    ds_write_b128 v222, v[184:187] offset:1024
    ds_write_b128 v222, v[188:191] offset:2048
    ds_write_b128 v222, v[192:195] offset:3072
    ds_write_b128 v222, v[196:199] offset:4096
    ds_read_b64_tr_b16 v[180:181], v223 offset:0
    ds_read_b64_tr_b16 v[182:183], v223 offset:2560
    ds_read_b64_tr_b16 v[184:185], v223 offset:32
    ds_read_b64_tr_b16 v[186:187], v223 offset:2592
    ds_read_b64_tr_b16 v[188:189], v223 offset:64
    ds_read_b64_tr_b16 v[190:191], v223 offset:2624
    ds_read_b64_tr_b16 v[192:193], v223 offset:96
    ds_read_b64_tr_b16 v[194:195], v223 offset:2656
    ds_read_b64_tr_b16 v[196:197], v223 offset:128
    ds_read_b64_tr_b16 v[198:199], v223 offset:2688
L_ls25:
    s_waitcnt vmcnt(5)
    ds_read_b64_tr_b16 v[60:61], v117 offset:24576
    ds_read_b64_tr_b16 v[62:63], v117 offset:25344
    s_waitcnt lgkmcnt(12)
    v_mfma_f32_32x32x16_bf16 v[0:15], v[72:75], v[104:107], v[0:15]
    buffer_load_dwordx4 v[100:103], v246, s[32:35], s59 offen offset:0 sc1
    ds_read_b64_tr_b16 v[64:65], v117 offset:24608
    ds_read_b64_tr_b16 v[66:67], v117 offset:25376
    s_waitcnt lgkmcnt(12)
    v_mfma_f32_32x32x16_bf16 v[16:31], v[76:79], v[104:107], v[16:31]
    ds_read_b64_tr_b16 v[68:69], v117 offset:24640
    ds_read_b64_tr_b16 v[70:71], v117 offset:25408
    s_waitcnt lgkmcnt(12)
    v_mfma_f32_32x32x16_bf16 v[32:47], v[80:83], v[104:107], v[32:47]
    s_waitcnt vmcnt(5)
    ds_read_b64_tr_b16 v[72:73], v117 offset:27648
    ds_read_b64_tr_b16 v[74:75], v117 offset:28416
    s_waitcnt lgkmcnt(12)
    v_mfma_f32_32x32x16_bf16 v[0:15], v[48:51], v[108:111], v[0:15]
    buffer_load_dwordx4 v[104:107], v246, s[32:35], s59 offen offset:1024 sc1
    ds_read_b64_tr_b16 v[76:77], v117 offset:27680
    ds_read_b64_tr_b16 v[78:79], v117 offset:28448
    s_waitcnt lgkmcnt(12)
    v_mfma_f32_32x32x16_bf16 v[16:31], v[52:55], v[108:111], v[16:31]
    ds_read_b64_tr_b16 v[80:81], v117 offset:27712
    ds_read_b64_tr_b16 v[82:83], v117 offset:28480
    s_waitcnt lgkmcnt(12)
    v_mfma_f32_32x32x16_bf16 v[32:47], v[56:59], v[108:111], v[32:47]
    s_waitcnt vmcnt(5)
    ds_read_b64_tr_b16 v[48:49], v117 offset:30720
    ds_read_b64_tr_b16 v[50:51], v117 offset:31488
    s_waitcnt lgkmcnt(12)
    v_mfma_f32_32x32x16_bf16 v[0:15], v[60:63], v[84:87], v[0:15]
    buffer_load_dwordx4 v[108:111], v246, s[32:35], s59 offen offset:2048 sc1
    ds_read_b64_tr_b16 v[52:53], v117 offset:30752
    ds_read_b64_tr_b16 v[54:55], v117 offset:31520
    s_waitcnt lgkmcnt(12)
    v_mfma_f32_32x32x16_bf16 v[16:31], v[64:67], v[84:87], v[16:31]
    ds_read_b64_tr_b16 v[56:57], v117 offset:30784
    ds_read_b64_tr_b16 v[58:59], v117 offset:31552
    s_waitcnt lgkmcnt(12)
    v_mfma_f32_32x32x16_bf16 v[32:47], v[68:71], v[84:87], v[32:47]
    v_mov_b32 v114, v248
    v_mov_b32 v115, v249
    s_nop 0
    v_permlane32_swap_b32 v248, v114
    v_permlane32_swap_b32 v249, v115
    v_add_f32 v248, v248, v114
    v_add_f32 v249, v249, v115
    v_mul_f32 v248, 0xbacccccd, v248
    v_mul_f32 v249, 0x3acccccd, v249
    s_waitcnt vmcnt(5)
    ds_read_b64_tr_b16 v[60:61], v117 offset:33792
    ds_read_b64_tr_b16 v[62:63], v117 offset:34560
    s_waitcnt lgkmcnt(12)
    v_mfma_f32_32x32x16_bf16 v[0:15], v[72:75], v[88:91], v[0:15]
    buffer_load_dwordx4 v[84:87], v246, s[32:35], s59 offen offset:3072 sc1
    s_add_u32 s59, s59, 4096
    ds_read_b64_tr_b16 v[64:65], v117 offset:33824
    ds_read_b64_tr_b16 v[66:67], v117 offset:34592
    s_waitcnt lgkmcnt(12)
    v_mfma_f32_32x32x16_bf16 v[16:31], v[76:79], v[88:91], v[16:31]
    ds_read_b64_tr_b16 v[68:69], v117 offset:33856
    ds_read_b64_tr_b16 v[70:71], v117 offset:34624
    s_waitcnt lgkmcnt(12)
    v_mfma_f32_32x32x16_bf16 v[32:47], v[80:83], v[88:91], v[32:47]
    v_fma_f32 v249, -v248, v248, v249
    v_max_f32 v249, 0, v249
    v_add_f32 v249, 0x3727c5ac, v249
    v_rsq_f32 v250, v249
    v_cvt_pk_bf16_f32 v114, v248, v248
    v_and_b32 v115, 0xffff0000, v114
    v_sub_f32 v115, v248, v115
    s_waitcnt vmcnt(5)
    ds_read_b64_tr_b16 v[72:73], v117 offset:36864
    ds_read_b64_tr_b16 v[74:75], v117 offset:37632
    s_waitcnt lgkmcnt(12)
    v_mfma_f32_32x32x16_bf16 v[0:15], v[48:51], v[92:95], v[0:15]
    buffer_load_dwordx4 v[88:91], v246, s[32:35], s59 offen offset:0 sc1
    ds_read_b64_tr_b16 v[76:77], v117 offset:36896
    ds_read_b64_tr_b16 v[78:79], v117 offset:37664
    s_waitcnt lgkmcnt(12)
    v_mfma_f32_32x32x16_bf16 v[16:31], v[52:55], v[92:95], v[16:31]
    ds_read_b64_tr_b16 v[80:81], v117 offset:36928
    ds_read_b64_tr_b16 v[82:83], v117 offset:37696
    s_waitcnt lgkmcnt(12)
    v_mfma_f32_32x32x16_bf16 v[32:47], v[56:59], v[92:95], v[32:47]
    v_mul_f32 v119, 0xc0135761, v250
    v_mul_f32 v116, v250, v250
    v_mul_f32 v116, v116, v250
    v_mul_f32 v116, 0xbdd2d3e8, v116
    s_mul_i32 s58, s68, 98304
    s_mul_i32 s78, s5, 1536
    s_add_u32 s58, s58, s78
    s_add_u32 s58, s58, 5767168
    s_lshl_b32 s56, s68, 7
    s_lshl_b32 s78, s5, 2
    s_add_u32 s56, s56, s78
    s_add_u32 s56, s56, 53248
    s_waitcnt vmcnt(5)
    ds_read_b64_tr_b16 v[48:49], v117 offset:39936
    ds_read_b64_tr_b16 v[50:51], v117 offset:40704
    s_waitcnt lgkmcnt(12)
    v_mfma_f32_32x32x16_bf16 v[0:15], v[60:63], v[96:99], v[0:15]
    buffer_load_dwordx4 v[92:95], v246, s[32:35], s59 offen offset:1024 sc1
    ds_read_b64_tr_b16 v[52:53], v117 offset:39968
    ds_read_b64_tr_b16 v[54:55], v117 offset:40736
    s_waitcnt lgkmcnt(12)
    v_mfma_f32_32x32x16_bf16 v[16:31], v[64:67], v[96:99], v[16:31]
    ds_read_b64_tr_b16 v[56:57], v117 offset:40000
    ds_read_b64_tr_b16 v[58:59], v117 offset:40768
    s_waitcnt lgkmcnt(12)
    v_mfma_f32_32x32x16_bf16 v[32:47], v[68:71], v[96:99], v[32:47]
    v_and_b32 v112, 15, v245
    v_bfe_u32 v113, v245, 4, 1
    v_lshrrev_b32 v114, 5, v245
    v_mul_u32_u24 v113, 49152, v113
    v_lshl_add_u32 v113, v112, 4, v113
    v_lshl_add_u32 v113, v114, 8, v113
    s_waitcnt vmcnt(5)
    ds_read_b64_tr_b16 v[60:61], v117 offset:43008
    ds_read_b64_tr_b16 v[62:63], v117 offset:43776
    s_waitcnt lgkmcnt(12)
    v_mfma_f32_32x32x16_bf16 v[0:15], v[72:75], v[100:103], v[0:15]
    buffer_load_dwordx4 v[96:99], v246, s[32:35], s59 offen offset:2048 sc1
    ds_read_b64_tr_b16 v[64:65], v117 offset:43040
    ds_read_b64_tr_b16 v[66:67], v117 offset:43808
    s_waitcnt lgkmcnt(12)
    v_mfma_f32_32x32x16_bf16 v[16:31], v[76:79], v[100:103], v[16:31]
    ds_read_b64_tr_b16 v[68:69], v117 offset:43072
    ds_read_b64_tr_b16 v[70:71], v117 offset:43840
    s_waitcnt lgkmcnt(12)
    v_mfma_f32_32x32x16_bf16 v[32:47], v[80:83], v[100:103], v[32:47]
    s_waitcnt vmcnt(5)
    ds_read_b64_tr_b16 v[72:73], v117 offset:46080
    ds_read_b64_tr_b16 v[74:75], v117 offset:46848
    s_waitcnt lgkmcnt(12)
    v_mfma_f32_32x32x16_bf16 v[0:15], v[48:51], v[104:107], v[0:15]
    buffer_load_dwordx4 v[100:103], v246, s[32:35], s59 offen offset:3072 sc1
    s_add_u32 s59, s59, 4096
    ds_read_b64_tr_b16 v[76:77], v117 offset:46112
    ds_read_b64_tr_b16 v[78:79], v117 offset:46880
    s_waitcnt lgkmcnt(12)
    v_mfma_f32_32x32x16_bf16 v[16:31], v[52:55], v[104:107], v[16:31]
    ds_read_b64_tr_b16 v[80:81], v117 offset:46144
    ds_read_b64_tr_b16 v[82:83], v117 offset:46912
    s_waitcnt lgkmcnt(12)
    v_mfma_f32_32x32x16_bf16 v[32:47], v[56:59], v[104:107], v[32:47]
    s_waitcnt vmcnt(5)
    ds_read_b64_tr_b16 v[48:49], v117 offset:49152
    ds_read_b64_tr_b16 v[50:51], v117 offset:49920
    s_waitcnt lgkmcnt(12)
    v_mfma_f32_32x32x16_bf16 v[0:15], v[60:63], v[108:111], v[0:15]
    ds_read_b64_tr_b16 v[52:53], v117 offset:49184
    ds_read_b64_tr_b16 v[54:55], v117 offset:49952
    s_waitcnt lgkmcnt(12)
    v_mfma_f32_32x32x16_bf16 v[16:31], v[64:67], v[108:111], v[16:31]
    ds_read_b64_tr_b16 v[56:57], v117 offset:49216
    ds_read_b64_tr_b16 v[58:59], v117 offset:49984
    s_waitcnt lgkmcnt(12)
    v_mfma_f32_32x32x16_bf16 v[32:47], v[68:71], v[108:111], v[32:47]
    s_add_u32 m0, s60, 0
    s_nop 0
    buffer_load_dwordx4 v240, s[28:31], s61 offen lds
    s_waitcnt vmcnt(5)
    ds_read_b64_tr_b16 v[60:61], v117 offset:52224
    ds_read_b64_tr_b16 v[62:63], v117 offset:52992
    s_waitcnt lgkmcnt(12)
    v_mfma_f32_32x32x16_bf16 v[0:15], v[72:75], v[84:87], v[0:15]
    ds_read_b64_tr_b16 v[64:65], v117 offset:52256
    ds_read_b64_tr_b16 v[66:67], v117 offset:53024
    s_waitcnt lgkmcnt(12)
    v_mfma_f32_32x32x16_bf16 v[16:31], v[76:79], v[84:87], v[16:31]
    ds_read_b64_tr_b16 v[68:69], v117 offset:52288
    ds_read_b64_tr_b16 v[70:71], v117 offset:53056
    s_waitcnt lgkmcnt(12)
    v_mfma_f32_32x32x16_bf16 v[32:47], v[80:83], v[84:87], v[32:47]
    s_add_u32 m0, s60, 1024
    s_nop 0
    buffer_load_dwordx4 v241, s[28:31], s61 offen lds
    v_cvt_pk_bf16_f32 v104, v248, v115
    v_mov_b32 v106, 0
    v_mov_b32 v107, 0
    v_mov_b32 v105, v104
    s_waitcnt vmcnt(5)
    ds_read_b64_tr_b16 v[72:73], v117 offset:55296
    ds_read_b64_tr_b16 v[74:75], v117 offset:56064
    s_waitcnt lgkmcnt(12)
    v_mfma_f32_32x32x16_bf16 v[0:15], v[48:51], v[88:91], v[0:15]
    ds_read_b64_tr_b16 v[76:77], v117 offset:55328
    ds_read_b64_tr_b16 v[78:79], v117 offset:56096
    s_waitcnt lgkmcnt(12)
    v_mfma_f32_32x32x16_bf16 v[16:31], v[52:55], v[88:91], v[16:31]
    ds_read_b64_tr_b16 v[80:81], v117 offset:55360
    ds_read_b64_tr_b16 v[82:83], v117 offset:56128
    s_waitcnt lgkmcnt(12)
    v_mfma_f32_32x32x16_bf16 v[32:47], v[56:59], v[88:91], v[32:47]
    s_add_u32 m0, s60, 2048
    s_nop 0
    buffer_load_dwordx4 v242, s[28:31], s61 offen lds
    s_waitcnt vmcnt(5)
    ds_read_b64_tr_b16 v[48:49], v117 offset:58368
    ds_read_b64_tr_b16 v[50:51], v117 offset:59136
    s_waitcnt lgkmcnt(12)
    v_mfma_f32_32x32x16_bf16 v[0:15], v[60:63], v[92:95], v[0:15]
    ds_read_b64_tr_b16 v[52:53], v117 offset:58400
    ds_read_b64_tr_b16 v[54:55], v117 offset:59168
    s_waitcnt lgkmcnt(12)
    v_mfma_f32_32x32x16_bf16 v[16:31], v[64:67], v[92:95], v[16:31]
    ds_read_b64_tr_b16 v[56:57], v117 offset:58432
    ds_read_b64_tr_b16 v[58:59], v117 offset:59200
    s_waitcnt lgkmcnt(12)
    v_mfma_f32_32x32x16_bf16 v[32:47], v[68:71], v[92:95], v[32:47]
    s_add_u32 m0, s60, 3072
    s_nop 0
    buffer_load_dwordx4 v243, s[28:31], s61 offen lds
    s_waitcnt vmcnt(5)
    s_waitcnt lgkmcnt(10)
    v_mfma_f32_32x32x16_bf16 v[0:15], v[72:75], v[96:99], v[0:15]
    s_waitcnt lgkmcnt(8)
    v_mfma_f32_32x32x16_bf16 v[16:31], v[76:79], v[96:99], v[16:31]
    s_waitcnt lgkmcnt(6)
    v_mfma_f32_32x32x16_bf16 v[32:47], v[80:83], v[96:99], v[32:47]
    s_add_u32 m0, s60, 4096
    s_nop 0
    buffer_load_dwordx4 v244, s[28:31], s61 offen lds
    v_mov_b32 v117, v113
    v_cvt_pk_bf16_f32 v60, v253, v253
    v_and_b32 v114, 0xffff0000, v60
    v_sub_f32 v114, v253, v114
    v_cvt_pk_bf16_f32 v61, v114, v114
    v_mov_b32 v62, 0
    v_mov_b32 v63, 0
    v_cvt_pk_bf16_f32 v64, v254, v254
    v_and_b32 v114, 0xffff0000, v64
    v_sub_f32 v114, v254, v114
    v_cvt_pk_bf16_f32 v65, v114, v114
    v_mov_b32 v66, 0
    v_mov_b32 v67, 0
    v_cvt_pk_bf16_f32 v68, v255, v255
    v_and_b32 v114, 0xffff0000, v68
    v_sub_f32 v114, v255, v114
    v_cvt_pk_bf16_f32 v69, v114, v114
    v_mov_b32 v70, 0
    v_mov_b32 v71, 0
    s_waitcnt vmcnt(5)
    s_waitcnt lgkmcnt(4)
    v_mfma_f32_32x32x16_bf16 v[0:15], v[48:51], v[100:103], v[0:15]
    s_waitcnt lgkmcnt(2)
    v_mfma_f32_32x32x16_bf16 v[16:31], v[52:55], v[100:103], v[16:31]
    s_waitcnt lgkmcnt(0)
    v_mfma_f32_32x32x16_bf16 v[32:47], v[56:59], v[100:103], v[32:47]
    buffer_load_dword v112, v118, s[36:39], s62 offen sc1
    v_mfma_f32_32x32x16_bf16 v[0:15], v[60:63], v[104:107], v[0:15]
    v_mfma_f32_32x32x16_bf16 v[16:31], v[64:67], v[104:107], v[16:31]
    v_mfma_f32_32x32x16_bf16 v[32:47], v[68:71], v[104:107], v[32:47]
    s_cmp_lt_u32 s3, 4
    s_cbranch_scc1 L_ep
    s_setprio 0
L_ep:
    s_nop 7
    v_mul_f32 v72, v0, v0
    v_mul_f32 v73, v1, v1
    v_mul_f32 v74, v2, v2
    v_mul_f32 v75, v3, v3
    v_mul_f32 v76, v4, v4
    v_mul_f32 v77, v5, v5
    v_mul_f32 v78, v6, v6
    v_mul_f32 v79, v7, v7
    v_fma_f32 v72, v72, v116, v119
    v_fma_f32 v73, v73, v116, v119
    v_fma_f32 v74, v74, v116, v119
    v_fma_f32 v75, v75, v116, v119
    v_fma_f32 v76, v76, v116, v119
    v_fma_f32 v77, v77, v116, v119
    v_fma_f32 v78, v78, v116, v119
    v_fma_f32 v79, v79, v116, v119
    v_mul_f32 v72, v72, v0
    v_mul_f32 v73, v73, v1
    v_mul_f32 v74, v74, v2
    v_mul_f32 v75, v75, v3
    v_mul_f32 v76, v76, v4
    v_mul_f32 v77, v77, v5
    v_mul_f32 v78, v78, v6
    v_mul_f32 v79, v79, v7
    v_exp_f32 v72, v72
    v_exp_f32 v73, v73
    v_exp_f32 v74, v74
    v_exp_f32 v75, v75
    v_exp_f32 v76, v76
    v_exp_f32 v77, v77
    v_exp_f32 v78, v78
    v_exp_f32 v79, v79
    v_mul_f32 v8, v8, v0
    v_mul_f32 v9, v9, v1
    v_mul_f32 v10, v10, v2
    v_mul_f32 v11, v11, v3
    v_mul_f32 v12, v12, v4
    v_mul_f32 v13, v13, v5
    v_mul_f32 v14, v14, v6
    v_mul_f32 v15, v15, v7
    v_fma_f32 v72, v72, v249, v249
    v_fma_f32 v73, v73, v249, v249
    v_fma_f32 v74, v74, v249, v249
    v_fma_f32 v75, v75, v249, v249
    v_fma_f32 v76, v76, v249, v249
    v_fma_f32 v77, v77, v249, v249
    v_fma_f32 v78, v78, v249, v249
    v_fma_f32 v79, v79, v249, v249
    v_rcp_f32 v72, v72
    v_rcp_f32 v73, v73
    v_rcp_f32 v74, v74
    v_rcp_f32 v75, v75
    v_rcp_f32 v76, v76
    v_rcp_f32 v77, v77
    v_rcp_f32 v78, v78
    v_rcp_f32 v79, v79
    v_mul_f32 v8, v8, v72
    v_mul_f32 v9, v9, v73
    v_mul_f32 v10, v10, v74
    v_mul_f32 v11, v11, v75
    v_mul_f32 v12, v12, v76
    v_mul_f32 v13, v13, v77
    v_mul_f32 v14, v14, v78
    v_mul_f32 v15, v15, v79
    v_cvt_pk_bf16_f32 v80, v8, v9
    v_cvt_pk_bf16_f32 v81, v10, v11
    v_cvt_pk_bf16_f32 v82, v12, v13
    v_cvt_pk_bf16_f32 v83, v14, v15
    s_cmp_ge_u32 s3, 4
    s_cbranch_scc1 L_x27
    s_waitcnt vmcnt(0)
    v_cmp_ne_u32 vcc, s40, v112
    s_nop 4
    s_cbranch_vccz L_y28
    s_mov_b32 s78, 0
L_poll29:
    buffer_load_dword v112, v118, s[36:39], s62 offen sc1
    s_add_u32 s78, s78, 1
    s_cmp_gt_u32 s78, 0x8000
    s_cbranch_scc1 L_pdone30
    s_waitcnt vmcnt(0)
    v_cmp_ne_u32 vcc, s40, v112
    s_nop 4
    s_cbranch_vccnz L_poll29
L_pdone30:
    s_waitcnt vmcnt(0)
L_y28:
    s_mul_i32 s65, s46, 4096
    s_add_u32 s65, s65, s63
    s_add_u32 s65, s65, 24576
    buffer_load_dwordx4 v[92:95], v251, s[36:39], s64 offen offset:0 sc1
    buffer_load_dwordx4 v[96:99], v252, s[36:39], s64 offen offset:0 sc1
    buffer_load_dwordx4 v[100:103], v251, s[36:39], s65 offen offset:0 sc1
    buffer_load_dwordx4 v[104:107], v252, s[36:39], s65 offen offset:0 sc1
    buffer_load_dwordx4 v[108:111], v251, s[36:39], s65 offen offset:1024 sc1
    buffer_load_dwordx4 v[112:115], v252, s[36:39], s65 offen offset:1024 sc1
    buffer_load_dwordx4 v[200:203], v251, s[36:39], s65 offen offset:2048 sc1
    buffer_load_dwordx4 v[204:207], v252, s[36:39], s65 offen offset:2048 sc1
    buffer_load_dwordx4 v[208:211], v251, s[36:39], s65 offen offset:3072 sc1
    buffer_load_dwordx4 v[212:215], v252, s[36:39], s65 offen offset:3072 sc1
L_x27:
    v_mul_f32 v72, v16, v16
    v_mul_f32 v73, v17, v17
    v_mul_f32 v74, v18, v18
    v_mul_f32 v75, v19, v19
    v_mul_f32 v76, v20, v20
    v_mul_f32 v77, v21, v21
    v_mul_f32 v78, v22, v22
    v_mul_f32 v79, v23, v23
    v_fma_f32 v72, v72, v116, v119
    v_fma_f32 v73, v73, v116, v119
    v_fma_f32 v74, v74, v116, v119
    v_fma_f32 v75, v75, v116, v119
    v_fma_f32 v76, v76, v116, v119
    v_fma_f32 v77, v77, v116, v119
    v_fma_f32 v78, v78, v116, v119
    v_fma_f32 v79, v79, v116, v119
    v_mul_f32 v72, v72, v16
    v_mul_f32 v73, v73, v17
    v_mul_f32 v74, v74, v18
    v_mul_f32 v75, v75, v19
    v_mul_f32 v76, v76, v20
    v_mul_f32 v77, v77, v21
    v_mul_f32 v78, v78, v22
    v_mul_f32 v79, v79, v23
    v_exp_f32 v72, v72
    v_exp_f32 v73, v73
    v_exp_f32 v74, v74
    v_exp_f32 v75, v75
    v_exp_f32 v76, v76
    v_exp_f32 v77, v77
    v_exp_f32 v78, v78
    v_exp_f32 v79, v79
    v_mul_f32 v24, v24, v16
    v_mul_f32 v25, v25, v17
    v_mul_f32 v26, v26, v18
    v_mul_f32 v27, v27, v19
    v_mul_f32 v28, v28, v20
    v_mul_f32 v29, v29, v21
    v_mul_f32 v30, v30, v22
    v_mul_f32 v31, v31, v23
    v_fma_f32 v72, v72, v249, v249
    v_fma_f32 v73, v73, v249, v249
    v_fma_f32 v74, v74, v249, v249
    v_fma_f32 v75, v75, v249, v249
    v_fma_f32 v76, v76, v249, v249
    v_fma_f32 v77, v77, v249, v249
    v_fma_f32 v78, v78, v249, v249
    v_fma_f32 v79, v79, v249, v249
    v_rcp_f32 v72, v72
    v_rcp_f32 v73, v73
    v_rcp_f32 v74, v74
    v_rcp_f32 v75, v75
    v_rcp_f32 v76, v76
    v_rcp_f32 v77, v77
    v_rcp_f32 v78, v78
    v_rcp_f32 v79, v79
    v_mul_f32 v24, v24, v72
    v_mul_f32 v25, v25, v73
    v_mul_f32 v26, v26, v74
    v_mul_f32 v27, v27, v75
    v_mul_f32 v28, v28, v76
    v_mul_f32 v29, v29, v77
    v_mul_f32 v30, v30, v78
    v_mul_f32 v31, v31, v79
    v_cvt_pk_bf16_f32 v84, v24, v25
    v_cvt_pk_bf16_f32 v85, v26, v27
    v_cvt_pk_bf16_f32 v86, v28, v29
    v_cvt_pk_bf16_f32 v87, v30, v31
    v_mul_f32 v72, v32, v32
    v_mul_f32 v73, v33, v33
    v_mul_f32 v74, v34, v34
    v_mul_f32 v75, v35, v35
    v_mul_f32 v76, v36, v36
    v_mul_f32 v77, v37, v37
    v_mul_f32 v78, v38, v38
    v_mul_f32 v79, v39, v39
    v_fma_f32 v72, v72, v116, v119
    v_fma_f32 v73, v73, v116, v119
    v_fma_f32 v74, v74, v116, v119
    v_fma_f32 v75, v75, v116, v119
    v_fma_f32 v76, v76, v116, v119
    v_fma_f32 v77, v77, v116, v119
    v_fma_f32 v78, v78, v116, v119
    v_fma_f32 v79, v79, v116, v119
    v_mul_f32 v72, v72, v32
    v_mul_f32 v73, v73, v33
    v_mul_f32 v74, v74, v34
    v_mul_f32 v75, v75, v35
    v_mul_f32 v76, v76, v36
    v_mul_f32 v77, v77, v37
    v_mul_f32 v78, v78, v38
    v_mul_f32 v79, v79, v39
    v_exp_f32 v72, v72
    v_exp_f32 v73, v73
    v_exp_f32 v74, v74
    v_exp_f32 v75, v75
    v_exp_f32 v76, v76
    v_exp_f32 v77, v77
    v_exp_f32 v78, v78
    v_exp_f32 v79, v79
    v_mul_f32 v40, v40, v32
    v_mul_f32 v41, v41, v33
    v_mul_f32 v42, v42, v34
    v_mul_f32 v43, v43, v35
    v_mul_f32 v44, v44, v36
    v_mul_f32 v45, v45, v37
    v_mul_f32 v46, v46, v38
    v_mul_f32 v47, v47, v39
    v_fma_f32 v72, v72, v249, v249
    v_fma_f32 v73, v73, v249, v249
    v_fma_f32 v74, v74, v249, v249
    v_fma_f32 v75, v75, v249, v249
    v_fma_f32 v76, v76, v249, v249
    v_fma_f32 v77, v77, v249, v249
    v_fma_f32 v78, v78, v249, v249
    v_fma_f32 v79, v79, v249, v249
    v_rcp_f32 v72, v72
    v_rcp_f32 v73, v73
    v_rcp_f32 v74, v74
    v_rcp_f32 v75, v75
    v_rcp_f32 v76, v76
    v_rcp_f32 v77, v77
    v_rcp_f32 v78, v78
    v_rcp_f32 v79, v79
    v_mul_f32 v40, v40, v72
    v_mul_f32 v41, v41, v73
    v_mul_f32 v42, v42, v74
    v_mul_f32 v43, v43, v75
    v_mul_f32 v44, v44, v76
    v_mul_f32 v45, v45, v77
    v_mul_f32 v46, v46, v78
    v_mul_f32 v47, v47, v79
    v_cvt_pk_bf16_f32 v88, v40, v41
    v_cvt_pk_bf16_f32 v89, v42, v43
    v_cvt_pk_bf16_f32 v90, v44, v45
    v_cvt_pk_bf16_f32 v91, v46, v47
    s_cmp_eq_u32 s42, 0
    s_cbranch_scc1 L_slow31
    buffer_store_dwordx4 v[80:83], v117, s[36:39], s58 offen offset:0 nt
    buffer_store_dwordx4 v[84:87], v117, s[36:39], s58 offen offset:512 nt
    buffer_store_dwordx4 v[88:91], v117, s[36:39], s58 offen offset:1024 nt
    s_branch L_stend32
L_slow31:
    buffer_store_dwordx4 v[80:83], v117, s[36:39], s58 offen offset:0 nt sc1
    buffer_store_dwordx4 v[84:87], v117, s[36:39], s58 offen offset:512 nt sc1
    buffer_store_dwordx4 v[88:91], v117, s[36:39], s58 offen offset:1024 nt sc1
L_stend32:
    v_add_u32 v248, s60, v246
    v_and_b32 v247, 3, v245
    v_lshrrev_b32 v249, 2, v245
    v_mul_u32_u24 v249, 160, v249
    v_lshl_add_u32 v249, v247, 3, v249
    v_add_u32 v249, s60, v249
    s_mul_i32 s78, s44, 40960
    s_add_u32 s79, s78, 40960
    v_add_u32 v250, s79, v248
    s_sub_u32 s79, 81920, s78
    v_add_u32 v253, s79, v248
    s_waitcnt vmcnt(3)
    s_cmp_ge_u32 s3, 4
    s_cbranch_scc1 L_p5l
    s_add_u32 s62, s62, 128
    ds_read_b64_tr_b16 v[0:1], v249 offset:0
    ds_read_b64_tr_b16 v[2:3], v249 offset:2560
    ds_read_b64_tr_b16 v[4:5], v249 offset:32
    ds_read_b64_tr_b16 v[6:7], v249 offset:2592
    ds_read_b64_tr_b16 v[8:9], v249 offset:64
    ds_read_b64_tr_b16 v[10:11], v249 offset:2624
    ds_read_b64_tr_b16 v[12:13], v249 offset:96
    ds_read_b64_tr_b16 v[14:15], v249 offset:2656
    ds_read_b64_tr_b16 v[16:17], v249 offset:128
    ds_read_b64_tr_b16 v[18:19], v249 offset:2688
    s_cmp_eq_u32 s43, 0
    s_cselect_b32 s78, 0xffff0000, 0
    s_cselect_b32 s79, 0x10000, 0
    v_mul_u32_u24 v20, s79, v230
    v_and_b32 v21, s78, v230
    v_mul_u32_u24 v22, s79, v231
    v_and_b32 v23, s78, v231
    v_mul_u32_u24 v24, s79, v232
    v_and_b32 v25, s78, v232
    v_mul_u32_u24 v26, s79, v233
    v_and_b32 v27, s78, v233
    v_mul_u32_u24 v28, s79, v234
    v_and_b32 v29, s78, v234
    v_mul_u32_u24 v30, s79, v235
    v_and_b32 v31, s78, v235
    v_mul_u32_u24 v32, s79, v236
    v_and_b32 v33, s78, v236
    v_mul_u32_u24 v34, s79, v237
    v_and_b32 v35, s78, v237
    v_mul_u32_u24 v36, s79, v238
    v_and_b32 v37, s78, v238
    v_mul_u32_u24 v38, s79, v239
    v_and_b32 v39, s78, v239
    v_mov_b32 v247, s40
    s_mov_b64 exec, 1
    s_waitcnt vmcnt(0)
    s_cmp_eq_u32 s42, 0
    s_cbranch_scc1 L_slow33
    buffer_store_dword v247, off, s[36:39], s56
    s_branch L_stend34
L_slow33:
    buffer_store_dword v247, off, s[36:39], s56 sc1
L_stend34:
    s_mov_b64 exec, -1
    s_barrier
    s_waitcnt lgkmcnt(0)
    v_mfma_f32_16x16x32_bf16 v[20:23], v[0:3], v[92:95], v[20:23]
    v_mfma_f32_16x16x32_bf16 v[40:43], v[0:3], v[96:99], 0
    v_mfma_f32_16x16x32_bf16 v[24:27], v[4:7], v[92:95], v[24:27]
    v_mfma_f32_16x16x32_bf16 v[44:47], v[4:7], v[96:99], 0
    v_mfma_f32_16x16x32_bf16 v[28:31], v[8:11], v[92:95], v[28:31]
    v_mfma_f32_16x16x32_bf16 v[48:51], v[8:11], v[96:99], 0
    v_mfma_f32_16x16x32_bf16 v[32:35], v[12:15], v[92:95], v[32:35]
    v_mfma_f32_16x16x32_bf16 v[52:55], v[12:15], v[96:99], 0
    v_mfma_f32_16x16x32_bf16 v[36:39], v[16:19], v[92:95], v[36:39]
    v_mfma_f32_16x16x32_bf16 v[56:59], v[16:19], v[96:99], 0
    v_mfma_f32_16x16x32_bf16 v[20:23], v[160:163], v[100:103], v[20:23]
    v_mfma_f32_16x16x32_bf16 v[40:43], v[160:163], v[104:107], v[40:43]
    v_mfma_f32_16x16x32_bf16 v[24:27], v[164:167], v[100:103], v[24:27]
    v_mfma_f32_16x16x32_bf16 v[44:47], v[164:167], v[104:107], v[44:47]
    v_mfma_f32_16x16x32_bf16 v[28:31], v[168:171], v[100:103], v[28:31]
    v_mfma_f32_16x16x32_bf16 v[48:51], v[168:171], v[104:107], v[48:51]
    v_mfma_f32_16x16x32_bf16 v[32:35], v[172:175], v[100:103], v[32:35]
    v_mfma_f32_16x16x32_bf16 v[52:55], v[172:175], v[104:107], v[52:55]
    v_mfma_f32_16x16x32_bf16 v[36:39], v[176:179], v[100:103], v[36:39]
    v_mfma_f32_16x16x32_bf16 v[56:59], v[176:179], v[104:107], v[56:59]
    v_mfma_f32_16x16x32_bf16 v[20:23], v[180:183], v[108:111], v[20:23]
    v_mfma_f32_16x16x32_bf16 v[40:43], v[180:183], v[112:115], v[40:43]
    v_mfma_f32_16x16x32_bf16 v[24:27], v[184:187], v[108:111], v[24:27]
    v_mfma_f32_16x16x32_bf16 v[44:47], v[184:187], v[112:115], v[44:47]
    v_mfma_f32_16x16x32_bf16 v[28:31], v[188:191], v[108:111], v[28:31]
    v_mfma_f32_16x16x32_bf16 v[48:51], v[188:191], v[112:115], v[48:51]
    v_mfma_f32_16x16x32_bf16 v[32:35], v[192:195], v[108:111], v[32:35]
    v_mfma_f32_16x16x32_bf16 v[52:55], v[192:195], v[112:115], v[52:55]
    v_mfma_f32_16x16x32_bf16 v[36:39], v[196:199], v[108:111], v[36:39]
    v_mfma_f32_16x16x32_bf16 v[56:59], v[196:199], v[112:115], v[56:59]
    buffer_load_dword v112, v118, s[36:39], s62 offen sc1
    v_mfma_f32_16x16x32_bf16 v[20:23], v[120:123], v[200:203], v[20:23]
    v_mfma_f32_16x16x32_bf16 v[40:43], v[120:123], v[204:207], v[40:43]
    v_mfma_f32_16x16x32_bf16 v[24:27], v[124:127], v[200:203], v[24:27]
    v_mfma_f32_16x16x32_bf16 v[44:47], v[124:127], v[204:207], v[44:47]
    v_mfma_f32_16x16x32_bf16 v[28:31], v[128:131], v[200:203], v[28:31]
    v_mfma_f32_16x16x32_bf16 v[48:51], v[128:131], v[204:207], v[48:51]
    v_mfma_f32_16x16x32_bf16 v[32:35], v[132:135], v[200:203], v[32:35]
    v_mfma_f32_16x16x32_bf16 v[52:55], v[132:135], v[204:207], v[52:55]
    v_mfma_f32_16x16x32_bf16 v[36:39], v[136:139], v[200:203], v[36:39]
    v_mfma_f32_16x16x32_bf16 v[56:59], v[136:139], v[204:207], v[56:59]
    v_mfma_f32_16x16x32_bf16 v[20:23], v[140:143], v[208:211], v[20:23]
    v_mfma_f32_16x16x32_bf16 v[40:43], v[140:143], v[212:215], v[40:43]
    v_mfma_f32_16x16x32_bf16 v[24:27], v[144:147], v[208:211], v[24:27]
    v_mfma_f32_16x16x32_bf16 v[44:47], v[144:147], v[212:215], v[44:47]
    v_mfma_f32_16x16x32_bf16 v[28:31], v[148:151], v[208:211], v[28:31]
    v_mfma_f32_16x16x32_bf16 v[48:51], v[148:151], v[212:215], v[48:51]
    v_mfma_f32_16x16x32_bf16 v[32:35], v[152:155], v[208:211], v[32:35]
    v_mfma_f32_16x16x32_bf16 v[52:55], v[152:155], v[212:215], v[52:55]
    v_mfma_f32_16x16x32_bf16 v[36:39], v[156:159], v[208:211], v[36:39]
    v_mfma_f32_16x16x32_bf16 v[56:59], v[156:159], v[212:215], v[56:59]
    s_waitcnt vmcnt(0)
    v_cmp_ne_u32 vcc, s40, v112
    s_nop 4
    s_cbranch_vccz L_z35
    ds_write_b128 v250, v[20:23] offset:0
    ds_write_b128 v250, v[24:27] offset:1024
    ds_write_b128 v250, v[28:31] offset:2048
    ds_write_b128 v250, v[32:35] offset:3072
    ds_write_b128 v250, v[36:39] offset:4096
    ds_write_b128 v253, v[40:43] offset:0
    ds_write_b128 v253, v[44:47] offset:1024
    ds_write_b128 v253, v[48:51] offset:2048
    ds_write_b128 v253, v[52:55] offset:3072
    ds_write_b128 v253, v[56:59] offset:4096
    s_mul_i32 s78, s44, 122880
    v_add_u32 v250, s78, v248
    s_sub_u32 s78, 122880, s78
    v_add_u32 v253, s78, v248
    s_mov_b32 s78, 0
L_poll36:
    buffer_load_dword v112, v118, s[36:39], s62 offen sc1
    s_add_u32 s78, s78, 1
    s_cmp_gt_u32 s78, 0x8000
    s_cbranch_scc1 L_pdone37
    s_waitcnt vmcnt(0)
    v_cmp_ne_u32 vcc, s40, v112
    s_nop 4
    s_cbranch_vccnz L_poll36
L_pdone37:
    s_waitcnt vmcnt(0)
    s_add_u32 s64, s64, 98304
    s_add_u32 s65, s65, 98304
    buffer_load_dwordx4 v[60:63], v251, s[36:39], s64 offen offset:0 sc1
    buffer_load_dwordx4 v[64:67], v252, s[36:39], s64 offen offset:0 sc1
    buffer_load_dwordx4 v[68:71], v251, s[36:39], s65 offen offset:0 sc1
    buffer_load_dwordx4 v[72:75], v252, s[36:39], s65 offen offset:0 sc1
    buffer_load_dwordx4 v[76:79], v251, s[36:39], s65 offen offset:1024 sc1
    buffer_load_dwordx4 v[80:83], v252, s[36:39], s65 offen offset:1024 sc1
    buffer_load_dwordx4 v[84:87], v251, s[36:39], s65 offen offset:2048 sc1
    buffer_load_dwordx4 v[88:91], v252, s[36:39], s65 offen offset:2048 sc1
    buffer_load_dwordx4 v[216:219], v251, s[36:39], s65 offen offset:3072 sc1
    buffer_load_dwordx4 v[220:223], v252, s[36:39], s65 offen offset:3072 sc1
    s_branch L_z35b
L_z35:
    s_add_u32 s64, s64, 98304
    s_add_u32 s65, s65, 98304
    buffer_load_dwordx4 v[60:63], v251, s[36:39], s64 offen offset:0 sc1
    buffer_load_dwordx4 v[64:67], v252, s[36:39], s64 offen offset:0 sc1
    buffer_load_dwordx4 v[68:71], v251, s[36:39], s65 offen offset:0 sc1
    buffer_load_dwordx4 v[72:75], v252, s[36:39], s65 offen offset:0 sc1
    buffer_load_dwordx4 v[76:79], v251, s[36:39], s65 offen offset:1024 sc1
    buffer_load_dwordx4 v[80:83], v252, s[36:39], s65 offen offset:1024 sc1
    buffer_load_dwordx4 v[84:87], v251, s[36:39], s65 offen offset:2048 sc1
    buffer_load_dwordx4 v[88:91], v252, s[36:39], s65 offen offset:2048 sc1
    buffer_load_dwordx4 v[216:219], v251, s[36:39], s65 offen offset:3072 sc1
    buffer_load_dwordx4 v[220:223], v252, s[36:39], s65 offen offset:3072 sc1
    ds_write_b128 v250, v[20:23] offset:0
    ds_write_b128 v250, v[24:27] offset:1024
    ds_write_b128 v250, v[28:31] offset:2048
    ds_write_b128 v250, v[32:35] offset:3072
    ds_write_b128 v250, v[36:39] offset:4096
    ds_write_b128 v253, v[40:43] offset:0
    ds_write_b128 v253, v[44:47] offset:1024
    ds_write_b128 v253, v[48:51] offset:2048
    ds_write_b128 v253, v[52:55] offset:3072
    ds_write_b128 v253, v[56:59] offset:4096
    s_mul_i32 s78, s44, 122880
    v_add_u32 v250, s78, v248
    s_sub_u32 s78, 122880, s78
    v_add_u32 v253, s78, v248
L_z35b:
    s_cmp_eq_u32 s43, 1
    s_cselect_b32 s78, 0xffff0000, 0
    s_cselect_b32 s79, 0x10000, 0
    v_mul_u32_u24 v20, s79, v230
    v_and_b32 v21, s78, v230
    v_mul_u32_u24 v22, s79, v231
    v_and_b32 v23, s78, v231
    v_mul_u32_u24 v24, s79, v232
    v_and_b32 v25, s78, v232
    v_mul_u32_u24 v26, s79, v233
    v_and_b32 v27, s78, v233
    v_mul_u32_u24 v28, s79, v234
    v_and_b32 v29, s78, v234
    v_mul_u32_u24 v30, s79, v235
    v_and_b32 v31, s78, v235
    v_mul_u32_u24 v32, s79, v236
    v_and_b32 v33, s78, v236
    v_mul_u32_u24 v34, s79, v237
    v_and_b32 v35, s78, v237
    v_mul_u32_u24 v36, s79, v238
    v_and_b32 v37, s78, v238
    v_mul_u32_u24 v38, s79, v239
    v_and_b32 v39, s78, v239
    s_waitcnt vmcnt(8)
    v_mfma_f32_16x16x32_bf16 v[20:23], v[0:3], v[60:63], v[20:23]
    v_mfma_f32_16x16x32_bf16 v[40:43], v[0:3], v[64:67], 0
    v_mfma_f32_16x16x32_bf16 v[24:27], v[4:7], v[60:63], v[24:27]
    v_mfma_f32_16x16x32_bf16 v[44:47], v[4:7], v[64:67], 0
    v_mfma_f32_16x16x32_bf16 v[28:31], v[8:11], v[60:63], v[28:31]
    v_mfma_f32_16x16x32_bf16 v[48:51], v[8:11], v[64:67], 0
    v_mfma_f32_16x16x32_bf16 v[32:35], v[12:15], v[60:63], v[32:35]
    v_mfma_f32_16x16x32_bf16 v[52:55], v[12:15], v[64:67], 0
    v_mfma_f32_16x16x32_bf16 v[36:39], v[16:19], v[60:63], v[36:39]
    v_mfma_f32_16x16x32_bf16 v[56:59], v[16:19], v[64:67], 0
    s_waitcnt vmcnt(6)
    v_mfma_f32_16x16x32_bf16 v[20:23], v[160:163], v[68:71], v[20:23]
    v_mfma_f32_16x16x32_bf16 v[40:43], v[160:163], v[72:75], v[40:43]
    v_mfma_f32_16x16x32_bf16 v[24:27], v[164:167], v[68:71], v[24:27]
    v_mfma_f32_16x16x32_bf16 v[44:47], v[164:167], v[72:75], v[44:47]
    v_mfma_f32_16x16x32_bf16 v[28:31], v[168:171], v[68:71], v[28:31]
    v_mfma_f32_16x16x32_bf16 v[48:51], v[168:171], v[72:75], v[48:51]
    v_mfma_f32_16x16x32_bf16 v[32:35], v[172:175], v[68:71], v[32:35]
    v_mfma_f32_16x16x32_bf16 v[52:55], v[172:175], v[72:75], v[52:55]
    v_mfma_f32_16x16x32_bf16 v[36:39], v[176:179], v[68:71], v[36:39]
    v_mfma_f32_16x16x32_bf16 v[56:59], v[176:179], v[72:75], v[56:59]
    s_waitcnt vmcnt(4)
    v_mfma_f32_16x16x32_bf16 v[20:23], v[180:183], v[76:79], v[20:23]
    v_mfma_f32_16x16x32_bf16 v[40:43], v[180:183], v[80:83], v[40:43]
    v_mfma_f32_16x16x32_bf16 v[24:27], v[184:187], v[76:79], v[24:27]
    v_mfma_f32_16x16x32_bf16 v[44:47], v[184:187], v[80:83], v[44:47]
    v_mfma_f32_16x16x32_bf16 v[28:31], v[188:191], v[76:79], v[28:31]
    v_mfma_f32_16x16x32_bf16 v[48:51], v[188:191], v[80:83], v[48:51]
    v_mfma_f32_16x16x32_bf16 v[32:35], v[192:195], v[76:79], v[32:35]
    v_mfma_f32_16x16x32_bf16 v[52:55], v[192:195], v[80:83], v[52:55]
    v_mfma_f32_16x16x32_bf16 v[36:39], v[196:199], v[76:79], v[36:39]
    v_mfma_f32_16x16x32_bf16 v[56:59], v[196:199], v[80:83], v[56:59]
    s_waitcnt vmcnt(2)
    v_mfma_f32_16x16x32_bf16 v[20:23], v[120:123], v[84:87], v[20:23]
    v_mfma_f32_16x16x32_bf16 v[40:43], v[120:123], v[88:91], v[40:43]
    v_mfma_f32_16x16x32_bf16 v[24:27], v[124:127], v[84:87], v[24:27]
    v_mfma_f32_16x16x32_bf16 v[44:47], v[124:127], v[88:91], v[44:47]
    v_mfma_f32_16x16x32_bf16 v[28:31], v[128:131], v[84:87], v[28:31]
    v_mfma_f32_16x16x32_bf16 v[48:51], v[128:131], v[88:91], v[48:51]
    v_mfma_f32_16x16x32_bf16 v[32:35], v[132:135], v[84:87], v[32:35]
    v_mfma_f32_16x16x32_bf16 v[52:55], v[132:135], v[88:91], v[52:55]
    v_mfma_f32_16x16x32_bf16 v[36:39], v[136:139], v[84:87], v[36:39]
    v_mfma_f32_16x16x32_bf16 v[56:59], v[136:139], v[88:91], v[56:59]
    s_waitcnt vmcnt(0)
    v_mfma_f32_16x16x32_bf16 v[20:23], v[140:143], v[216:219], v[20:23]
    v_mfma_f32_16x16x32_bf16 v[40:43], v[140:143], v[220:223], v[40:43]
    v_mfma_f32_16x16x32_bf16 v[24:27], v[144:147], v[216:219], v[24:27]
    v_mfma_f32_16x16x32_bf16 v[44:47], v[144:147], v[220:223], v[44:47]
    v_mfma_f32_16x16x32_bf16 v[28:31], v[148:151], v[216:219], v[28:31]
    v_mfma_f32_16x16x32_bf16 v[48:51], v[148:151], v[220:223], v[48:51]
    v_mfma_f32_16x16x32_bf16 v[32:35], v[152:155], v[216:219], v[32:35]
    v_mfma_f32_16x16x32_bf16 v[52:55], v[152:155], v[220:223], v[52:55]
    v_mfma_f32_16x16x32_bf16 v[36:39], v[156:159], v[216:219], v[36:39]
    v_mfma_f32_16x16x32_bf16 v[56:59], v[156:159], v[220:223], v[56:59]
    s_branch L_p5e
L_p5l:
    ds_read_b64_tr_b16 v[0:1], v249 offset:0
    ds_read_b64_tr_b16 v[2:3], v249 offset:2560
    ds_read_b64_tr_b16 v[4:5], v249 offset:32
    ds_read_b64_tr_b16 v[6:7], v249 offset:2592
    ds_read_b64_tr_b16 v[8:9], v249 offset:64
    ds_read_b64_tr_b16 v[10:11], v249 offset:2624
    ds_read_b64_tr_b16 v[12:13], v249 offset:96
    ds_read_b64_tr_b16 v[14:15], v249 offset:2656
    ds_read_b64_tr_b16 v[16:17], v249 offset:128
    ds_read_b64_tr_b16 v[18:19], v249 offset:2688
    v_mov_b32 v247, s40
    s_mov_b64 exec, 1
    s_waitcnt vmcnt(0)
    s_cmp_eq_u32 s42, 0
    s_cbranch_scc1 L_slow38
    buffer_store_dword v247, off, s[36:39], s56
    s_branch L_stend39
L_slow38:
    buffer_store_dword v247, off, s[36:39], s56 sc1
L_stend39:
    s_mov_b64 exec, -1
    s_setprio 0
    s_mov_b32 s78, 0
L_poll40:
    buffer_load_dword v112, v118, s[36:39], s62 offen sc1
    s_add_u32 s78, s78, 1
    s_cmp_gt_u32 s78, 0x8000
    s_cbranch_scc1 L_pdone41
    s_waitcnt vmcnt(0)
    v_cmp_ne_u32 vcc, s40, v112
    s_nop 4
    s_cbranch_vccnz L_poll40
L_pdone41:
    s_waitcnt vmcnt(0)
    s_mul_i32 s65, s46, 6144
    s_add_u32 s65, s65, s63
    buffer_load_dwordx4 v[60:63], v251, s[36:39], s64 offen offset:0 sc1
    buffer_load_dwordx4 v[64:67], v252, s[36:39], s64 offen offset:0 sc1
    buffer_load_dwordx4 v[68:71], v251, s[36:39], s65 offen offset:0 sc1
    buffer_load_dwordx4 v[72:75], v252, s[36:39], s65 offen offset:0 sc1
    buffer_load_dwordx4 v[76:79], v251, s[36:39], s65 offen offset:1024 sc1
    buffer_load_dwordx4 v[80:83], v252, s[36:39], s65 offen offset:1024 sc1
    buffer_load_dwordx4 v[84:87], v251, s[36:39], s65 offen offset:2048 sc1
    buffer_load_dwordx4 v[88:91], v252, s[36:39], s65 offen offset:2048 sc1
    buffer_load_dwordx4 v[92:95], v251, s[36:39], s65 offen offset:3072 sc1
    buffer_load_dwordx4 v[96:99], v252, s[36:39], s65 offen offset:3072 sc1
    s_add_u32 s65, s65, 4096
    buffer_load_dwordx4 v[100:103], v251, s[36:39], s65 offen offset:0 sc1
    buffer_load_dwordx4 v[104:107], v252, s[36:39], s65 offen offset:0 sc1
    buffer_load_dwordx4 v[108:111], v251, s[36:39], s65 offen offset:1024 sc1
    buffer_load_dwordx4 v[112:115], v252, s[36:39], s65 offen offset:1024 sc1
    s_add_u32 s62, s62, 128
    s_waitcnt lgkmcnt(0)
    s_waitcnt vmcnt(12)
    v_mfma_f32_16x16x32_bf16 v[20:23], v[0:3], v[60:63], 0
    v_mfma_f32_16x16x32_bf16 v[40:43], v[0:3], v[64:67], 0
    v_mfma_f32_16x16x32_bf16 v[24:27], v[4:7], v[60:63], 0
    v_mfma_f32_16x16x32_bf16 v[44:47], v[4:7], v[64:67], 0
    v_mfma_f32_16x16x32_bf16 v[28:31], v[8:11], v[60:63], 0
    v_mfma_f32_16x16x32_bf16 v[48:51], v[8:11], v[64:67], 0
    v_mfma_f32_16x16x32_bf16 v[32:35], v[12:15], v[60:63], 0
    v_mfma_f32_16x16x32_bf16 v[52:55], v[12:15], v[64:67], 0
    v_mfma_f32_16x16x32_bf16 v[36:39], v[16:19], v[60:63], 0
    v_mfma_f32_16x16x32_bf16 v[56:59], v[16:19], v[64:67], 0
    s_waitcnt vmcnt(10)
    v_mfma_f32_16x16x32_bf16 v[20:23], v[120:123], v[68:71], v[20:23]
    v_mfma_f32_16x16x32_bf16 v[40:43], v[120:123], v[72:75], v[40:43]
    v_mfma_f32_16x16x32_bf16 v[24:27], v[124:127], v[68:71], v[24:27]
    v_mfma_f32_16x16x32_bf16 v[44:47], v[124:127], v[72:75], v[44:47]
    v_mfma_f32_16x16x32_bf16 v[28:31], v[128:131], v[68:71], v[28:31]
    v_mfma_f32_16x16x32_bf16 v[48:51], v[128:131], v[72:75], v[48:51]
    v_mfma_f32_16x16x32_bf16 v[32:35], v[132:135], v[68:71], v[32:35]
    v_mfma_f32_16x16x32_bf16 v[52:55], v[132:135], v[72:75], v[52:55]
    v_mfma_f32_16x16x32_bf16 v[36:39], v[136:139], v[68:71], v[36:39]
    v_mfma_f32_16x16x32_bf16 v[56:59], v[136:139], v[72:75], v[56:59]
    s_waitcnt vmcnt(8)
    v_mfma_f32_16x16x32_bf16 v[20:23], v[140:143], v[76:79], v[20:23]
    v_mfma_f32_16x16x32_bf16 v[40:43], v[140:143], v[80:83], v[40:43]
    v_mfma_f32_16x16x32_bf16 v[24:27], v[144:147], v[76:79], v[24:27]
    v_mfma_f32_16x16x32_bf16 v[44:47], v[144:147], v[80:83], v[44:47]
    v_mfma_f32_16x16x32_bf16 v[28:31], v[148:151], v[76:79], v[28:31]
    v_mfma_f32_16x16x32_bf16 v[48:51], v[148:151], v[80:83], v[48:51]
    v_mfma_f32_16x16x32_bf16 v[32:35], v[152:155], v[76:79], v[32:35]
    v_mfma_f32_16x16x32_bf16 v[52:55], v[152:155], v[80:83], v[52:55]
    v_mfma_f32_16x16x32_bf16 v[36:39], v[156:159], v[76:79], v[36:39]
    v_mfma_f32_16x16x32_bf16 v[56:59], v[156:159], v[80:83], v[56:59]
    s_waitcnt vmcnt(6)
    v_mfma_f32_16x16x32_bf16 v[20:23], v[160:163], v[84:87], v[20:23]
    v_mfma_f32_16x16x32_bf16 v[40:43], v[160:163], v[88:91], v[40:43]
    v_mfma_f32_16x16x32_bf16 v[24:27], v[164:167], v[84:87], v[24:27]
    v_mfma_f32_16x16x32_bf16 v[44:47], v[164:167], v[88:91], v[44:47]
    v_mfma_f32_16x16x32_bf16 v[28:31], v[168:171], v[84:87], v[28:31]
    v_mfma_f32_16x16x32_bf16 v[48:51], v[168:171], v[88:91], v[48:51]
    v_mfma_f32_16x16x32_bf16 v[32:35], v[172:175], v[84:87], v[32:35]
    v_mfma_f32_16x16x32_bf16 v[52:55], v[172:175], v[88:91], v[52:55]
    v_mfma_f32_16x16x32_bf16 v[36:39], v[176:179], v[84:87], v[36:39]
    v_mfma_f32_16x16x32_bf16 v[56:59], v[176:179], v[88:91], v[56:59]
    s_waitcnt vmcnt(4)
    v_mfma_f32_16x16x32_bf16 v[20:23], v[180:183], v[92:95], v[20:23]
    v_mfma_f32_16x16x32_bf16 v[40:43], v[180:183], v[96:99], v[40:43]
    v_mfma_f32_16x16x32_bf16 v[24:27], v[184:187], v[92:95], v[24:27]
    v_mfma_f32_16x16x32_bf16 v[44:47], v[184:187], v[96:99], v[44:47]
    v_mfma_f32_16x16x32_bf16 v[28:31], v[188:191], v[92:95], v[28:31]
    v_mfma_f32_16x16x32_bf16 v[48:51], v[188:191], v[96:99], v[48:51]
    v_mfma_f32_16x16x32_bf16 v[32:35], v[192:195], v[92:95], v[32:35]
    v_mfma_f32_16x16x32_bf16 v[52:55], v[192:195], v[96:99], v[52:55]
    v_mfma_f32_16x16x32_bf16 v[36:39], v[196:199], v[92:95], v[36:39]
    v_mfma_f32_16x16x32_bf16 v[56:59], v[196:199], v[96:99], v[56:59]
    s_waitcnt vmcnt(2)
    v_mfma_f32_16x16x32_bf16 v[20:23], v[200:203], v[100:103], v[20:23]
    v_mfma_f32_16x16x32_bf16 v[40:43], v[200:203], v[104:107], v[40:43]
    v_mfma_f32_16x16x32_bf16 v[24:27], v[204:207], v[100:103], v[24:27]
    v_mfma_f32_16x16x32_bf16 v[44:47], v[204:207], v[104:107], v[44:47]
    v_mfma_f32_16x16x32_bf16 v[28:31], v[208:211], v[100:103], v[28:31]
    v_mfma_f32_16x16x32_bf16 v[48:51], v[208:211], v[104:107], v[48:51]
    v_mfma_f32_16x16x32_bf16 v[32:35], v[212:215], v[100:103], v[32:35]
    v_mfma_f32_16x16x32_bf16 v[52:55], v[212:215], v[104:107], v[52:55]
    v_mfma_f32_16x16x32_bf16 v[36:39], v[216:219], v[100:103], v[36:39]
    v_mfma_f32_16x16x32_bf16 v[56:59], v[216:219], v[104:107], v[56:59]
    s_waitcnt vmcnt(0)
    v_mfma_f32_16x16x32_bf16 v[20:23], v[220:223], v[108:111], v[20:23]
    v_mfma_f32_16x16x32_bf16 v[40:43], v[220:223], v[112:115], v[40:43]
    v_mfma_f32_16x16x32_bf16 v[24:27], v[224:227], v[108:111], v[24:27]
    v_mfma_f32_16x16x32_bf16 v[44:47], v[224:227], v[112:115], v[44:47]
    v_mfma_f32_16x16x32_bf16 v[28:31], v[228:231], v[108:111], v[28:31]
    v_mfma_f32_16x16x32_bf16 v[48:51], v[228:231], v[112:115], v[48:51]
    v_mfma_f32_16x16x32_bf16 v[32:35], v[232:235], v[108:111], v[32:35]
    v_mfma_f32_16x16x32_bf16 v[52:55], v[232:235], v[112:115], v[52:55]
    v_mfma_f32_16x16x32_bf16 v[36:39], v[236:239], v[108:111], v[36:39]
    v_mfma_f32_16x16x32_bf16 v[56:59], v[236:239], v[112:115], v[56:59]
    s_barrier
    ds_write_b128 v250, v[20:23] offset:0
    ds_write_b128 v250, v[24:27] offset:1024
    ds_write_b128 v250, v[28:31] offset:2048
    s_nop 0
    ds_write_b128 v250, v[32:35] offset:3072
    s_nop 0
    ds_write_b128 v250, v[36:39] offset:4096
    ds_write_b128 v253, v[40:43] offset:0
    ds_write_b128 v253, v[44:47] offset:1024
    ds_write_b128 v253, v[48:51] offset:2048
    ds_write_b128 v253, v[52:55] offset:3072
    ds_write_b128 v253, v[56:59] offset:4096
    s_mul_i32 s78, s44, 122880
    v_add_u32 v250, s78, v248
    s_sub_u32 s78, 122880, s78
    v_add_u32 v253, s78, v248
    s_setprio 1
    s_mov_b32 s78, 0
L_poll42:
    buffer_load_dword v112, v118, s[36:39], s62 offen sc1
    s_add_u32 s78, s78, 1
    s_cmp_gt_u32 s78, 0x8000
    s_cbranch_scc1 L_pdone43
    s_waitcnt vmcnt(0)
    v_cmp_ne_u32 vcc, s40, v112
    s_nop 4
    s_cbranch_vccnz L_poll42
L_pdone43:
    s_waitcnt vmcnt(0)
    s_add_u32 s64, s64, 98304
    s_add_u32 s65, s65, 94208
    buffer_load_dwordx4 v[60:63], v251, s[36:39], s64 offen offset:0 sc1
    buffer_load_dwordx4 v[64:67], v252, s[36:39], s64 offen offset:0 sc1
    buffer_load_dwordx4 v[68:71], v251, s[36:39], s65 offen offset:0 sc1
    buffer_load_dwordx4 v[72:75], v252, s[36:39], s65 offen offset:0 sc1
    buffer_load_dwordx4 v[76:79], v251, s[36:39], s65 offen offset:1024 sc1
    buffer_load_dwordx4 v[80:83], v252, s[36:39], s65 offen offset:1024 sc1
    buffer_load_dwordx4 v[84:87], v251, s[36:39], s65 offen offset:2048 sc1
    buffer_load_dwordx4 v[88:91], v252, s[36:39], s65 offen offset:2048 sc1
    buffer_load_dwordx4 v[92:95], v251, s[36:39], s65 offen offset:3072 sc1
    buffer_load_dwordx4 v[96:99], v252, s[36:39], s65 offen offset:3072 sc1
    s_add_u32 s65, s65, 4096
    buffer_load_dwordx4 v[100:103], v251, s[36:39], s65 offen offset:0 sc1
    buffer_load_dwordx4 v[104:107], v252, s[36:39], s65 offen offset:0 sc1
    buffer_load_dwordx4 v[108:111], v251, s[36:39], s65 offen offset:1024 sc1
    buffer_load_dwordx4 v[112:115], v252, s[36:39], s65 offen offset:1024 sc1
    s_waitcnt vmcnt(12)
    v_mfma_f32_16x16x32_bf16 v[20:23], v[0:3], v[60:63], 0
    v_mfma_f32_16x16x32_bf16 v[40:43], v[0:3], v[64:67], 0
    v_mfma_f32_16x16x32_bf16 v[24:27], v[4:7], v[60:63], 0
    v_mfma_f32_16x16x32_bf16 v[44:47], v[4:7], v[64:67], 0
    v_mfma_f32_16x16x32_bf16 v[28:31], v[8:11], v[60:63], 0
    v_mfma_f32_16x16x32_bf16 v[48:51], v[8:11], v[64:67], 0
    v_mfma_f32_16x16x32_bf16 v[32:35], v[12:15], v[60:63], 0
    v_mfma_f32_16x16x32_bf16 v[52:55], v[12:15], v[64:67], 0
    v_mfma_f32_16x16x32_bf16 v[36:39], v[16:19], v[60:63], 0
    v_mfma_f32_16x16x32_bf16 v[56:59], v[16:19], v[64:67], 0
    s_waitcnt vmcnt(10)
    v_mfma_f32_16x16x32_bf16 v[20:23], v[120:123], v[68:71], v[20:23]
    v_mfma_f32_16x16x32_bf16 v[40:43], v[120:123], v[72:75], v[40:43]
    v_mfma_f32_16x16x32_bf16 v[24:27], v[124:127], v[68:71], v[24:27]
    v_mfma_f32_16x16x32_bf16 v[44:47], v[124:127], v[72:75], v[44:47]
    v_mfma_f32_16x16x32_bf16 v[28:31], v[128:131], v[68:71], v[28:31]
    v_mfma_f32_16x16x32_bf16 v[48:51], v[128:131], v[72:75], v[48:51]
    v_mfma_f32_16x16x32_bf16 v[32:35], v[132:135], v[68:71], v[32:35]
    v_mfma_f32_16x16x32_bf16 v[52:55], v[132:135], v[72:75], v[52:55]
    v_mfma_f32_16x16x32_bf16 v[36:39], v[136:139], v[68:71], v[36:39]
    v_mfma_f32_16x16x32_bf16 v[56:59], v[136:139], v[72:75], v[56:59]
    s_waitcnt vmcnt(8)
    v_mfma_f32_16x16x32_bf16 v[20:23], v[140:143], v[76:79], v[20:23]
    v_mfma_f32_16x16x32_bf16 v[40:43], v[140:143], v[80:83], v[40:43]
    v_mfma_f32_16x16x32_bf16 v[24:27], v[144:147], v[76:79], v[24:27]
    v_mfma_f32_16x16x32_bf16 v[44:47], v[144:147], v[80:83], v[44:47]
    v_mfma_f32_16x16x32_bf16 v[28:31], v[148:151], v[76:79], v[28:31]
    v_mfma_f32_16x16x32_bf16 v[48:51], v[148:151], v[80:83], v[48:51]
    v_mfma_f32_16x16x32_bf16 v[32:35], v[152:155], v[76:79], v[32:35]
    v_mfma_f32_16x16x32_bf16 v[52:55], v[152:155], v[80:83], v[52:55]
    v_mfma_f32_16x16x32_bf16 v[36:39], v[156:159], v[76:79], v[36:39]
    v_mfma_f32_16x16x32_bf16 v[56:59], v[156:159], v[80:83], v[56:59]
    s_waitcnt vmcnt(6)
    v_mfma_f32_16x16x32_bf16 v[20:23], v[160:163], v[84:87], v[20:23]
    v_mfma_f32_16x16x32_bf16 v[40:43], v[160:163], v[88:91], v[40:43]
    v_mfma_f32_16x16x32_bf16 v[24:27], v[164:167], v[84:87], v[24:27]
    v_mfma_f32_16x16x32_bf16 v[44:47], v[164:167], v[88:91], v[44:47]
    v_mfma_f32_16x16x32_bf16 v[28:31], v[168:171], v[84:87], v[28:31]
    v_mfma_f32_16x16x32_bf16 v[48:51], v[168:171], v[88:91], v[48:51]
    v_mfma_f32_16x16x32_bf16 v[32:35], v[172:175], v[84:87], v[32:35]
    v_mfma_f32_16x16x32_bf16 v[52:55], v[172:175], v[88:91], v[52:55]
    v_mfma_f32_16x16x32_bf16 v[36:39], v[176:179], v[84:87], v[36:39]
    v_mfma_f32_16x16x32_bf16 v[56:59], v[176:179], v[88:91], v[56:59]
    s_waitcnt vmcnt(4)
    v_mfma_f32_16x16x32_bf16 v[20:23], v[180:183], v[92:95], v[20:23]
    v_mfma_f32_16x16x32_bf16 v[40:43], v[180:183], v[96:99], v[40:43]
    v_mfma_f32_16x16x32_bf16 v[24:27], v[184:187], v[92:95], v[24:27]
    v_mfma_f32_16x16x32_bf16 v[44:47], v[184:187], v[96:99], v[44:47]
    v_mfma_f32_16x16x32_bf16 v[28:31], v[188:191], v[92:95], v[28:31]
    v_mfma_f32_16x16x32_bf16 v[48:51], v[188:191], v[96:99], v[48:51]
    v_mfma_f32_16x16x32_bf16 v[32:35], v[192:195], v[92:95], v[32:35]
    v_mfma_f32_16x16x32_bf16 v[52:55], v[192:195], v[96:99], v[52:55]
    v_mfma_f32_16x16x32_bf16 v[36:39], v[196:199], v[92:95], v[36:39]
    v_mfma_f32_16x16x32_bf16 v[56:59], v[196:199], v[96:99], v[56:59]
    s_waitcnt vmcnt(2)
    v_mfma_f32_16x16x32_bf16 v[20:23], v[200:203], v[100:103], v[20:23]
    v_mfma_f32_16x16x32_bf16 v[40:43], v[200:203], v[104:107], v[40:43]
    v_mfma_f32_16x16x32_bf16 v[24:27], v[204:207], v[100:103], v[24:27]
    v_mfma_f32_16x16x32_bf16 v[44:47], v[204:207], v[104:107], v[44:47]
    v_mfma_f32_16x16x32_bf16 v[28:31], v[208:211], v[100:103], v[28:31]
    v_mfma_f32_16x16x32_bf16 v[48:51], v[208:211], v[104:107], v[48:51]
    v_mfma_f32_16x16x32_bf16 v[32:35], v[212:215], v[100:103], v[32:35]
    v_mfma_f32_16x16x32_bf16 v[52:55], v[212:215], v[104:107], v[52:55]
    v_mfma_f32_16x16x32_bf16 v[36:39], v[216:219], v[100:103], v[36:39]
    v_mfma_f32_16x16x32_bf16 v[56:59], v[216:219], v[104:107], v[56:59]
    s_waitcnt vmcnt(0)
    v_mfma_f32_16x16x32_bf16 v[20:23], v[220:223], v[108:111], v[20:23]
    v_mfma_f32_16x16x32_bf16 v[40:43], v[220:223], v[112:115], v[40:43]
    v_mfma_f32_16x16x32_bf16 v[24:27], v[224:227], v[108:111], v[24:27]
    v_mfma_f32_16x16x32_bf16 v[44:47], v[224:227], v[112:115], v[44:47]
    v_mfma_f32_16x16x32_bf16 v[28:31], v[228:231], v[108:111], v[28:31]
    v_mfma_f32_16x16x32_bf16 v[48:51], v[228:231], v[112:115], v[48:51]
    v_mfma_f32_16x16x32_bf16 v[32:35], v[232:235], v[108:111], v[32:35]
    v_mfma_f32_16x16x32_bf16 v[52:55], v[232:235], v[112:115], v[52:55]
    v_mfma_f32_16x16x32_bf16 v[36:39], v[236:239], v[108:111], v[36:39]
    v_mfma_f32_16x16x32_bf16 v[56:59], v[236:239], v[112:115], v[56:59]
L_p5e:
    ds_write_b128 v250, v[20:23] offset:0
    ds_write_b128 v250, v[24:27] offset:1024
    s_nop 0
    ds_write_b128 v250, v[28:31] offset:2048
    s_nop 0
    ds_write_b128 v250, v[32:35] offset:3072
    s_nop 0
    ds_write_b128 v250, v[36:39] offset:4096
    ds_write_b128 v253, v[40:43] offset:0
    ds_write_b128 v253, v[44:47] offset:1024
    ds_write_b128 v253, v[48:51] offset:2048
    ds_write_b128 v253, v[52:55] offset:3072
    ds_write_b128 v253, v[56:59] offset:4096
    s_add_u32 s78, s46, 1
    s_cmp_eq_u32 s46, 2
    s_cselect_b32 s78, 0, s78
    s_min_u32 s78, s78, 3
    s_mul_i32 s78, s78, 40960
    s_mul_i32 s79, s45, 3072
    s_add_u32 s78, s78, s79
    v_add_u32 v1, s78, v246
    v_and_b32 v2, 15, v245
    v_lshrrev_b32 v3, 4, v245
    v_mul_u32_u24 v2, 1280, v2
    v_lshl_add_u32 v5, v3, 3, v2
    v_and_b32 v4, 1, v3
    v_lshrrev_b32 v3, 1, v3
    v_lshl_add_u32 v2, v4, 5, v2
    v_lshl_add_u32 v4, v3, 4, v2
    s_lshl_b32 s56, s6, 2
    s_add_u32 s56, s56, s46
    s_mul_i32 s56, s56, 20480
    s_mul_i32 s57, s7, 160
    s_add_u32 s56, s56, s57
    s_mul_i32 s57, s45, 96
    s_add_u32 s56, s56, s57
    s_waitcnt lgkmcnt(0)
    s_barrier
    ds_read_b128 v[64:67], v1 offset:0
    ds_read_b128 v[68:71], v1 offset:5120
    ds_read_b128 v[72:75], v1 offset:10240
    ds_read_b128 v[76:79], v1 offset:15360
    ds_read_b128 v[80:83], v1 offset:20480
    ds_read_b128 v[84:87], v1 offset:25600
    ds_read_b128 v[88:91], v1 offset:30720
    ds_read_b128 v[92:95], v1 offset:35840
    ds_read_b128 v[96:99], v1 offset:1024
    ds_read_b128 v[100:103], v1 offset:6144
    ds_read_b128 v[104:107], v1 offset:11264
    ds_read_b128 v[108:111], v1 offset:16384
    ds_read_b128 v[112:115], v1 offset:21504
    ds_read_b128 v[116:119], v1 offset:26624
    ds_read_b128 v[120:123], v1 offset:31744
    ds_read_b128 v[124:127], v1 offset:36864
    s_cmp_eq_u32 s45, 1
    s_cbranch_scc1 L_t544
    ds_read_b128 v[128:131], v1 offset:2048
    ds_read_b128 v[132:135], v1 offset:7168
    ds_read_b128 v[136:139], v1 offset:12288
    ds_read_b128 v[140:143], v1 offset:17408
    ds_read_b128 v[144:147], v1 offset:22528
    ds_read_b128 v[148:151], v1 offset:27648
    ds_read_b128 v[152:155], v1 offset:32768
    ds_read_b128 v[156:159], v1 offset:37888
L_t544:
    s_waitcnt lgkmcnt(8)
    v_pk_add_f32 v[64:65], v[64:65], v[80:81]
    v_pk_add_f32 v[66:67], v[66:67], v[82:83]
    v_pk_add_f32 v[68:69], v[68:69], v[84:85]
    v_pk_add_f32 v[70:71], v[70:71], v[86:87]
    v_pk_add_f32 v[72:73], v[72:73], v[88:89]
    v_pk_add_f32 v[74:75], v[74:75], v[90:91]
    v_pk_add_f32 v[76:77], v[76:77], v[92:93]
    v_pk_add_f32 v[78:79], v[78:79], v[94:95]
    v_pk_add_f32 v[64:65], v[64:65], v[72:73]
    v_pk_add_f32 v[66:67], v[66:67], v[74:75]
    v_pk_add_f32 v[68:69], v[68:69], v[76:77]
    v_pk_add_f32 v[70:71], v[70:71], v[78:79]
    v_pk_add_f32 v[64:65], v[64:65], v[68:69]
    v_pk_add_f32 v[66:67], v[66:67], v[70:71]
    v_cvt_pk_bf16_f32 v10, v64, v65
    v_cvt_pk_bf16_f32 v11, v66, v67
    s_waitcnt lgkmcnt(0)
    v_pk_add_f32 v[96:97], v[96:97], v[112:113]
    v_pk_add_f32 v[98:99], v[98:99], v[114:115]
    v_pk_add_f32 v[100:101], v[100:101], v[116:117]
    v_pk_add_f32 v[102:103], v[102:103], v[118:119]
    v_pk_add_f32 v[104:105], v[104:105], v[120:121]
    v_pk_add_f32 v[106:107], v[106:107], v[122:123]
    v_pk_add_f32 v[108:109], v[108:109], v[124:125]
    v_pk_add_f32 v[110:111], v[110:111], v[126:127]
    v_pk_add_f32 v[96:97], v[96:97], v[104:105]
    v_pk_add_f32 v[98:99], v[98:99], v[106:107]
    v_pk_add_f32 v[100:101], v[100:101], v[108:109]
    v_pk_add_f32 v[102:103], v[102:103], v[110:111]
    v_pk_add_f32 v[96:97], v[96:97], v[100:101]
    v_pk_add_f32 v[98:99], v[98:99], v[102:103]
    v_cvt_pk_bf16_f32 v12, v96, v97
    v_cvt_pk_bf16_f32 v13, v98, v99
    s_nop 0
    v_permlane16_swap_b32 v10, v12
    v_permlane16_swap_b32 v11, v13
    s_cmp_eq_u32 s42, 0
    s_cbranch_scc1 L_slow46
    buffer_store_dwordx4 v[10:13], v4, s[32:35], s56 offen nt
    s_branch L_stend47
L_slow46:
    buffer_store_dwordx4 v[10:13], v4, s[32:35], s56 offen nt sc1
L_stend47:
    s_cmp_eq_u32 s45, 1
    s_cbranch_scc1 L_t645
    s_waitcnt lgkmcnt(0)
    v_pk_add_f32 v[128:129], v[128:129], v[144:145]
    v_pk_add_f32 v[130:131], v[130:131], v[146:147]
    v_pk_add_f32 v[132:133], v[132:133], v[148:149]
    v_pk_add_f32 v[134:135], v[134:135], v[150:151]
    v_pk_add_f32 v[136:137], v[136:137], v[152:153]
    v_pk_add_f32 v[138:139], v[138:139], v[154:155]
    v_pk_add_f32 v[140:141], v[140:141], v[156:157]
    v_pk_add_f32 v[142:143], v[142:143], v[158:159]
    v_pk_add_f32 v[128:129], v[128:129], v[136:137]
    v_pk_add_f32 v[130:131], v[130:131], v[138:139]
    v_pk_add_f32 v[132:133], v[132:133], v[140:141]
    v_pk_add_f32 v[134:135], v[134:135], v[142:143]
    v_pk_add_f32 v[128:129], v[128:129], v[132:133]
    v_pk_add_f32 v[130:131], v[130:131], v[134:135]
    v_cvt_pk_bf16_f32 v14, v128, v129
    v_cvt_pk_bf16_f32 v15, v130, v131
    s_cmp_eq_u32 s42, 0
    s_cbranch_scc1 L_slow48
    buffer_store_dwordx2 v[14:15], v5, s[32:35], s56 offen offset:64 nt
    s_branch L_stend49
L_slow48:
    buffer_store_dwordx2 v[14:15], v5, s[32:35], s56 offen offset:64 nt sc1
L_stend49:
L_t645:
    s_add_u32 s78, s2, s3
    s_cmp_lg_u32 s78, 0
    s_cbranch_scc1 L_ep50
    v_mov_b32 v46, s40
    s_mov_b64 exec, 1
    buffer_store_dword v46, off, s[36:39], 0 sc1
    s_mov_b64 exec, -1
L_ep50:
L_exit:
    s_endpgm
L_fallback:
    v_subrev_u32 v140, 133120, v140
    v_subrev_u32 v141, 133120, v141
    v_subrev_u32 v142, 133120, v142
    v_mov_b32 v144, 0xff800000
    v_mov_b32 v145, 0xff800000
    s_mov_b32 s63, 65536
    s_nop 7
L_fb1:
    buffer_load_dwordx4 v[80:83], v140, s[36:39], s63 offen sc1
    buffer_load_dwordx2 v[88:89], v141, s[36:39], s63 offen sc1
    s_waitcnt vmcnt(0)
    v_mfma_f32_32x32x16_bf16 v[32:47], v[80:83], v[128:131], 0
    v_mfma_f32_32x32x8_bf16 v[32:47], v[88:89], v[132:133], v[32:47]
    v_mfma_f32_32x32x16_bf16 v[48:63], v[80:83], v[134:137], 0
    v_mfma_f32_32x32x8_bf16 v[48:63], v[88:89], v[138:139], v[48:63]
    s_nop 9
    v_max3_f32 v144, v144, v32, v33
    v_max3_f32 v144, v144, v34, v35
    v_max3_f32 v144, v144, v36, v37
    v_max3_f32 v144, v144, v38, v39
    v_max3_f32 v144, v144, v40, v41
    v_max3_f32 v144, v144, v42, v43
    v_max3_f32 v144, v144, v44, v45
    v_max3_f32 v144, v144, v46, v47
    v_max3_f32 v145, v145, v48, v49
    v_max3_f32 v145, v145, v50, v51
    v_max3_f32 v145, v145, v52, v53
    v_max3_f32 v145, v145, v54, v55
    v_max3_f32 v145, v145, v56, v57
    v_max3_f32 v145, v145, v58, v59
    v_max3_f32 v145, v145, v60, v61
    v_max3_f32 v145, v145, v62, v63
    s_add_u32 s63, s63, 2560
    s_cmp_lt_u32 s63, 229376
    s_cbranch_scc1 L_fb1
    v_mov_b32 v146, v144
    v_mov_b32 v147, v145
    s_nop 0
    v_permlane32_swap_b32 v144, v146
    v_permlane32_swap_b32 v145, v147
    v_max_f32 v144, v144, v146
    v_max_f32 v145, v145, v147
    s_mov_b32 s63, 65536
    v_mov_b32 v0, 0
    v_mov_b32 v1, 0
    v_mov_b32 v2, 0
    v_mov_b32 v3, 0
    v_mov_b32 v4, 0
    v_mov_b32 v5, 0
    v_mov_b32 v6, 0
    v_mov_b32 v7, 0
    v_mov_b32 v8, 0
    v_mov_b32 v9, 0
    v_mov_b32 v10, 0
    v_mov_b32 v11, 0
    v_mov_b32 v12, 0
    v_mov_b32 v13, 0
    v_mov_b32 v14, 0
    v_mov_b32 v15, 0
    v_mov_b32 v16, 0
    v_mov_b32 v17, 0
    v_mov_b32 v18, 0
    v_mov_b32 v19, 0
    v_mov_b32 v20, 0
    v_mov_b32 v21, 0
    v_mov_b32 v22, 0
    v_mov_b32 v23, 0
    v_mov_b32 v24, 0
    v_mov_b32 v25, 0
    v_mov_b32 v26, 0
    v_mov_b32 v27, 0
    v_mov_b32 v28, 0
    v_mov_b32 v29, 0
    v_mov_b32 v30, 0
    v_mov_b32 v31, 0
    s_nop 7
L_fb2:
    buffer_load_dwordx4 v[80:83], v140, s[36:39], s63 offen sc1
    buffer_load_dwordx2 v[88:89], v141, s[36:39], s63 offen sc1
    s_mov_b64 exec, s[76:77]
    buffer_load_dwordx4 v[96:99], v142, s[36:39], s63 offen sc1
    buffer_load_dwordx4 v[100:103], v142, s[36:39], s63 offen offset:1280 sc1
    s_mov_b64 exec, -1
    s_waitcnt vmcnt(0)
    v_mfma_f32_32x32x16_bf16 v[32:47], v[80:83], v[128:131], 0
    v_mfma_f32_32x32x8_bf16 v[32:47], v[88:89], v[132:133], v[32:47]
    v_mfma_f32_32x32x16_bf16 v[48:63], v[80:83], v[134:137], 0
    v_mfma_f32_32x32x8_bf16 v[48:63], v[88:89], v[138:139], v[48:63]
    s_nop 9
    v_sub_f32 v32, v32, v144
    v_sub_f32 v33, v33, v144
    v_sub_f32 v34, v34, v144
    v_sub_f32 v35, v35, v144
    v_sub_f32 v36, v36, v144
    v_sub_f32 v37, v37, v144
    v_sub_f32 v38, v38, v144
    v_sub_f32 v39, v39, v144
    v_sub_f32 v40, v40, v144
    v_sub_f32 v41, v41, v144
    v_sub_f32 v42, v42, v144
    v_sub_f32 v43, v43, v144
    v_sub_f32 v44, v44, v144
    v_sub_f32 v45, v45, v144
    v_sub_f32 v46, v46, v144
    v_sub_f32 v47, v47, v144
    v_exp_f32 v32, v32
    v_exp_f32 v33, v33
    v_exp_f32 v34, v34
    v_exp_f32 v35, v35
    v_exp_f32 v36, v36
    v_exp_f32 v37, v37
    v_exp_f32 v38, v38
    v_exp_f32 v39, v39
    v_exp_f32 v40, v40
    v_exp_f32 v41, v41
    v_exp_f32 v42, v42
    v_exp_f32 v43, v43
    v_exp_f32 v44, v44
    v_exp_f32 v45, v45
    v_exp_f32 v46, v46
    v_exp_f32 v47, v47
    v_sub_f32 v48, v48, v145
    v_sub_f32 v49, v49, v145
    v_sub_f32 v50, v50, v145
    v_sub_f32 v51, v51, v145
    v_sub_f32 v52, v52, v145
    v_sub_f32 v53, v53, v145
    v_sub_f32 v54, v54, v145
    v_sub_f32 v55, v55, v145
    v_sub_f32 v56, v56, v145
    v_sub_f32 v57, v57, v145
    v_sub_f32 v58, v58, v145
    v_sub_f32 v59, v59, v145
    v_sub_f32 v60, v60, v145
    v_sub_f32 v61, v61, v145
    v_sub_f32 v62, v62, v145
    v_sub_f32 v63, v63, v145
    v_exp_f32 v48, v48
    v_exp_f32 v49, v49
    v_exp_f32 v50, v50
    v_exp_f32 v51, v51
    v_exp_f32 v52, v52
    v_exp_f32 v53, v53
    v_exp_f32 v54, v54
    v_exp_f32 v55, v55
    v_exp_f32 v56, v56
    v_exp_f32 v57, v57
    v_exp_f32 v58, v58
    v_exp_f32 v59, v59
    v_exp_f32 v60, v60
    v_exp_f32 v61, v61
    v_exp_f32 v62, v62
    v_exp_f32 v63, v63
    v_smfmac_f32_32x32x32_bf16 v[0:15], v[96:99], v[32:39], v143
    v_smfmac_f32_32x32x32_bf16 v[0:15], v[100:103], v[40:47], v143
    v_smfmac_f32_32x32x32_bf16 v[16:31], v[96:99], v[48:55], v143
    v_smfmac_f32_32x32x32_bf16 v[16:31], v[100:103], v[56:63], v143
    s_add_u32 s63, s63, 2560
    s_cmp_lt_u32 s63, 229376
    s_nop 7
    s_cbranch_scc1 L_fb2
    s_mov_b32 s64, 1
    s_nop 7
    s_branch L_fbret
L_end:
    s_endpgm
.section .rodata,"a"
.p2align 6
.amdhsa_kernel sequential_preLN__grouped_kv_mqa__glu_gated_geglu__prompt_kernel
  .amdhsa_next_free_vgpr 256
  .amdhsa_next_free_sgpr 102
  .amdhsa_accum_offset 256
  .amdhsa_group_segment_fixed_size 0
  .amdhsa_kernarg_size 96
  .amdhsa_user_sgpr_count 2
  .amdhsa_user_sgpr_kernarg_segment_ptr 1
  .amdhsa_system_sgpr_workgroup_id_x 1
.end_amdhsa_kernel
```
